```python
import torch

def _softmax(x, axis=-1):
    return torch.softmax(x, dim=axis)

def _gelu(x):
    return torch.nn.functional.gelu(x, approximate='tanh')

def _silu(x):
    return torch.nn.functional.silu(x)

def _sigmoid(x):
    return torch.sigmoid(x)

def _layernorm(x, axis=-1, eps=1e-05):
    m = x.mean(dim=axis, keepdim=True)
    v = x.var(dim=axis, keepdim=True, unbiased=False)
    return (x - m) / torch.sqrt(v + eps)

def _scatter_add(tgt, idx, src, axis=0):
    return tgt.clone().index_add_(axis, idx, src)

def _segment_sum(src, seg, n):
    out = torch.zeros((n,) + src.shape[1:], dtype=src.dtype)
    return out.index_add_(0, seg, src)

def _pad(x, pw):
    flat = tuple((v for pair in reversed(pw) for v in pair))
    return torch.nn.functional.pad(x, flat)
kernel_name = 'adaLN_cond__spectral_gfnet__glu_gated_bilinear__prompt'

def setup_inputs():

    _w = lambda a: (lambda t: t.to(torch.bfloat16) if t.is_floating_point() else t)(torch.as_tensor(a))

    def _A_setup():
        B, S, D = (1, 2048, 640)
        Df = D // 2 + 1
        return {'x': _w((lambda *s: torch.randn(*s, dtype=torch.bfloat16) * 0.05)(B, S, D)), 'w_r': _w((lambda *s: torch.randn(*s, dtype=torch.bfloat16) * 1.6)(S, Df) * 0.02), 'w_i': _w((lambda *s: torch.randn(*s, dtype=torch.bfloat16) * 1.6)(S, Df) * 0.02)}
    _A_in = _A_setup()

    def _B_setup():
        B, S, D, F = (1, 2048, 640, 1728)
        return {'x': _w((lambda *s: torch.randn(*s, dtype=torch.bfloat16) * 0.05)(B, S, D)), 'w_gate': _w((lambda *s: torch.randn(*s, dtype=torch.bfloat16) * 0.4)(D, F) * D ** (-0.5)), 'w_up': _w((lambda *s: torch.randn(*s, dtype=torch.bfloat16) * 0.4)(D, F) * D ** (-0.5)), 'w_down': _w((lambda *s: torch.randn(*s, dtype=torch.bfloat16) * 0.4)(F, D) * F ** (-0.5))}
    _B_in = _B_setup()
    return {'A_x': _A_in['x'], 'A_w_r': _A_in['w_r'], 'A_w_i': _A_in['w_i'], 'B_x': _B_in['x'], 'B_w_gate': _B_in['w_gate'], 'B_w_up': _B_in['w_up'], 'B_w_down': _B_in['w_down'], 'c': _w((lambda *s: torch.randn(*s, dtype=torch.bfloat16) * 0.1)(1, 640) * 8.0), 'w_mod': _w((lambda *s: torch.randn(*s, dtype=torch.bfloat16) * 0.1)(640, 6 * 640) * 640 ** (-0.5) * 8.0)}

def reference(A_x, A_w_r, A_w_i, B_x, B_w_gate, B_w_up, B_w_down, c, w_mod):

    def _A_ref(x, w_r, w_i):
        B, S, D = x.shape
        X = (lambda x, axes=(-2, -1): torch.fft.rfft2(x.float(), dim=axes))(x, axes=(-2, -1))
        W = w_r + 1j * w_i
        X = X * W
        y = (lambda x, s, axes=(-2, -1): torch.fft.irfft2(x, s=s, dim=axes).to(torch.bfloat16))(X, (S, D), axes=(-2, -1))
        return y

    def _B_ref(x, w_gate, w_up, w_down):
        g = torch.einsum('bsd,df->bsf', x, w_gate)
        u = torch.einsum('bsd,df->bsf', x, w_up)
        h = g * u
        return torch.einsum('bsf,fd->bsd', h, w_down)
    x = A_x
    mod = (_silu(c) @ w_mod).reshape(c.shape[0], 6, 1, -1)
    sa, ca, ga, sb, cb, gb = (mod[:, 0].clone(), mod[:, 1].clone(), mod[:, 2].clone(), mod[:, 3].clone(), mod[:, 4].clone(), mod[:, 5].clone())
    h = _layernorm(x, axis=-1) * (1 + ca) + sa
    x = x + ga * _A_ref(h, A_w_r, A_w_i)
    h = _layernorm(x, axis=-1) * (1 + cb) + sb
    x = x + gb * _B_ref(h, B_w_gate, B_w_up, B_w_down)
    return x
```

```asm
; @launch grid=(256,1,1) block=(256,1,1) lds=163840
.amdgcn_target "amdgcn-amd-amdhsa--gfx950"
.text
.p2align 12
.globl adaLN_cond__spectral_gfnet__glu_gated_bilinear__prompt_kernel
.p2align 8
.type adaLN_cond__spectral_gfnet__glu_gated_bilinear__prompt_kernel,@function
adaLN_cond__spectral_gfnet__glu_gated_bilinear__prompt_kernel:
L_b:
    s_load_dwordx2 s[12:13], s[0:1], 0
    s_mov_b32 s14, 2621440
    s_mov_b32 s15, 0x20000
    s_load_dwordx2 s[8:9], s[0:1], 88
    s_mov_b32 s10, 22609920
    s_mov_b32 s11, 0x20000
    v_lshrrev_b32 v1, 6, v0
    s_nop 0
    v_readfirstlane_b32 s3, v1
    v_and_b32 v1, 63, v0
    s_load_dwordx2 s[20:21], s[0:1], 80
    s_mov_b32 s22, 256
    s_mov_b32 s23, 0x20000
    s_load_dwordx2 s[24:25], s[0:1], 8
    s_mov_b32 s26, 1314816
    s_mov_b32 s27, 0x20000
    s_load_dwordx2 s[28:29], s[0:1], 16
    s_mov_b32 s30, 1314816
    s_mov_b32 s31, 0x20000
    s_load_dwordx2 s[16:17], s[0:1], 72
    s_mov_b32 s18, 2621440
    s_mov_b32 s19, 0x20000
    v_and_b32 v2, 15, v1
    v_lshrrev_b32 v3, 4, v1
    v_lshlrev_b32 v4, 4, v1
    s_cmp_ge_u32 s2, 160
    s_cbranch_scc1 L_oth
    s_and_b32 s4, s2, 7
    s_lshr_b32 s5, s2, 3
    s_mul_i32 s6, s5, 52
    s_lshr_b32 s6, s6, 8
    s_mul_i32 s7, s6, 5
    s_sub_u32 s5, s5, s7
    s_lshl_b32 s4, s4, 2
    s_add_u32 s4, s4, s6
    s_lshl_b32 s48, s3, 9
    s_add_u32 s48, s48, s4
    s_mul_i32 s48, s48, 1280
    s_lshl_b32 m0, s3, 10
    v_sub_u32 v6, 0, v3
    v_xor_b32 v6, v6, v1
    v_and_b32 v6, 3, v6
    v_lshrrev_b32 v5, 2, v1
    v_mul_u32_u24 v5, 40960, v5
    v_lshl_add_u32 v5, v6, 4, v5
    v_lshrrev_b32 v7, 1, v1
    v_mul_u32_u24 v7, 40960, v7
    v_and_b32 v6, 1, v1
    v_lshl_add_u32 v7, v6, 7, v7
    s_lshl_b32 s49, s5, 8
    s_add_u32 s49, s49, s48
    s_waitcnt lgkmcnt(0)
    s_mov_b32 exec_hi, 0
    buffer_load_dword v253, v7, s[12:15], s49 offen
    s_mov_b64 exec, -1
    buffer_load_dwordx4 v5, s[12:15], s49 offen offset:0 lds
    s_add_u32 m0, m0, 4032
    s_nop 0
    buffer_load_dwordx4 v5, s[12:15], s49 offen offset:64 lds
    s_add_u32 m0, m0, 4032
    s_nop 0
    buffer_load_dwordx4 v5, s[12:15], s49 offen offset:128 lds
    s_add_u32 m0, m0, 4032
    s_nop 0
    buffer_load_dwordx4 v5, s[12:15], s49 offen offset:192 lds
    s_add_u32 m0, m0, 4288
    s_add_u32 s49, s49, 256
    s_cmp_eq_u32 s5, 4
    s_cselect_b32 s49, s48, s49
    buffer_load_dwordx4 v5, s[12:15], s49 offen offset:0 lds
    s_add_u32 m0, m0, 4032
    s_nop 0
    buffer_load_dwordx4 v5, s[12:15], s49 offen offset:64 lds
    s_add_u32 m0, m0, 4032
    s_nop 0
    buffer_load_dwordx4 v5, s[12:15], s49 offen offset:128 lds
    s_add_u32 m0, m0, 4032
    s_nop 0
    buffer_load_dwordx4 v5, s[12:15], s49 offen offset:192 lds
    s_add_u32 m0, m0, 4288
    s_add_u32 s49, s49, 256
    s_cmp_eq_u32 s5, 3
    s_cselect_b32 s49, s48, s49
    buffer_load_dwordx4 v5, s[12:15], s49 offen offset:0 lds
    s_add_u32 m0, m0, 4032
    s_nop 0
    buffer_load_dwordx4 v5, s[12:15], s49 offen offset:64 lds
    s_add_u32 m0, m0, 4032
    v_lshrrev_b32 v248, 1, v1
    v_lshl_add_u32 v248, v248, 6, s4
    v_sub_u32 v249, 2048, v248
    s_cmp_ge_u32 s3, 2
    s_cselect_b64 s[46:47], -1, 0
    v_cndmask_b32 v248, v248, v249, s[46:47]
    v_mul_u32_u24 v248, 642, v248
    v_and_b32 v248, 0xffffff80, v248
    v_and_b32 v249, 1, v1
    v_mul_u32_u24 v249, 640, v249
    v_add_u32 v248, v248, v249
    s_lshl_b32 s40, s5, 7
    s_bitcmp1_b32 s3, 0
    s_cselect_b32 s44, s28, s24
    s_cselect_b32 s45, s29, s25
    s_mov_b32 s46, 1314816
    s_mov_b32 s47, 0x20000
    s_cmp_eq_u32 s5, 0
    s_cselect_b32 s41, -1, 0x55555555
    s_mov_b32 exec_lo, s41
    s_mov_b32 exec_hi, s41
    buffer_load_dword v252, v248, s[44:47], s40 offen
    s_mov_b64 exec, -1
    s_lshl_b32 s6, s3, 4
    v_add_u32 v14, s6, v2
    v_lshrrev_b32 v8, 1, v14
    v_and_b32 v6, 1, v14
    v_cmp_eq_u32 vcc, 1, v14
    v_lshrrev_b32 v7, 1, v3
    v_lshlrev_b32 v7, 4, v7
    v_and_b32 v44, 1, v3
    v_lshl_add_u32 v44, v44, 2, v7
    v_cndmask_b32 v8, v8, 32, vcc
    v_cndmask_b32 v6, v6, 0, vcc
    v_cvt_f32_u32 v8, v8
    v_cvt_f32_u32 v6, v6
    v_cvt_f32_u32 v7, v44
    v_mul_f32 v8, 0x3c800000, v8
    v_mul_f32 v6, 0x3e800000, v6
    v_fma_f32 v6, v8, v7, v6
    v_fmamk_f32 v16, v8, 0x00000000, v6
    v_cos_f32 v16, v16
    v_fmamk_f32 v17, v8, 0x3f800000, v6
    v_cos_f32 v17, v17
    v_fmamk_f32 v18, v8, 0x40000000, v6
    v_cos_f32 v18, v18
    v_fmamk_f32 v19, v8, 0x40400000, v6
    v_cos_f32 v19, v19
    v_fmamk_f32 v20, v8, 0x41000000, v6
    v_cos_f32 v20, v20
    v_fmamk_f32 v21, v8, 0x41100000, v6
    v_cos_f32 v21, v21
    v_fmamk_f32 v22, v8, 0x41200000, v6
    v_cos_f32 v22, v22
    v_fmamk_f32 v23, v8, 0x41300000, v6
    v_cos_f32 v23, v23
    v_fmamk_f32 v24, v8, 0x42000000, v6
    v_cos_f32 v24, v24
    v_fmamk_f32 v25, v8, 0x42040000, v6
    v_cos_f32 v25, v25
    v_fmamk_f32 v26, v8, 0x42080000, v6
    v_cos_f32 v26, v26
    v_fmamk_f32 v27, v8, 0x420c0000, v6
    v_cos_f32 v27, v27
    v_fmamk_f32 v28, v8, 0x42200000, v6
    v_cos_f32 v28, v28
    v_fmamk_f32 v29, v8, 0x42240000, v6
    v_cos_f32 v29, v29
    v_fmamk_f32 v30, v8, 0x42280000, v6
    v_cos_f32 v30, v30
    v_fmamk_f32 v31, v8, 0x422c0000, v6
    v_cos_f32 v31, v31
    v_mov_b32 v32, 0x3f803f80
    v_mov_b32 v33, 0x3f803f80
    v_mov_b32 v34, 0x3f803f80
    v_mov_b32 v35, 0x3f803f80
    v_lshrrev_b32 v14, 2, v2
    v_sub_u32 v14, 0, v14
    v_xor_b32 v14, v14, v3
    v_and_b32 v14, 3, v14
    v_lshlrev_b32 v14, 4, v14
    v_lshl_add_u32 v14, v2, 6, v14
    s_lshl_b32 s6, s3, 10
    v_add_u32 v14, s6, v14
    v_add_u32 v9, 40960, v14
    s_nop 4
    s_call_b64 s[62:63], L_pre2
    buffer_load_dwordx4 v5, s[12:15], s49 offen offset:128 lds
    s_add_u32 m0, m0, 4032
    s_nop 0
    buffer_load_dwordx4 v5, s[12:15], s49 offen offset:192 lds
    s_add_u32 m0, m0, 4288
    s_add_u32 s49, s49, 256
    s_cmp_eq_u32 s5, 2
    s_cselect_b32 s49, s48, s49
    buffer_load_dwordx4 v5, s[12:15], s49 offen offset:0 lds
    s_add_u32 m0, m0, 4032
    s_nop 0
    buffer_load_dwordx4 v5, s[12:15], s49 offen offset:64 lds
    s_add_u32 m0, m0, 4032
    s_nop 0
    buffer_load_dwordx4 v5, s[12:15], s49 offen offset:128 lds
    s_add_u32 m0, m0, 4032
    v_bfe_u32 v10, v1, 2, 2
    v_add_u32 v10, v10, v44
    v_lshlrev_b32 v10, 6, v10
    v_and_b32 v11, 1, v1
    v_lshl_add_u32 v10, v11, 3, v10
    v_and_b32 v11, 1, v3
    v_sub_u32 v11, 0, v11
    v_bfe_u32 v12, v1, 1, 1
    v_xor_b32 v11, v11, v12
    v_and_b32 v11, 3, v11
    v_lshl_add_u32 v12, v11, 4, v10
    v_xor_b32 v13, 32, v12
    v_and_b32 v6, 3, v2
    v_bfe_u32 v7, v2, 2, 1
    v_lshl_add_u32 v6, v7, 3, v6
    v_lshrrev_b32 v7, 3, v2
    v_lshl_add_u32 v6, v7, 2, v6
    s_lshl_b32 s6, s3, 4
    v_add_u32 v6, s6, v6
    v_lshlrev_b32 v7, 1, v6
    v_lshlrev_b32 v6, 2, v6
    v_add_u32 v6, 81920, v6
    v_add_u32 v7, 81920, v7
    v_lshlrev_b32 v44, 5, v3
    v_add_u32 v44, 81920, v44
    v_lshlrev_b32 v45, 4, v3
    v_add_u32 v45, 81920, v45
    s_mov_b32 s52, 0x22222222
    s_mov_b32 s53, 0x22222222
    s_mov_b32 s54, 0x44444444
    s_mov_b32 s55, 0x44444444
    s_mov_b32 s56, 0x88888888
    s_mov_b32 s57, 0x88888888
    s_mov_b32 s6, 164864
    v_mul_lo_u32 v46, v3, s6
    v_lshl_add_u32 v46, v2, 4, v46
    s_mul_i32 s58, s3, 659456
    s_lshl_b32 s59, s5, 14
    s_add_u32 s58, s58, s59
    s_lshl_b32 s59, s4, 9
    s_add_u32 s58, s58, s59
    s_add_u32 s59, s58, 82432
    buffer_load_dwordx4 v5, s[12:15], s49 offen offset:192 lds
    s_add_u32 m0, m0, 4288
    s_add_u32 s49, s49, 256
    s_cmp_eq_u32 s5, 1
    s_cselect_b32 s49, s48, s49
    buffer_load_dwordx4 v5, s[12:15], s49 offen offset:0 lds
    s_add_u32 m0, m0, 4032
    s_nop 0
    buffer_load_dwordx4 v5, s[12:15], s49 offen offset:64 lds
    s_add_u32 m0, m0, 4032
    s_nop 0
    buffer_load_dwordx4 v5, s[12:15], s49 offen offset:128 lds
    s_add_u32 m0, m0, 4032
    s_nop 0
    buffer_load_dwordx4 v5, s[12:15], s49 offen offset:192 lds
    s_cmp_lg_u32 s3, 0
    s_cbranch_scc1 L_tc256_0
    s_call_b64 s[60:61], L_pg1
L_tc256_0:
    s_cmp_lg_u32 s3, 1
    s_cbranch_scc1 L_tc256_1
    s_call_b64 s[60:61], L_pg2
L_tc256_1:
    s_waitcnt vmcnt(18)
    ds_read_b128 v[48:51], v14 offset:0
    ds_read_b128 v[52:55], v14 offset:4096
    s_waitcnt vmcnt(16)
    ds_read_b128 v[56:59], v14 offset:8192
    ds_read_b128 v[60:63], v14 offset:12288
    s_waitcnt lgkmcnt(2)
    v_mfma_f32_16x16x32_bf16 v[36:39], v[48:51], v[32:35], 0
    v_mfma_f32_16x16x32_bf16 v[40:43], v[48:51], v[48:51], 0
    v_mfma_f32_16x16x32_bf16 v[36:39], v[52:55], v[32:35], v[36:39]
    v_mfma_f32_16x16x32_bf16 v[40:43], v[52:55], v[52:55], v[40:43]
    s_waitcnt vmcnt(14)
    ds_read_b128 v[64:67], v14 offset:16384
    ds_read_b128 v[68:71], v14 offset:20480
    s_waitcnt lgkmcnt(2)
    v_mfma_f32_16x16x32_bf16 v[36:39], v[56:59], v[32:35], v[36:39]
    v_mfma_f32_16x16x32_bf16 v[40:43], v[56:59], v[56:59], v[40:43]
    v_mfma_f32_16x16x32_bf16 v[36:39], v[60:63], v[32:35], v[36:39]
    v_mfma_f32_16x16x32_bf16 v[40:43], v[60:63], v[60:63], v[40:43]
    s_waitcnt vmcnt(12)
    ds_read_b128 v[72:75], v14 offset:24576
    ds_read_b128 v[76:79], v14 offset:28672
    s_waitcnt lgkmcnt(2)
    v_mfma_f32_16x16x32_bf16 v[36:39], v[64:67], v[32:35], v[36:39]
    v_mfma_f32_16x16x32_bf16 v[40:43], v[64:67], v[64:67], v[40:43]
    v_mfma_f32_16x16x32_bf16 v[36:39], v[68:71], v[32:35], v[36:39]
    v_mfma_f32_16x16x32_bf16 v[40:43], v[68:71], v[68:71], v[40:43]
    s_waitcnt vmcnt(10)
    ds_read_b128 v[80:83], v14 offset:32768
    ds_read_b128 v[84:87], v14 offset:36864
    s_waitcnt lgkmcnt(2)
    v_mfma_f32_16x16x32_bf16 v[36:39], v[72:75], v[32:35], v[36:39]
    v_mfma_f32_16x16x32_bf16 v[40:43], v[72:75], v[72:75], v[40:43]
    v_mfma_f32_16x16x32_bf16 v[36:39], v[76:79], v[32:35], v[36:39]
    v_mfma_f32_16x16x32_bf16 v[40:43], v[76:79], v[76:79], v[40:43]
    s_mov_b32 exec_lo, s68
    s_mov_b32 exec_hi, s68
    s_add_u32 m0, s69, 0
    s_nop 0
    buffer_load_dwordx4 v244, s[24:27], 0 offen lds
    s_add_u32 m0, s69, 1024
    s_nop 0
    buffer_load_dwordx4 v244, s[28:31], 0 offen lds
    s_add_u32 m0, s69, 2048
    s_nop 0
    buffer_load_dwordx4 v245, s[24:27], 0 offen lds
    s_add_u32 m0, s69, 3072
    s_nop 0
    buffer_load_dwordx4 v245, s[28:31], 0 offen lds
    s_add_u32 m0, s69, 4096
    s_nop 0
    buffer_load_dwordx4 v246, s[24:27], 0 offen lds
    s_add_u32 m0, s69, 5120
    s_nop 0
    buffer_load_dwordx4 v246, s[28:31], 0 offen lds
    s_add_u32 m0, s69, 6144
    s_nop 0
    buffer_load_dwordx4 v247, s[24:27], 0 offen lds
    s_add_u32 m0, s69, 7168
    s_nop 0
    buffer_load_dwordx4 v247, s[28:31], 0 offen lds
    s_mov_b64 exec, -1
    s_waitcnt vmcnt(16)
    ds_read_b128 v[88:91], v9 offset:0
    ds_read_b128 v[92:95], v9 offset:4096
    s_waitcnt lgkmcnt(2)
    v_mfma_f32_16x16x32_bf16 v[36:39], v[80:83], v[32:35], v[36:39]
    v_mfma_f32_16x16x32_bf16 v[40:43], v[80:83], v[80:83], v[40:43]
    v_mfma_f32_16x16x32_bf16 v[36:39], v[84:87], v[32:35], v[36:39]
    v_mfma_f32_16x16x32_bf16 v[40:43], v[84:87], v[84:87], v[40:43]
    s_waitcnt vmcnt(14)
    ds_read_b128 v[96:99], v9 offset:8192
    ds_read_b128 v[100:103], v9 offset:12288
    s_waitcnt lgkmcnt(2)
    v_mfma_f32_16x16x32_bf16 v[36:39], v[88:91], v[32:35], v[36:39]
    v_mfma_f32_16x16x32_bf16 v[40:43], v[88:91], v[88:91], v[40:43]
    v_mfma_f32_16x16x32_bf16 v[36:39], v[92:95], v[32:35], v[36:39]
    v_mfma_f32_16x16x32_bf16 v[40:43], v[92:95], v[92:95], v[40:43]
    s_waitcnt vmcnt(12)
    ds_read_b128 v[104:107], v9 offset:16384
    ds_read_b128 v[108:111], v9 offset:20480
    s_waitcnt lgkmcnt(2)
    v_mfma_f32_16x16x32_bf16 v[36:39], v[96:99], v[32:35], v[36:39]
    v_mfma_f32_16x16x32_bf16 v[40:43], v[96:99], v[96:99], v[40:43]
    v_mfma_f32_16x16x32_bf16 v[36:39], v[100:103], v[32:35], v[36:39]
    v_mfma_f32_16x16x32_bf16 v[40:43], v[100:103], v[100:103], v[40:43]
    s_waitcnt vmcnt(10)
    ds_read_b128 v[112:115], v9 offset:24576
    ds_read_b128 v[116:119], v9 offset:28672
    s_waitcnt lgkmcnt(2)
    v_mfma_f32_16x16x32_bf16 v[36:39], v[104:107], v[32:35], v[36:39]
    v_mfma_f32_16x16x32_bf16 v[40:43], v[104:107], v[104:107], v[40:43]
    v_mfma_f32_16x16x32_bf16 v[36:39], v[108:111], v[32:35], v[36:39]
    v_mfma_f32_16x16x32_bf16 v[40:43], v[108:111], v[108:111], v[40:43]
    s_waitcnt vmcnt(8)
    ds_read_b128 v[120:123], v9 offset:32768
    ds_read_b128 v[124:127], v9 offset:36864
    s_waitcnt lgkmcnt(2)
    v_mfma_f32_16x16x32_bf16 v[36:39], v[112:115], v[32:35], v[36:39]
    v_mfma_f32_16x16x32_bf16 v[40:43], v[112:115], v[112:115], v[40:43]
    v_mfma_f32_16x16x32_bf16 v[36:39], v[116:119], v[32:35], v[36:39]
    v_mfma_f32_16x16x32_bf16 v[40:43], v[116:119], v[116:119], v[40:43]
    s_barrier
    ds_read_b64_tr_b16 a[0:1], v12 offset:0
    ds_read_b64_tr_b16 a[2:3], v13 offset:512
    ds_read_b64_tr_b16 a[4:5], v12 offset:2048
    ds_read_b64_tr_b16 a[6:7], v13 offset:2560
    ds_read_b64_tr_b16 a[8:9], v13 offset:0
    ds_read_b64_tr_b16 a[10:11], v12 offset:512
    ds_read_b64_tr_b16 a[12:13], v13 offset:2048
    ds_read_b64_tr_b16 a[14:15], v12 offset:2560
    ds_read_b64_tr_b16 a[16:17], v12 offset:4096
    ds_read_b64_tr_b16 a[18:19], v13 offset:4608
    ds_read_b64_tr_b16 a[20:21], v12 offset:6144
    ds_read_b64_tr_b16 a[22:23], v13 offset:6656
    s_waitcnt lgkmcnt(12)
    v_mfma_f32_16x16x32_bf16 v[36:39], v[120:123], v[32:35], v[36:39]
    v_mfma_f32_16x16x32_bf16 v[40:43], v[120:123], v[120:123], v[40:43]
    v_mfma_f32_16x16x32_bf16 v[36:39], v[124:127], v[32:35], v[36:39]
    v_mfma_f32_16x16x32_bf16 v[40:43], v[124:127], v[124:127], v[40:43]
    ds_read_b64_tr_b16 a[24:25], v13 offset:4096
    ds_read_b64_tr_b16 a[26:27], v12 offset:4608
    ds_read_b64_tr_b16 a[28:29], v13 offset:6144
    ds_read_b64_tr_b16 a[30:31], v12 offset:6656
    ds_read_b64_tr_b16 a[32:33], v12 offset:8192
    ds_read_b64_tr_b16 a[34:35], v13 offset:8704
    ds_read_b64_tr_b16 a[36:37], v12 offset:10240
    ds_read_b64_tr_b16 a[38:39], v13 offset:10752
    ds_read_b64_tr_b16 a[40:41], v13 offset:8192
    ds_read_b64_tr_b16 a[42:43], v12 offset:8704
    ds_read_b64_tr_b16 a[44:45], v13 offset:10240
    ds_read_b64_tr_b16 a[46:47], v12 offset:10752
    ds_read_b64_tr_b16 a[48:49], v12 offset:12288
    ds_read_b64_tr_b16 a[50:51], v13 offset:12800
    ds_read_b64_tr_b16 a[52:53], v12 offset:14336
    ds_read_b64_tr_b16 a[54:55], v13 offset:14848
    ds_read_b64_tr_b16 a[56:57], v13 offset:12288
    ds_read_b64_tr_b16 a[58:59], v12 offset:12800
    ds_read_b64_tr_b16 a[60:61], v13 offset:14336
    ds_read_b64_tr_b16 a[62:63], v12 offset:14848
    v_cndmask_b32 v36, v36, v37, s[52:53]
    v_cndmask_b32 v36, v36, v38, s[54:55]
    v_cndmask_b32 v36, v36, v39, s[56:57]
    v_cndmask_b32 v40, v40, v41, s[52:53]
    v_cndmask_b32 v40, v40, v42, s[54:55]
    v_cndmask_b32 v40, v40, v43, s[56:57]
    v_mul_f32 v36, 0xbacccccd, v36
    v_mul_f32 v40, 0x3acccccd, v40
    v_fma_f32 v40, -v36, v36, v40
    v_max_f32 v40, 0, v40
    v_add_f32 v40, 0x3727c5ac, v40
    v_rsq_f32 v40, v40
    v_cvt_pk_bf16_f32 v37, v36, v36
    v_lshlrev_b32 v38, 16, v37
    v_sub_f32 v38, v36, v38
    v_cvt_pk_bf16_f32 v38, v38, v38
    s_mov_b32 exec_lo, 0x00f0000f
    s_mov_b32 exec_hi, 0xf0000f00
    ds_write_b32 v6, v40
    ds_write_b16 v7, v37 offset:256
    ds_write_b16 v7, v38 offset:384
    s_mov_b64 exec, -1
    s_waitcnt lgkmcnt(0)
    s_barrier
    ds_read_b128 v[48:51], v44 offset:0
    ds_read_b128 v[52:55], v44 offset:16
    ds_read_b128 v[56:59], v44 offset:128
    ds_read_b128 v[60:63], v44 offset:144
    ds_read_b128 v[64:67], v45 offset:256
    ds_read_b128 v[72:75], v45 offset:384
    ds_read_b128 v[68:71], v45 offset:320
    ds_read_b128 v[76:79], v45 offset:448
    s_waitcnt lgkmcnt(6)
    v_pk_mul_f32 v[16:17], v[16:17], v[48:49]
    v_pk_mul_f32 v[18:19], v[18:19], v[50:51]
    v_pk_mul_f32 v[20:21], v[20:21], v[52:53]
    v_pk_mul_f32 v[22:23], v[22:23], v[54:55]
    v_cvt_pk_bf16_f32 v80, v16, v17
    v_cvt_pk_bf16_f32 v81, v18, v19
    v_cvt_pk_bf16_f32 v82, v20, v21
    v_cvt_pk_bf16_f32 v83, v22, v23
    s_waitcnt lgkmcnt(4)
    v_pk_mul_f32 v[24:25], v[24:25], v[56:57]
    v_pk_mul_f32 v[26:27], v[26:27], v[58:59]
    v_pk_mul_f32 v[28:29], v[28:29], v[60:61]
    v_pk_mul_f32 v[30:31], v[30:31], v[62:63]
    v_cvt_pk_bf16_f32 v84, v24, v25
    v_cvt_pk_bf16_f32 v85, v26, v27
    v_cvt_pk_bf16_f32 v86, v28, v29
    v_cvt_pk_bf16_f32 v87, v30, v31
    s_waitcnt lgkmcnt(0)
    v_mfma_f32_16x16x32_bf16 v[88:91], v[80:83], v[64:67], 0
    v_mfma_f32_16x16x32_bf16 v[88:91], v[80:83], v[72:75], v[88:91]
    v_mfma_f32_16x16x32_bf16 v[88:91], v[84:87], v[68:71], v[88:91]
    v_mfma_f32_16x16x32_bf16 v[88:91], v[84:87], v[76:79], v[88:91]
    v_mfma_f32_16x16x32_bf16 v[96:99], v[80:83], a[0:3], v[88:91]
    v_mfma_f32_16x16x32_bf16 v[100:103], v[80:83], a[8:11], v[88:91]
    v_mfma_f32_16x16x32_bf16 v[104:107], v[80:83], a[16:19], v[88:91]
    v_mfma_f32_16x16x32_bf16 v[108:111], v[80:83], a[24:27], v[88:91]
    v_mfma_f32_16x16x32_bf16 v[112:115], v[80:83], a[32:35], v[88:91]
    v_mfma_f32_16x16x32_bf16 v[116:119], v[80:83], a[40:43], v[88:91]
    v_mfma_f32_16x16x32_bf16 v[120:123], v[80:83], a[48:51], v[88:91]
    v_mfma_f32_16x16x32_bf16 v[124:127], v[80:83], a[56:59], v[88:91]
    v_mfma_f32_16x16x32_bf16 v[96:99], v[84:87], a[4:7], v[96:99]
    v_mfma_f32_16x16x32_bf16 v[100:103], v[84:87], a[12:15], v[100:103]
    v_mfma_f32_16x16x32_bf16 v[104:107], v[84:87], a[20:23], v[104:107]
    v_mfma_f32_16x16x32_bf16 v[108:111], v[84:87], a[28:31], v[108:111]
    v_mfma_f32_16x16x32_bf16 v[112:115], v[84:87], a[36:39], v[112:115]
    v_mfma_f32_16x16x32_bf16 v[116:119], v[84:87], a[44:47], v[116:119]
    v_mfma_f32_16x16x32_bf16 v[120:123], v[84:87], a[52:55], v[120:123]
    v_mfma_f32_16x16x32_bf16 v[124:127], v[84:87], a[60:63], v[124:127]
    s_nop 1
    v_cvt_pk_bf16_f32 v48, v96, v100
    v_cvt_pk_bf16_f32 v52, v97, v101
    v_cvt_pk_bf16_f32 v56, v98, v102
    v_cvt_pk_bf16_f32 v60, v99, v103
    v_cvt_pk_bf16_f32 v49, v104, v108
    v_cvt_pk_bf16_f32 v53, v105, v109
    v_cvt_pk_bf16_f32 v57, v106, v110
    v_cvt_pk_bf16_f32 v61, v107, v111
    v_cvt_pk_bf16_f32 v50, v112, v116
    v_cvt_pk_bf16_f32 v54, v113, v117
    v_cvt_pk_bf16_f32 v58, v114, v118
    v_cvt_pk_bf16_f32 v62, v115, v119
    v_cvt_pk_bf16_f32 v51, v120, v124
    v_cvt_pk_bf16_f32 v55, v121, v125
    v_cvt_pk_bf16_f32 v59, v122, v126
    v_cvt_pk_bf16_f32 v63, v123, v127
    buffer_store_dwordx4 v[48:51], v46, s[8:11], s58 offen offset:0 sc1
    buffer_store_dwordx4 v[52:55], v46, s[8:11], s58 offen offset:256 sc1
    buffer_store_dwordx4 v[56:59], v46, s[8:11], s59 offen offset:0 sc1
    buffer_store_dwordx4 v[60:63], v46, s[8:11], s59 offen offset:256 sc1
    v_mov_b32 v255, 0
    buffer_load_dword v255, v255, s[20:23], 0 offen offset:128 sc1
    v_add_u32 v249, 122880, v4
    ds_read_b128 a[64:67], v249 offset:0
    ds_read_b128 a[68:71], v249 offset:1024
    ds_read_b128 a[72:75], v249 offset:2048
    ds_read_b128 a[76:79], v249 offset:3072
    ds_read_b128 a[80:83], v249 offset:4096
    ds_read_b128 a[84:87], v249 offset:5120
    ds_read_b128 a[88:91], v249 offset:6144
    ds_read_b128 a[92:95], v249 offset:7168
    s_nop 0
    s_call_b64 s[62:63], L_pre2b
    s_nop 0
    s_branch L_sig1
L_oth_s:
    s_setpc_b64 s[60:61]
L_oth:
    s_cmp_ge_u32 s2, 256
    s_cbranch_scc1 L_end
    s_load_dwordx2 s[32:33], s[0:1], 56
    s_mov_b32 s34, 1280
    s_mov_b32 s35, 0x20000
    s_load_dwordx2 s[36:37], s[0:1], 64
    s_mov_b32 s38, 4915200
    s_mov_b32 s39, 0x20000
    s_sub_u32 s64, s2, 168
    s_cmp_lt_u32 s64, 20
    s_cbranch_scc1 L_gvi
    s_cmp_lt_u32 s2, 165
    s_cbranch_scc1 L_g32
    s_cmp_ge_u32 s2, 251
    s_cbranch_scc1 L_clr
    s_sub_u32 s6, s2, 240
    s_cmp_ge_u32 s6, 8
    s_cbranch_scc1 L_clr3
    s_getpc_b64 s[44:45]
L_pc:
    s_sub_u32 s44, s44, L_pc-L_b
    s_subb_u32 s45, s45, 0
    v_lshlrev_b32 v6, 7, v0
    v_mov_b32 v7, 0
    v_lshl_add_u64 v[6:7], v[6:7], 0, s[44:45]
    global_load_dword v248, v[6:7], off
    v_cmp_gt_u32 vcc, (L_e-L_b-32768)/128, v0
    s_nop 0
    s_and_saveexec_b64 s[46:47], vcc
    s_cbranch_execz L_cw_2
    s_mov_b32 s44, 32768
    s_mov_b32 s45, 0
    v_lshl_add_u64 v[6:7], v[6:7], 0, s[44:45]
    global_load_dword v249, v[6:7], off
L_cw_2:
    s_mov_b64 exec, -1
    s_branch L_clr3
L_clr:
    s_sub_u32 s44, s2, 251
    s_lshl_b32 s44, s44, 15
    s_add_u32 s44, s44, 22347776
    v_lshlrev_b32 v6, 7, v0
    v_mov_b32 v8, 0
    v_mov_b32 v9, 0
    s_waitcnt lgkmcnt(0)
    buffer_store_dwordx2 v[8:9], v6, s[8:11], s44 offen sc1
    s_waitcnt vmcnt(0)
    s_barrier
    s_cmp_lg_u32 s3, 0
    s_cbranch_scc1 L_clr4
    v_mov_b32 v9, 1
    s_mov_b64 exec, 1
    buffer_atomic_add v9, v8, s[20:23], 0 offen sc0 sc1
    s_waitcnt vmcnt(0)
    v_readfirstlane_b32 s44, v9
    s_nop 0
    s_cmp_lg_u32 s44, 4
    s_cbranch_scc1 L_clr2
    buffer_store_dword v9, v8, s[20:23], 0 offen offset:128 sc1
L_clr2:
    s_mov_b64 exec, -1
L_clr4:
    s_barrier
L_clr3:
    s_sub_u32 s64, s2, 188
    s_cmp_ge_u32 s64, 40
    s_cbranch_scc1 L_bg
    s_cmp_ge_u32 s64, 20
    s_cselect_b32 s6, 0, 30
    s_cmp_ge_u32 s64, 30
    s_cselect_b32 s6, 20, s6
    s_add_u32 s64, s64, s6
L_gvi:
    s_lshl_b32 s64, s64, 6
    v_lshrrev_b32 v8, 3, v0
    v_mul_u32_u24 v5, 40, v8
    s_mov_b32 s48, 153600
    v_mul_lo_u32 v6, v8, s48
    v_and_b32 v7, 7, v0
    v_lshl_add_u32 v6, v7, 4, v6
    s_lshl_b32 s48, s64, 1
    s_waitcnt lgkmcnt(0)
    buffer_load_dwordx4 v[100:103], v5, s[32:35], 0 offen
    buffer_load_dwordx4 v[104:107], v5, s[32:35], 0 offen offset:16
    buffer_load_dwordx2 v[108:109], v5, s[32:35], 0 offen offset:32
    buffer_load_dwordx4 v[152:155], v6, s[36:39], s48 offen nt
    s_add_u32 s48, s48, 7680
    buffer_load_dwordx4 v[156:159], v6, s[36:39], s48 offen nt
    s_add_u32 s48, s48, 7680
    buffer_load_dwordx4 v[160:163], v6, s[36:39], s48 offen nt
    s_add_u32 s48, s48, 7680
    buffer_load_dwordx4 v[164:167], v6, s[36:39], s48 offen nt
    s_add_u32 s48, s48, 7680
    buffer_load_dwordx4 v[168:171], v6, s[36:39], s48 offen nt
    s_add_u32 s48, s48, 7680
    buffer_load_dwordx4 v[172:175], v6, s[36:39], s48 offen nt
    s_add_u32 s48, s48, 7680
    buffer_load_dwordx4 v[176:179], v6, s[36:39], s48 offen nt
    s_add_u32 s48, s48, 7680
    buffer_load_dwordx4 v[180:183], v6, s[36:39], s48 offen nt
    s_add_u32 s48, s48, 7680
    buffer_load_dwordx4 v[184:187], v6, s[36:39], s48 offen nt
    s_add_u32 s48, s48, 7680
    buffer_load_dwordx4 v[188:191], v6, s[36:39], s48 offen nt
    s_add_u32 s48, s48, 7680
    buffer_load_dwordx4 v[192:195], v6, s[36:39], s48 offen nt
    s_add_u32 s48, s48, 7680
    buffer_load_dwordx4 v[196:199], v6, s[36:39], s48 offen nt
    s_add_u32 s48, s48, 7680
    buffer_load_dwordx4 v[200:203], v6, s[36:39], s48 offen nt
    s_add_u32 s48, s48, 7680
    buffer_load_dwordx4 v[204:207], v6, s[36:39], s48 offen nt
    s_add_u32 s48, s48, 7680
    buffer_load_dwordx4 v[208:211], v6, s[36:39], s48 offen nt
    s_add_u32 s48, s48, 7680
    buffer_load_dwordx4 v[212:215], v6, s[36:39], s48 offen nt
    s_add_u32 s48, s48, 7680
    buffer_load_dwordx4 v[216:219], v6, s[36:39], s48 offen nt
    s_add_u32 s48, s48, 7680
    buffer_load_dwordx4 v[220:223], v6, s[36:39], s48 offen nt
    s_add_u32 s48, s48, 7680
    buffer_load_dwordx4 v[224:227], v6, s[36:39], s48 offen nt
    s_add_u32 s48, s48, 7680
    buffer_load_dwordx4 v[228:231], v6, s[36:39], s48 offen nt
    s_cmp_lt_u32 s2, 188
    s_cbranch_scc1 L_a1fin
    s_branch L_bg
L_end:
    s_endpgm
L_pre2_s:
    s_setpc_b64 s[60:61]
L_pre2:
    s_and_b32 s41, s3, 1
    s_cselect_b32 s40, 0, 160
    s_branch L_pg0c
.p2align 12
L_pg0:
    s_setpc_b64 s[60:61]
L_pg0c:
    s_cmp_eq_u32 s3, 3
    s_cselect_b32 s40, 320, s40
    s_lshl_b32 s41, s5, 4
    s_add_u32 s42, s40, s41
    s_sub_u32 s43, s40, s41
    s_sub_u32 s43, s43, 15
    s_cmp_ge_u32 s3, 2
    s_cselect_b32 s42, s43, s42
    s_cselect_b32 s43, 15, 0
    s_lshl_b32 s42, s42, 1
    s_lshl_b32 s44, s3, 3
    s_lshr_b32 s44, 0x1e0a2814, s44
    s_and_b32 s44, s44, 0xff
    s_lshl_b32 s44, s44, 4
    v_lshrrev_b32 v128, 2, v1
    v_lshl_add_u32 v128, v128, 6, s4
    v_add_u32 v129, 1024, v128
    v_sub_u32 v130, 0, v128
    v_sub_u32 v131, 0, v129
    v_and_b32 v130, 2047, v130
    v_and_b32 v131, 2047, v131
    v_and_b32 v132, 3, v1
    v_lshlrev_b32 v132, 4, v132
    v_add_u32 v132, s42, v132
    s_mov_b32 s46, 0x88888888
    s_mov_b32 s47, s46
    v_mov_b32 v133, s44
    v_cndmask_b32 v132, v132, v133, s[46:47]
    s_mov_b32 s45, 642
    v_mad_u32_u24 v128, v128, s45, v132
    v_and_b32 v244, -16, v128
    v_mad_u32_u24 v129, v129, s45, v132
    v_and_b32 v245, -16, v129
    v_mad_u32_u24 v130, v130, s45, v132
    v_and_b32 v246, -16, v130
    v_mad_u32_u24 v131, v131, s45, v132
    v_and_b32 v247, -16, v131
    s_lshl_b32 s45, s3, 13
    s_add_u32 s45, s45, 131072
    s_mov_b32 s69, s45
    s_cmp_eq_u32 s5, 0
    s_cselect_b32 s68, -1, 0x77777777
    v_lshl_add_u32 v133, v3, 7, s45
    v_xor_b32 v132, s43, v2
    v_lshl_add_u32 v132, v132, 1, v133
    s_lshl_b32 s40, s4, 1
    s_add_u32 s41, s42, s40
    s_and_b32 s41, s41, 15
    s_sub_u32 s43, s42, s40
    s_and_b32 s43, s43, 15
    v_add_u32 v240, s41, v132
    v_add_u32 v241, s43, v132
    s_and_b32 s41, s40, 15
    s_add_u32 s41, s41, 48
    s_sub_u32 s43, 0, s40
    s_and_b32 s43, s43, 15
    s_add_u32 s43, s43, 48
    v_add_u32 v242, s41, v133
    v_add_u32 v243, s43, v133
    s_cmp_eq_u32 s5, 0
    s_cselect_b32 s46, 0x00010001, 0
    s_cmp_eq_u32 s3, 1
    s_cselect_b32 s46, 0, s46
    s_mov_b32 s47, s46
    v_cndmask_b32 v240, v240, v242, s[46:47]
    v_cndmask_b32 v241, v241, v243, s[46:47]
    v_cvt_f32_u32 v128, v3
    v_lshrrev_b32 v129, 1, v2
    v_and_b32 v130, 1, v2
    s_lshl_b32 s40, s3, 3
    v_add_u32 v129, s40, v129
    v_lshl_add_u32 v131, v129, 6, s4
    v_cvt_f32_u32 v131, v131
    v_mul_f32 v131, 0x3a000000, v131
    v_cvt_f32_u32 v130, v130
    v_mul_f32 v130, 0x3e800000, v130
    v_add_f32 v128, v128, v128
    v_fma_f32 v132, v131, v128, v130
    s_and_b32 s40, s4, 31
    s_cselect_b32 s40, -1, 0xffff
    s_cselect_b32 s42, -1.0, 0
    s_cmp_eq_u32 s4, 32
    s_cselect_b32 s41, 16, 0
    v_fmamk_f32 v160, v131, 0x00000000, v132
    v_sin_f32 v168, v160
    v_cos_f32 v160, v160
    v_fmamk_f32 v161, v131, 0x3f800000, v132
    v_sin_f32 v169, v161
    v_cos_f32 v161, v161
    v_fmamk_f32 v162, v131, 0x41000000, v132
    v_sin_f32 v170, v162
    v_cos_f32 v162, v162
    v_fmamk_f32 v163, v131, 0x41100000, v132
    v_sin_f32 v171, v163
    v_cos_f32 v163, v163
    v_fmamk_f32 v164, v131, 0x41800000, v132
    v_sin_f32 v172, v164
    v_cos_f32 v164, v164
    v_fmamk_f32 v165, v131, 0x41880000, v132
    v_sin_f32 v173, v165
    v_cos_f32 v165, v165
    v_fmamk_f32 v166, v131, 0x41c00000, v132
    v_sin_f32 v174, v166
    v_cos_f32 v166, v166
    v_fmamk_f32 v167, v131, 0x41c80000, v132
    v_sin_f32 v175, v167
    v_cos_f32 v167, v167
    v_cvt_pk_bf16_f32 v136, v160, v168
    v_cvt_pk_bf16_f32 v137, v161, v169
    v_cvt_pk_bf16_f32 v138, v162, v170
    v_cvt_pk_bf16_f32 v139, v163, v171
    v_cvt_pk_bf16_f32 v140, v164, v172
    v_cvt_pk_bf16_f32 v141, v165, v173
    v_cvt_pk_bf16_f32 v142, v166, v174
    v_cvt_pk_bf16_f32 v143, v167, v175
    v_and_b32 v136, s40, v136
    v_lshlrev_b32 v136, s41, v136
    v_and_b32 v137, s40, v137
    v_lshlrev_b32 v137, s41, v137
    v_and_b32 v138, s40, v138
    v_lshlrev_b32 v138, s41, v138
    v_and_b32 v139, s40, v139
    v_lshlrev_b32 v139, s41, v139
    v_and_b32 v140, s40, v140
    v_lshlrev_b32 v140, s41, v140
    v_and_b32 v141, s40, v141
    v_lshlrev_b32 v141, s41, v141
    v_and_b32 v142, s40, v142
    v_lshlrev_b32 v142, s41, v142
    v_and_b32 v143, s40, v143
    v_lshlrev_b32 v143, s41, v143
    s_lshl_b32 s43, s3, 11
    s_add_u32 s43, s43, 122880
    v_add_u32 v133, s43, v4
    ds_write_b128 v133, v[136:139]
    ds_write_b128 v133, v[140:143] offset:1024
    v_mul_f32 v130, s42, v130
    v_cvt_f32_u32 v131, v129
    v_mul_f32 v131, 0x3a000000, v131
    v_lshl_add_u32 v128, v3, 7, s4
    v_cvt_f32_u32 v132, v128
    v_fma_f32 v132, v131, v132, v130
    v_fmamk_f32 v160, v131, 0x00000000, v132
    v_sin_f32 v168, v160
    v_cos_f32 v160, v160
    v_fmamk_f32 v161, v131, 0x42800000, v132
    v_sin_f32 v169, v161
    v_cos_f32 v161, v161
    v_fmamk_f32 v162, v131, 0x44000000, v132
    v_sin_f32 v170, v162
    v_cos_f32 v162, v162
    v_fmamk_f32 v163, v131, 0x44100000, v132
    v_sin_f32 v171, v163
    v_cos_f32 v163, v163
    v_fmamk_f32 v164, v131, 0x44800000, v132
    v_sin_f32 v172, v164
    v_cos_f32 v164, v164
    v_fmamk_f32 v165, v131, 0x44880000, v132
    v_sin_f32 v173, v165
    v_cos_f32 v165, v165
    v_fmamk_f32 v166, v131, 0x44c00000, v132
    v_sin_f32 v174, v166
    v_cos_f32 v166, v166
    v_fmamk_f32 v167, v131, 0x44c80000, v132
    v_sin_f32 v175, v167
    v_cos_f32 v167, v167
    v_cvt_pk_bf16_f32 v152, v160, -v168
    v_cvt_pk_bf16_f32 v153, v161, -v169
    v_cvt_pk_bf16_f32 v154, v162, -v170
    v_cvt_pk_bf16_f32 v155, v163, -v171
    v_cvt_pk_bf16_f32 v156, v164, -v172
    v_cvt_pk_bf16_f32 v157, v165, -v173
    v_cvt_pk_bf16_f32 v158, v166, -v174
    v_cvt_pk_bf16_f32 v159, v167, -v175
    s_nop 4
    s_setpc_b64 s[62:63]
L_pre2b:
    s_lshl_b32 s40, s5, 4
    v_add_u32 v128, s40, v2
    v_subrev_u32 v129, 40, v128
    v_min_u32 v129, v128, v129
    v_cvt_f32_u32 v129, v129
    v_lshl_add_u32 v130, v3, 2, s3
    v_mul_u32_u24 v130, v130, v128
    v_cvt_f32_u32 v130, v130
    v_mul_f32 v129, 0x3ccccccd, v129
    v_mul_f32 v130, 0x3acccccd, v130
    v_fmamk_f32 v160, v129, 0x00000000, v130
    v_sin_f32 v168, v160
    v_cos_f32 v160, v160
    v_fmamk_f32 v161, v129, 0x3f800000, v130
    v_sin_f32 v169, v161
    v_cos_f32 v161, v161
    v_fmamk_f32 v162, v129, 0x40000000, v130
    v_sin_f32 v170, v162
    v_cos_f32 v162, v162
    v_fmamk_f32 v163, v129, 0x40400000, v130
    v_sin_f32 v171, v163
    v_cos_f32 v163, v163
    v_fmamk_f32 v164, v129, 0x40800000, v130
    v_sin_f32 v172, v164
    v_cos_f32 v164, v164
    v_fmamk_f32 v165, v129, 0x40a00000, v130
    v_sin_f32 v173, v165
    v_cos_f32 v165, v165
    v_fmamk_f32 v166, v129, 0x40c00000, v130
    v_sin_f32 v174, v166
    v_cos_f32 v166, v166
    v_fmamk_f32 v167, v129, 0x40e00000, v130
    v_sin_f32 v175, v167
    v_cos_f32 v167, v167
    v_fmamk_f32 v176, v129, 0x41000000, v130
    v_sin_f32 v184, v176
    v_cos_f32 v176, v176
    v_fmamk_f32 v177, v129, 0x41100000, v130
    v_sin_f32 v185, v177
    v_cos_f32 v177, v177
    v_fmamk_f32 v178, v129, 0x41200000, v130
    v_sin_f32 v186, v178
    v_cos_f32 v178, v178
    v_fmamk_f32 v179, v129, 0x41300000, v130
    v_sin_f32 v187, v179
    v_cos_f32 v179, v179
    v_fmamk_f32 v180, v129, 0x41400000, v130
    v_sin_f32 v188, v180
    v_cos_f32 v180, v180
    v_fmamk_f32 v181, v129, 0x41500000, v130
    v_sin_f32 v189, v181
    v_cos_f32 v181, v181
    v_fmamk_f32 v182, v129, 0x41600000, v130
    v_sin_f32 v190, v182
    v_cos_f32 v182, v182
    v_fmamk_f32 v183, v129, 0x41700000, v130
    v_sin_f32 v191, v183
    v_cos_f32 v183, v183
    v_fmamk_f32 v192, v129, 0x41800000, v130
    v_sin_f32 v200, v192
    v_cos_f32 v192, v192
    v_fmamk_f32 v193, v129, 0x41880000, v130
    v_sin_f32 v201, v193
    v_cos_f32 v193, v193
    v_fmamk_f32 v194, v129, 0x41900000, v130
    v_sin_f32 v202, v194
    v_cos_f32 v194, v194
    v_fmamk_f32 v195, v129, 0x41980000, v130
    v_sin_f32 v203, v195
    v_cos_f32 v195, v195
    v_fmamk_f32 v196, v129, 0x41a00000, v130
    v_sin_f32 v204, v196
    v_cos_f32 v196, v196
    v_fmamk_f32 v197, v129, 0x41a80000, v130
    v_sin_f32 v205, v197
    v_cos_f32 v197, v197
    v_fmamk_f32 v198, v129, 0x41b00000, v130
    v_sin_f32 v206, v198
    v_cos_f32 v198, v198
    v_fmamk_f32 v199, v129, 0x41b80000, v130
    v_sin_f32 v207, v199
    v_cos_f32 v199, v199
    v_fmamk_f32 v208, v129, 0x41c00000, v130
    v_sin_f32 v216, v208
    v_cos_f32 v208, v208
    v_fmamk_f32 v209, v129, 0x41c80000, v130
    v_sin_f32 v217, v209
    v_cos_f32 v209, v209
    v_fmamk_f32 v210, v129, 0x41d00000, v130
    v_sin_f32 v218, v210
    v_cos_f32 v210, v210
    v_fmamk_f32 v211, v129, 0x41d80000, v130
    v_sin_f32 v219, v211
    v_cos_f32 v211, v211
    v_fmamk_f32 v212, v129, 0x41e00000, v130
    v_sin_f32 v220, v212
    v_cos_f32 v212, v212
    v_fmamk_f32 v213, v129, 0x41e80000, v130
    v_sin_f32 v221, v213
    v_cos_f32 v213, v213
    v_fmamk_f32 v214, v129, 0x41f00000, v130
    v_sin_f32 v222, v214
    v_cos_f32 v214, v214
    v_fmamk_f32 v215, v129, 0x41f80000, v130
    v_sin_f32 v223, v215
    v_cos_f32 v215, v215
    v_fmamk_f32 v224, v129, 0x42000000, v130
    v_sin_f32 v232, v224
    v_cos_f32 v224, v224
    v_fmamk_f32 v225, v129, 0x42040000, v130
    v_sin_f32 v233, v225
    v_cos_f32 v225, v225
    v_fmamk_f32 v226, v129, 0x42080000, v130
    v_sin_f32 v234, v226
    v_cos_f32 v226, v226
    v_fmamk_f32 v227, v129, 0x420c0000, v130
    v_sin_f32 v235, v227
    v_cos_f32 v227, v227
    v_fmamk_f32 v228, v129, 0x42100000, v130
    v_sin_f32 v236, v228
    v_cos_f32 v228, v228
    v_fmamk_f32 v229, v129, 0x42140000, v130
    v_sin_f32 v237, v229
    v_cos_f32 v229, v229
    v_fmamk_f32 v230, v129, 0x42180000, v130
    v_sin_f32 v238, v230
    v_cos_f32 v230, v230
    v_fmamk_f32 v231, v129, 0x421c0000, v130
    v_sin_f32 v239, v231
    v_cos_f32 v231, v231
    s_cmp_lg_u32 s5, 0
    s_cbranch_scc1 L_pre2e
    s_and_b32 s40, s3, 1
    s_cselect_b32 s40, 0x3f3504f3, 1.0
    v_lshlrev_b32 v128, 31, v3
    v_or_b32 v128, s40, v128
    s_mov_b32 exec_lo, 0x00010001
    s_mov_b32 exec_hi, 0x00010001
    v_mov_b32 v168, v128
    v_mov_b32 v169, v128
    v_mov_b32 v170, v128
    v_mov_b32 v171, v128
    v_mov_b32 v172, v128
    v_mov_b32 v173, v128
    v_mov_b32 v174, v128
    v_mov_b32 v175, v128
    v_mov_b32 v184, v128
    v_mov_b32 v185, v128
    v_mov_b32 v186, v128
    v_mov_b32 v187, v128
    v_mov_b32 v188, v128
    v_mov_b32 v189, v128
    v_mov_b32 v190, v128
    v_mov_b32 v191, v128
    v_mov_b32 v200, v128
    v_mov_b32 v201, v128
    v_mov_b32 v202, v128
    v_mov_b32 v203, v128
    v_mov_b32 v204, v128
    v_mov_b32 v205, v128
    v_mov_b32 v206, v128
    v_mov_b32 v207, v128
    v_mov_b32 v216, v128
    v_mov_b32 v217, v128
    v_mov_b32 v218, v128
    v_mov_b32 v219, v128
    v_mov_b32 v220, v128
    v_mov_b32 v221, v128
    v_mov_b32 v222, v128
    v_mov_b32 v223, v128
    v_mov_b32 v232, v128
    v_mov_b32 v233, v128
    v_mov_b32 v234, v128
    v_mov_b32 v235, v128
    v_mov_b32 v236, v128
    v_mov_b32 v237, v128
    v_mov_b32 v238, v128
    v_mov_b32 v239, v128
    s_mov_b64 exec, -1
L_pre2e:
    s_nop 3
    s_setpc_b64 s[62:63]
L_sig1_s:
    s_setpc_b64 s[60:61]
L_sig1:
    s_waitcnt vmcnt(0) lgkmcnt(0)
    s_barrier
    s_cmp_lg_u32 s3, 0
    s_cbranch_scc1 L_sg1
    v_readfirstlane_b32 s53, v255
    s_nop 0
    s_cmp_lg_u32 s53, 0
    s_cbranch_scc1 L_rc2
    s_mov_b32 s52, 20000
L_rw3:
    s_sleep 4
    v_mov_b32 v255, 0
    buffer_load_dword v255, v255, s[20:23], 0 offen offset:128 sc1
    s_waitcnt vmcnt(0)
    v_readfirstlane_b32 s53, v255
    s_sub_u32 s52, s52, 1
    s_cselect_b32 s53, 1, s53
    s_cmp_eq_u32 s53, 0
    s_cbranch_scc1 L_rw3
L_rc2:
    v_lshlrev_b32 v6, 10, v1
    s_bfe_u32 s52, s2, 0x30003
    s_lshl_b32 s52, s52, 7
    s_add_u32 s52, s52, 22429696
    s_mov_b64 exec, 0xff
    v_mov_b32 v7, 1
    buffer_atomic_add v7, v6, s[8:11], s52 offen sc1
    s_mov_b64 exec, -1
L_sg1:
L_p2:
    v_accvgpr_write_b32 a56, v152
    v_accvgpr_write_b32 a57, v153
    v_accvgpr_write_b32 a58, v154
    v_accvgpr_write_b32 a59, v155
    v_accvgpr_write_b32 a60, v156
    v_accvgpr_write_b32 a61, v157
    v_accvgpr_write_b32 a62, v158
    v_accvgpr_write_b32 a63, v159
    v_readfirstlane_b32 s53, v255
    s_nop 0
    s_cmp_lg_u32 s53, 0
    s_cbranch_scc1 L_rc4
    s_mov_b32 s52, 20000
L_rw5:
    s_sleep 4
    v_mov_b32 v255, 0
    buffer_load_dword v255, v255, s[20:23], 0 offen offset:128 sc1
    s_waitcnt vmcnt(0)
    v_readfirstlane_b32 s53, v255
    s_sub_u32 s52, s52, 1
    s_cselect_b32 s53, 1, s53
    s_cmp_eq_u32 s53, 0
    s_cbranch_scc1 L_rw5
L_rc4:
    s_and_b32 s53, s2, 31
    s_lshl_b32 s53, s53, 7
    s_add_u32 s53, s53, 22446080
    v_mov_b32 v9, 0
    s_mov_b64 exec, 1
    buffer_atomic_add v9, v9, s[8:11], s53 offen sc0 sc1
    s_mov_b64 exec, -1
    s_mul_i32 s41, s3, 10240
    s_add_u32 s41, s41, 81920
    s_lshl_b32 s45, s3, 6
    s_add_u32 s45, s45, 21924352
    v_lshrrev_b32 v26, 2, v1
    v_lshlrev_b32 v26, 8, v26
    v_and_b32 v27, 3, v1
    v_lshl_add_u32 v26, v27, 4, v26
    s_and_b32 s6, s4, 31
    s_cselect_b32 s50, 1.0, 0.5
    s_mov_b32 s51, s50
    v_xor_b32 v5, v2, v3
    v_lshlrev_b32 v24, 8, v3
    v_xor_b32 v25, 0, v5
    v_lshl_add_u32 v10, v25, 4, v24
    v_xor_b32 v25, 12, v5
    v_lshl_add_u32 v11, v25, 4, v24
    v_xor_b32 v25, 8, v5
    v_lshl_add_u32 v12, v25, 4, v24
    v_xor_b32 v25, 4, v5
    v_lshl_add_u32 v13, v25, 4, v24
    v_lshrrev_b32 v5, 2, v2
    v_sub_u32 v5, 0, v5
    v_xor_b32 v5, v5, v3
    v_and_b32 v5, 3, v5
    v_and_b32 v24, 3, v2
    v_lshl_add_u32 v5, v5, 2, v24
    s_lshl_b32 s40, s3, 12
    v_lshlrev_b32 v14, 8, v2
    v_lshl_add_u32 v14, v5, 4, v14
    v_add_u32 v14, s40, v14
    v_xor_b32 v15, 16, v14
    v_xor_b32 v16, 32, v14
    v_xor_b32 v17, 48, v14
    v_add_u32 v19, 81920, v4
    s_mul_i32 s48, s3, 10240
    v_add_u32 v18, s48, v19
    v_lshl_add_u32 v22, v3, 4, s41
    v_lshlrev_b32 v23, 3, v1
    v_add_u32 v20, s40, v23
    s_lshl_b32 s48, s3, 14
    v_add_u32 v23, s48, v23
    v_add_u32 v21, s40, v4
    v_add_u32 v21, 65536, v21
    s_mul_i32 s44, s6, 82432
    s_add_u32 s44, s44, s40
    s_mov_b32 s48, 82048
    v_lshrrev_b32 v5, 1, v2
    v_mul_lo_u32 v5, v5, s48
    v_and_b32 v24, 1, v2
    v_lshl_add_u32 v5, v24, 6, v5
    v_lshl_add_u32 v5, v3, 4, v5
    s_mul_i32 s48, s3, 656384
    s_lshl_b32 s49, s5, 12
    s_add_u32 s48, s48, s49
    s_lshl_b32 s49, s6, 7
    s_add_u32 s48, s48, s49
    s_add_u32 s48, s48, 2686976
    s_mov_b32 s49, -1
    s_cmp_eq_u32 s4, 0
    s_cselect_b32 s49, 0x55555555, s49
    s_cmp_eq_u32 s4, 32
    s_cselect_b32 s49, 0xaaaaaaaa, s49
    v_mov_b32 v64, 0
    v_mov_b32 v65, 0
    v_mov_b32 v66, 0
    v_mov_b32 v67, 0
    v_mov_b32 v68, 0
    v_mov_b32 v69, 0
    v_mov_b32 v70, 0
    v_mov_b32 v71, 0
    v_mov_b32 v72, 0
    v_mov_b32 v73, 0
    v_mov_b32 v74, 0
    v_mov_b32 v75, 0
    v_mov_b32 v76, 0
    v_mov_b32 v77, 0
    v_mov_b32 v78, 0
    v_mov_b32 v79, 0
    v_mov_b32 v80, 0
    v_mov_b32 v81, 0
    v_mov_b32 v82, 0
    v_mov_b32 v83, 0
    v_mov_b32 v84, 0
    v_mov_b32 v85, 0
    v_mov_b32 v86, 0
    v_mov_b32 v87, 0
    v_mov_b32 v88, 0
    v_mov_b32 v89, 0
    v_mov_b32 v90, 0
    v_mov_b32 v91, 0
    v_mov_b32 v92, 0
    v_mov_b32 v93, 0
    v_mov_b32 v94, 0
    v_mov_b32 v95, 0
    v_mov_b32 v128, 0
    v_mov_b32 v129, 0
    v_mov_b32 v130, 0
    v_mov_b32 v131, 0
    v_mov_b32 v132, 0
    v_mov_b32 v133, 0
    v_mov_b32 v134, 0
    v_mov_b32 v135, 0
    v_mov_b32 v136, 0
    v_mov_b32 v137, 0
    v_mov_b32 v138, 0
    v_mov_b32 v139, 0
    v_mov_b32 v140, 0
    v_mov_b32 v141, 0
    v_mov_b32 v142, 0
    v_mov_b32 v143, 0
    v_mov_b32 v144, 0
    v_mov_b32 v145, 0
    v_mov_b32 v146, 0
    v_mov_b32 v147, 0
    v_mov_b32 v148, 0
    v_mov_b32 v149, 0
    v_mov_b32 v150, 0
    v_mov_b32 v151, 0
    v_mov_b32 v152, 0
    v_mov_b32 v153, 0
    v_mov_b32 v154, 0
    v_mov_b32 v155, 0
    v_mov_b32 v156, 0
    v_mov_b32 v157, 0
    v_mov_b32 v158, 0
    v_mov_b32 v159, 0
    s_cmp_lg_u32 s3, 0
    s_cbranch_scc1 L_tc1188_0
    s_call_b64 s[60:61], L_pg3
    s_call_b64 s[60:61], L_pg7
L_tc1188_0:
    s_cmp_lg_u32 s3, 1
    s_cbranch_scc1 L_tc1188_1
    s_call_b64 s[60:61], L_pg4
L_tc1188_1:
    s_cmp_lg_u32 s3, 2
    s_cbranch_scc1 L_tc1188_2
    s_call_b64 s[60:61], L_pg5
L_tc1188_2:
    s_cmp_lg_u32 s3, 3
    s_cbranch_scc1 L_tc1188_3
    s_call_b64 s[60:61], L_pg6
L_tc1188_3:
    s_waitcnt vmcnt(0)
    s_mov_b32 s56, 20000
    s_branch L_cc6c
L_cc6:
    s_sleep 2
    s_and_b32 s53, s2, 31
    s_lshl_b32 s53, s53, 7
    s_add_u32 s53, s53, 22446080
    v_mov_b32 v9, 0
    s_mov_b64 exec, 1
    buffer_atomic_add v9, v9, s[8:11], s53 offen sc0 sc1
    s_mov_b64 exec, -1
    s_waitcnt vmcnt(0)
L_cc6c:
    v_readfirstlane_b32 s54, v9
    s_sub_u32 s56, s56, 1
    s_cselect_b32 s54, 20, s54
    s_cmp_lt_u32 s54, 20
    s_cbranch_scc1 L_cc6
    s_mov_b32 m0, s41
    s_mov_b32 exec_hi, 0xff
    buffer_load_dwordx4 v26, s[8:11], s45 offen sc1 lds
    s_add_u32 m0, m0, 640
    s_sub_u32 s45, s45, 2560
    buffer_load_dwordx4 v26, s[8:11], s45 offen sc1 lds
    s_mov_b64 exec, -1
    ds_read_u16_d16_hi v128, v240 offset:0
    ds_read_u16_d16_hi v129, v240 offset:1024
    ds_read_u16_d16_hi v130, v241 offset:4096
    ds_read_u16_d16_hi v131, v241 offset:5120
    ds_read_u16_d16_hi v132, v240 offset:64
    ds_read_u16_d16_hi v133, v240 offset:1088
    ds_read_u16_d16_hi v134, v241 offset:4160
    ds_read_u16_d16_hi v135, v241 offset:5184
    ds_read_u16_d16_hi v136, v240 offset:512
    ds_read_u16_d16_hi v137, v240 offset:1536
    ds_read_u16_d16_hi v138, v241 offset:4608
    ds_read_u16_d16_hi v139, v241 offset:5632
    ds_read_u16_d16_hi v140, v240 offset:576
    ds_read_u16_d16_hi v141, v240 offset:1600
    ds_read_u16_d16_hi v142, v241 offset:4672
    ds_read_u16_d16_hi v143, v241 offset:5696
    ds_read_u16_d16_hi v144, v240 offset:2048
    ds_read_u16_d16_hi v145, v240 offset:3072
    ds_read_u16_d16_hi v146, v241 offset:6144
    ds_read_u16_d16_hi v147, v241 offset:7168
    ds_read_u16_d16_hi v148, v240 offset:2112
    ds_read_u16_d16_hi v149, v240 offset:3136
    ds_read_u16_d16_hi v150, v241 offset:6208
    ds_read_u16_d16_hi v151, v241 offset:7232
    ds_read_u16_d16_hi v152, v240 offset:2560
    ds_read_u16_d16_hi v153, v240 offset:3584
    ds_read_u16_d16_hi v154, v241 offset:6656
    ds_read_u16_d16_hi v155, v241 offset:7680
    ds_read_u16_d16_hi v156, v240 offset:2624
    ds_read_u16_d16_hi v157, v240 offset:3648
    ds_read_u16_d16_hi v158, v241 offset:6720
    ds_read_u16_d16_hi v159, v241 offset:7744
    s_waitcnt lgkmcnt(0)
    v_pk_add_f32 v[96:97], v[128:129], v[130:131] neg_hi:[0,1]
    v_pk_mul_f32 v[96:97], v[96:97], s[50:51]
    v_pk_add_f32 v[98:99], v[128:129], v[130:131] neg_lo:[0,1]
    v_pk_mul_f32 v[98:99], v[98:99], s[50:51]
    v_pk_add_f32 v[100:101], v[132:133], v[134:135] neg_hi:[0,1]
    v_pk_mul_f32 v[100:101], v[100:101], s[50:51]
    v_pk_add_f32 v[102:103], v[132:133], v[134:135] neg_lo:[0,1]
    v_pk_mul_f32 v[102:103], v[102:103], s[50:51]
    v_pk_add_f32 v[104:105], v[136:137], v[138:139] neg_hi:[0,1]
    v_pk_mul_f32 v[104:105], v[104:105], s[50:51]
    v_pk_add_f32 v[106:107], v[136:137], v[138:139] neg_lo:[0,1]
    v_pk_mul_f32 v[106:107], v[106:107], s[50:51]
    v_pk_add_f32 v[108:109], v[140:141], v[142:143] neg_hi:[0,1]
    v_pk_mul_f32 v[108:109], v[108:109], s[50:51]
    v_pk_add_f32 v[110:111], v[140:141], v[142:143] neg_lo:[0,1]
    v_pk_mul_f32 v[110:111], v[110:111], s[50:51]
    v_pk_add_f32 v[112:113], v[144:145], v[146:147] neg_hi:[0,1]
    v_pk_mul_f32 v[112:113], v[112:113], s[50:51]
    v_pk_add_f32 v[114:115], v[144:145], v[146:147] neg_lo:[0,1]
    v_pk_mul_f32 v[114:115], v[114:115], s[50:51]
    v_pk_add_f32 v[116:117], v[148:149], v[150:151] neg_hi:[0,1]
    v_pk_mul_f32 v[116:117], v[116:117], s[50:51]
    v_pk_add_f32 v[118:119], v[148:149], v[150:151] neg_lo:[0,1]
    v_pk_mul_f32 v[118:119], v[118:119], s[50:51]
    v_pk_add_f32 v[120:121], v[152:153], v[154:155] neg_hi:[0,1]
    v_pk_mul_f32 v[120:121], v[120:121], s[50:51]
    v_pk_add_f32 v[122:123], v[152:153], v[154:155] neg_lo:[0,1]
    v_pk_mul_f32 v[122:123], v[122:123], s[50:51]
    v_pk_add_f32 v[124:125], v[156:157], v[158:159] neg_hi:[0,1]
    v_pk_mul_f32 v[124:125], v[124:125], s[50:51]
    v_pk_add_f32 v[126:127], v[156:157], v[158:159] neg_lo:[0,1]
    v_pk_mul_f32 v[126:127], v[126:127], s[50:51]
    s_lshl_b32 s57, s5, 2
    s_add_u32 s57, s57, s3
    s_cmp_lg_u32 s57, 1
    s_cbranch_scc1 L_p2_nsp
    ds_read_u16_d16_hi v128, v242 offset:0
    ds_read_u16_d16_hi v129, v242 offset:1024
    ds_read_u16_d16_hi v130, v243 offset:4096
    ds_read_u16_d16_hi v131, v243 offset:5120
    ds_read_u16_d16_hi v132, v242 offset:64
    ds_read_u16_d16_hi v133, v242 offset:1088
    ds_read_u16_d16_hi v134, v243 offset:4160
    ds_read_u16_d16_hi v135, v243 offset:5184
    ds_read_u16_d16_hi v136, v242 offset:512
    ds_read_u16_d16_hi v137, v242 offset:1536
    ds_read_u16_d16_hi v138, v243 offset:4608
    ds_read_u16_d16_hi v139, v243 offset:5632
    ds_read_u16_d16_hi v140, v242 offset:576
    ds_read_u16_d16_hi v141, v242 offset:1600
    ds_read_u16_d16_hi v142, v243 offset:4672
    ds_read_u16_d16_hi v143, v243 offset:5696
    ds_read_u16_d16_hi v144, v242 offset:2048
    ds_read_u16_d16_hi v145, v242 offset:3072
    ds_read_u16_d16_hi v146, v243 offset:6144
    ds_read_u16_d16_hi v147, v243 offset:7168
    ds_read_u16_d16_hi v148, v242 offset:2112
    ds_read_u16_d16_hi v149, v242 offset:3136
    ds_read_u16_d16_hi v150, v243 offset:6208
    ds_read_u16_d16_hi v151, v243 offset:7232
    ds_read_u16_d16_hi v152, v242 offset:2560
    ds_read_u16_d16_hi v153, v242 offset:3584
    ds_read_u16_d16_hi v154, v243 offset:6656
    ds_read_u16_d16_hi v155, v243 offset:7680
    ds_read_u16_d16_hi v156, v242 offset:2624
    ds_read_u16_d16_hi v157, v242 offset:3648
    ds_read_u16_d16_hi v158, v243 offset:6720
    ds_read_u16_d16_hi v159, v243 offset:7744
    s_waitcnt lgkmcnt(0)
    v_pk_add_f32 v[128:129], v[128:129], v[130:131] neg_hi:[0,1]
    v_pk_mul_f32 v[128:129], v[128:129], s[50:51]
    v_pk_add_f32 v[132:133], v[132:133], v[134:135] neg_hi:[0,1]
    v_pk_mul_f32 v[132:133], v[132:133], s[50:51]
    v_pk_add_f32 v[136:137], v[136:137], v[138:139] neg_hi:[0,1]
    v_pk_mul_f32 v[136:137], v[136:137], s[50:51]
    v_pk_add_f32 v[140:141], v[140:141], v[142:143] neg_hi:[0,1]
    v_pk_mul_f32 v[140:141], v[140:141], s[50:51]
    v_pk_add_f32 v[144:145], v[144:145], v[146:147] neg_hi:[0,1]
    v_pk_mul_f32 v[144:145], v[144:145], s[50:51]
    v_pk_add_f32 v[148:149], v[148:149], v[150:151] neg_hi:[0,1]
    v_pk_mul_f32 v[148:149], v[148:149], s[50:51]
    v_pk_add_f32 v[152:153], v[152:153], v[154:155] neg_hi:[0,1]
    v_pk_mul_f32 v[152:153], v[152:153], s[50:51]
    v_pk_add_f32 v[156:157], v[156:157], v[158:159] neg_hi:[0,1]
    v_pk_mul_f32 v[156:157], v[156:157], s[50:51]
    s_mov_b32 exec_lo, 0x00010001
    s_mov_b32 exec_hi, 0x00010001
    v_mul_f32 v96, 0.5, v96
    v_mul_f32 v97, 0.5, v97
    v_mov_b32 v98, 0
    v_mov_b32 v99, 0
    v_mul_f32 v240, 0.5, v128
    v_mul_f32 v241, 0.5, v129
    v_mul_f32 v100, 0.5, v100
    v_mul_f32 v101, 0.5, v101
    v_mov_b32 v102, 0
    v_mov_b32 v103, 0
    v_mul_f32 v242, 0.5, v132
    v_mul_f32 v243, 0.5, v133
    v_mul_f32 v104, 0.5, v104
    v_mul_f32 v105, 0.5, v105
    v_mov_b32 v106, 0
    v_mov_b32 v107, 0
    v_mul_f32 v244, 0.5, v136
    v_mul_f32 v245, 0.5, v137
    v_mul_f32 v108, 0.5, v108
    v_mul_f32 v109, 0.5, v109
    v_mov_b32 v110, 0
    v_mov_b32 v111, 0
    v_mul_f32 v246, 0.5, v140
    v_mul_f32 v247, 0.5, v141
    v_mul_f32 v112, 0.5, v112
    v_mul_f32 v113, 0.5, v113
    v_mov_b32 v114, 0
    v_mov_b32 v115, 0
    v_mul_f32 v248, 0.5, v144
    v_mul_f32 v249, 0.5, v145
    v_mul_f32 v116, 0.5, v116
    v_mul_f32 v117, 0.5, v117
    v_mov_b32 v118, 0
    v_mov_b32 v119, 0
    v_mul_f32 v250, 0.5, v148
    v_mul_f32 v251, 0.5, v149
    v_mul_f32 v120, 0.5, v120
    v_mul_f32 v121, 0.5, v121
    v_mov_b32 v122, 0
    v_mov_b32 v123, 0
    v_mul_f32 v252, 0.5, v152
    v_mul_f32 v253, 0.5, v153
    v_mul_f32 v124, 0.5, v124
    v_mul_f32 v125, 0.5, v125
    v_mov_b32 v126, 0
    v_mov_b32 v127, 0
    v_mul_f32 v254, 0.5, v156
    v_mul_f32 v255, 0.5, v157
    s_mov_b32 exec_lo, 0xfffefffe
    s_mov_b32 exec_hi, 0xfffefffe
L_p2_nsp:
    s_branch L_pg1c
.p2align 12
L_pg1:
    s_setpc_b64 s[60:61]
L_pg1c:
    v_mov_b32 v240, v96
    v_mov_b32 v241, v97
    v_mov_b32 v242, v100
    v_mov_b32 v243, v101
    v_mov_b32 v244, v104
    v_mov_b32 v245, v105
    v_mov_b32 v246, v108
    v_mov_b32 v247, v109
    v_mov_b32 v248, v112
    v_mov_b32 v249, v113
    v_mov_b32 v250, v116
    v_mov_b32 v251, v117
    v_mov_b32 v252, v120
    v_mov_b32 v253, v121
    v_mov_b32 v254, v124
    v_mov_b32 v255, v125
    s_mov_b64 exec, -1
    s_waitcnt vmcnt(0)
    ds_read_b128 v[24:27], v22 offset:0
    ds_read_b128 v[28:31], v22 offset:64
    ds_read_b128 v[32:35], v22 offset:128
    ds_read_b128 v[36:39], v22 offset:192
    ds_read_b128 v[40:43], v22 offset:256
    ds_read_b128 v[44:47], v22 offset:320
    ds_read_b128 v[48:51], v22 offset:384
    ds_read_b128 v[52:55], v22 offset:448
    ds_read_b128 v[56:59], v22 offset:512
    ds_read_b128 v[60:63], v22 offset:576
    s_cmp_lg_u32 s4, 0
    s_cbranch_scc1 L_p2_nosa
    ds_read_b128 v[128:131], v22 offset:640
    ds_read_b128 v[132:135], v22 offset:704
    ds_read_b128 v[136:139], v22 offset:768
    ds_read_b128 v[140:143], v22 offset:832
    ds_read_b128 v[144:147], v22 offset:896
    ds_read_b128 v[148:151], v22 offset:960
    ds_read_b128 v[152:155], v22 offset:1024
    ds_read_b128 v[156:159], v22 offset:1088
    ds_read_b128 v[64:67], v22 offset:1152
    ds_read_b128 v[68:71], v22 offset:1216
    v_mov_b32 v6, 0
    v_mov_b32 v7, 0
    s_waitcnt lgkmcnt(0)
    v_fmac_f32 v6, v128, v160
    v_fmac_f32 v7, v128, v168
    v_fmac_f32 v6, v129, v161
    v_fmac_f32 v7, v129, v169
    v_fmac_f32 v6, v130, v162
    v_fmac_f32 v7, v130, v170
    v_fmac_f32 v6, v131, v163
    v_fmac_f32 v7, v131, v171
    v_fmac_f32 v6, v132, v164
    v_fmac_f32 v7, v132, v172
    v_fmac_f32 v6, v133, v165
    v_fmac_f32 v7, v133, v173
    v_fmac_f32 v6, v134, v166
    v_fmac_f32 v7, v134, v174
    v_fmac_f32 v6, v135, v167
    v_fmac_f32 v7, v135, v175
    v_fmac_f32 v6, v136, v176
    v_fmac_f32 v7, v136, v184
    v_fmac_f32 v6, v137, v177
    v_fmac_f32 v7, v137, v185
    v_fmac_f32 v6, v138, v178
    v_fmac_f32 v7, v138, v186
    v_fmac_f32 v6, v139, v179
    v_fmac_f32 v7, v139, v187
    v_fmac_f32 v6, v140, v180
    v_fmac_f32 v7, v140, v188
    v_fmac_f32 v6, v141, v181
    v_fmac_f32 v7, v141, v189
    v_fmac_f32 v6, v142, v182
    v_fmac_f32 v7, v142, v190
    v_fmac_f32 v6, v143, v183
    v_fmac_f32 v7, v143, v191
    v_fmac_f32 v6, v144, v192
    v_fmac_f32 v7, v144, v200
    v_fmac_f32 v6, v145, v193
    v_fmac_f32 v7, v145, v201
    v_fmac_f32 v6, v146, v194
    v_fmac_f32 v7, v146, v202
    v_fmac_f32 v6, v147, v195
    v_fmac_f32 v7, v147, v203
    v_fmac_f32 v6, v148, v196
    v_fmac_f32 v7, v148, v204
    v_fmac_f32 v6, v149, v197
    v_fmac_f32 v7, v149, v205
    v_fmac_f32 v6, v150, v198
    v_fmac_f32 v7, v150, v206
    v_fmac_f32 v6, v151, v199
    v_fmac_f32 v7, v151, v207
    v_fmac_f32 v6, v152, v208
    v_fmac_f32 v7, v152, v216
    v_fmac_f32 v6, v153, v209
    v_fmac_f32 v7, v153, v217
    v_fmac_f32 v6, v154, v210
    v_fmac_f32 v7, v154, v218
    v_fmac_f32 v6, v155, v211
    v_fmac_f32 v7, v155, v219
    v_fmac_f32 v6, v156, v212
    v_fmac_f32 v7, v156, v220
    v_fmac_f32 v6, v157, v213
    v_fmac_f32 v7, v157, v221
    v_fmac_f32 v6, v158, v214
    v_fmac_f32 v7, v158, v222
    v_fmac_f32 v6, v159, v215
    v_fmac_f32 v7, v159, v223
    v_fmac_f32 v6, v64, v224
    v_fmac_f32 v7, v64, v232
    v_fmac_f32 v6, v65, v225
    v_fmac_f32 v7, v65, v233
    v_fmac_f32 v6, v66, v226
    v_fmac_f32 v7, v66, v234
    v_fmac_f32 v6, v67, v227
    v_fmac_f32 v7, v67, v235
    v_fmac_f32 v6, v68, v228
    v_fmac_f32 v7, v68, v236
    v_fmac_f32 v6, v69, v229
    v_fmac_f32 v7, v69, v237
    v_fmac_f32 v6, v70, v230
    v_fmac_f32 v7, v70, v238
    v_fmac_f32 v6, v71, v231
    v_fmac_f32 v7, v71, v239
    v_mov_b32 v8, v6
    v_mov_b32 v9, v7
    s_nop 0
    v_permlane32_swap_b32 v6, v8
    v_permlane32_swap_b32 v7, v9
    v_add_f32 v6, v6, v8
    v_add_f32 v7, v7, v9
    v_mov_b32 v8, v6
    v_mov_b32 v9, v7
    s_nop 0
    v_permlane16_swap_b32 v6, v8
    v_permlane16_swap_b32 v7, v9
    v_add_f32 v6, v6, v8
    v_add_f32 v7, v7, v9
    v_mul_f32 v6, 0x42800000, v6
    v_mul_f32 v7, 0x42800000, v7
    s_lshl_b32 s57, s3, 7
    s_add_u32 s57, s57, 122880
    v_lshl_add_u32 v8, v2, 2, s57
    ds_write_b32 v8, v6
    ds_write_b32 v8, v7 offset:64
    v_mov_b32 v65, 0
    v_mov_b32 v67, 0
    v_mov_b32 v69, 0
    v_mov_b32 v71, 0
    s_nop 4
L_p2_nosa:
    s_nop 0
    v_lshlrev_b32 v6, 7, v1
    s_cmp_lg_u32 s3, 0
    s_cbranch_scc1 L_gi7
    v_mov_b32 v8, 24
    v_writelane_b32 v8, 16, 4
    v_writelane_b32 v8, 16, 5
    v_writelane_b32 v8, 16, 6
    v_writelane_b32 v8, 16, 7
    s_and_b32 s66, s2, 7
    s_lshl_b32 s66, s66, 10
    s_add_u32 s66, s66, 22429696
    s_mov_b64 exec, 0xff
    v_mov_b32 v7, 0
    buffer_atomic_add v7, v6, s[8:11], s66 offen sc0 sc1
    s_mov_b64 exec, -1
L_gi7:
    s_waitcnt lgkmcnt(0)
    v_pk_mul_f32 v[160:161], v[160:161], v[24:25]
    v_pk_mul_f32 v[162:163], v[162:163], v[26:27]
    v_pk_mul_f32 v[164:165], v[164:165], v[28:29]
    v_pk_mul_f32 v[166:167], v[166:167], v[30:31]
    v_cvt_pk_bf16_f32 v160, v160, v161
    v_cvt_pk_bf16_f32 v161, v162, v163
    v_cvt_pk_bf16_f32 v162, v164, v165
    v_cvt_pk_bf16_f32 v163, v166, v167
    ds_write_b128 v18, v[160:163] offset:0
    v_pk_mul_f32 v[168:169], v[168:169], v[24:25]
    v_pk_mul_f32 v[170:171], v[170:171], v[26:27]
    v_pk_mul_f32 v[172:173], v[172:173], v[28:29]
    v_pk_mul_f32 v[174:175], v[174:175], v[30:31]
    v_cvt_pk_bf16_f32 v168, v168, v169
    v_cvt_pk_bf16_f32 v169, v170, v171
    v_cvt_pk_bf16_f32 v170, v172, v173
    v_cvt_pk_bf16_f32 v171, v174, v175
    ds_write_b128 v18, v[168:171] offset:1024
    v_pk_mul_f32 v[176:177], v[176:177], v[32:33]
    v_pk_mul_f32 v[178:179], v[178:179], v[34:35]
    v_pk_mul_f32 v[180:181], v[180:181], v[36:37]
    v_pk_mul_f32 v[182:183], v[182:183], v[38:39]
    v_cvt_pk_bf16_f32 v176, v176, v177
    v_cvt_pk_bf16_f32 v177, v178, v179
    v_cvt_pk_bf16_f32 v178, v180, v181
    v_cvt_pk_bf16_f32 v179, v182, v183
    ds_write_b128 v18, v[176:179] offset:2048
    v_pk_mul_f32 v[184:185], v[184:185], v[32:33]
    v_pk_mul_f32 v[186:187], v[186:187], v[34:35]
    v_pk_mul_f32 v[188:189], v[188:189], v[36:37]
    v_pk_mul_f32 v[190:191], v[190:191], v[38:39]
    v_cvt_pk_bf16_f32 v184, v184, v185
    v_cvt_pk_bf16_f32 v185, v186, v187
    v_cvt_pk_bf16_f32 v186, v188, v189
    v_cvt_pk_bf16_f32 v187, v190, v191
    ds_write_b128 v18, v[184:187] offset:3072
    v_pk_mul_f32 v[192:193], v[192:193], v[40:41]
    v_pk_mul_f32 v[194:195], v[194:195], v[42:43]
    v_pk_mul_f32 v[196:197], v[196:197], v[44:45]
    v_pk_mul_f32 v[198:199], v[198:199], v[46:47]
    v_cvt_pk_bf16_f32 v192, v192, v193
    v_cvt_pk_bf16_f32 v193, v194, v195
    v_cvt_pk_bf16_f32 v194, v196, v197
    v_cvt_pk_bf16_f32 v195, v198, v199
    ds_write_b128 v18, v[192:195] offset:4096
    v_pk_mul_f32 v[200:201], v[200:201], v[40:41]
    v_pk_mul_f32 v[202:203], v[202:203], v[42:43]
    v_pk_mul_f32 v[204:205], v[204:205], v[44:45]
    v_pk_mul_f32 v[206:207], v[206:207], v[46:47]
    v_cvt_pk_bf16_f32 v200, v200, v201
    v_cvt_pk_bf16_f32 v201, v202, v203
    v_cvt_pk_bf16_f32 v202, v204, v205
    v_cvt_pk_bf16_f32 v203, v206, v207
    ds_write_b128 v18, v[200:203] offset:5120
    v_pk_mul_f32 v[208:209], v[208:209], v[48:49]
    v_pk_mul_f32 v[210:211], v[210:211], v[50:51]
    v_pk_mul_f32 v[212:213], v[212:213], v[52:53]
    v_pk_mul_f32 v[214:215], v[214:215], v[54:55]
    v_cvt_pk_bf16_f32 v208, v208, v209
    v_cvt_pk_bf16_f32 v209, v210, v211
    v_cvt_pk_bf16_f32 v210, v212, v213
    v_cvt_pk_bf16_f32 v211, v214, v215
    ds_write_b128 v18, v[208:211] offset:6144
    v_pk_mul_f32 v[216:217], v[216:217], v[48:49]
    v_pk_mul_f32 v[218:219], v[218:219], v[50:51]
    v_pk_mul_f32 v[220:221], v[220:221], v[52:53]
    v_pk_mul_f32 v[222:223], v[222:223], v[54:55]
    v_cvt_pk_bf16_f32 v216, v216, v217
    v_cvt_pk_bf16_f32 v217, v218, v219
    v_cvt_pk_bf16_f32 v218, v220, v221
    v_cvt_pk_bf16_f32 v219, v222, v223
    ds_write_b128 v18, v[216:219] offset:7168
    v_pk_mul_f32 v[224:225], v[224:225], v[56:57]
    v_pk_mul_f32 v[226:227], v[226:227], v[58:59]
    v_pk_mul_f32 v[228:229], v[228:229], v[60:61]
    v_pk_mul_f32 v[230:231], v[230:231], v[62:63]
    v_cvt_pk_bf16_f32 v224, v224, v225
    v_cvt_pk_bf16_f32 v225, v226, v227
    v_cvt_pk_bf16_f32 v226, v228, v229
    v_cvt_pk_bf16_f32 v227, v230, v231
    ds_write_b128 v18, v[224:227] offset:8192
    v_pk_mul_f32 v[232:233], v[232:233], v[56:57]
    v_pk_mul_f32 v[234:235], v[234:235], v[58:59]
    v_pk_mul_f32 v[236:237], v[236:237], v[60:61]
    v_pk_mul_f32 v[238:239], v[238:239], v[62:63]
    v_cvt_pk_bf16_f32 v232, v232, v233
    v_cvt_pk_bf16_f32 v233, v234, v235
    v_cvt_pk_bf16_f32 v234, v236, v237
    v_cvt_pk_bf16_f32 v235, v238, v239
    ds_write_b128 v18, v[232:235] offset:9216
    s_waitcnt lgkmcnt(0)
    s_cmp_lg_u32 s3, 0
    s_cbranch_scc1 L_gw8x
    s_mov_b32 s52, 20000
    s_mov_b64 exec, 0xff
    s_branch L_gw8f
L_gw8:
    s_sleep 1
    v_mov_b32 v7, 0
    buffer_atomic_add v7, v6, s[8:11], s66 offen sc0 sc1
L_gw8f:
    s_waitcnt vmcnt(0)
    v_cmp_lt_u32 vcc, v7, v8
    s_sub_u32 s52, s52, 1
    s_cselect_b32 s54, 0, vcc_lo
    s_mov_b32 exec_lo, s54
    s_cmp_lg_u32 s54, 0
    s_cbranch_scc1 L_gw8
    s_mov_b64 exec, -1
L_gw8x:
    s_barrier
    s_mov_b32 m0, s40
    s_nop 0
    buffer_load_dwordx4 v10, s[8:11], s44 offen offset:0 sc1 lds
    buffer_load_dwordx4 v11, s[8:11], s44 offen offset:1024 sc1 lds
    buffer_load_dwordx4 v12, s[8:11], s44 offen offset:2048 sc1 lds
    buffer_load_dwordx4 v13, s[8:11], s44 offen offset:3072 sc1 lds
    s_add_u32 s40, s40, 16384
    s_add_u32 s44, s44, 16384
    s_mov_b32 m0, s40
    s_nop 0
    buffer_load_dwordx4 v10, s[8:11], s44 offen offset:0 sc1 lds
    buffer_load_dwordx4 v11, s[8:11], s44 offen offset:1024 sc1 lds
    buffer_load_dwordx4 v12, s[8:11], s44 offen offset:2048 sc1 lds
    buffer_load_dwordx4 v13, s[8:11], s44 offen offset:3072 sc1 lds
    s_add_u32 s40, s40, 16384
    s_add_u32 s44, s44, 16384
    s_mov_b32 m0, s40
    s_nop 0
    buffer_load_dwordx4 v10, s[8:11], s44 offen offset:0 sc1 lds
    buffer_load_dwordx4 v11, s[8:11], s44 offen offset:1024 sc1 lds
    ds_read_b128 a[96:99], v19 offset:0
    ds_read_b128 a[100:103], v19 offset:1024
    ds_read_b128 a[104:107], v19 offset:10240
    ds_read_b128 a[108:111], v19 offset:11264
    ds_read_b128 a[112:115], v19 offset:20480
    ds_read_b128 a[116:119], v19 offset:21504
    ds_read_b128 a[120:123], v19 offset:30720
    ds_read_b128 a[124:127], v19 offset:31744
    buffer_load_dwordx4 v12, s[8:11], s44 offen offset:2048 sc1 lds
    buffer_load_dwordx4 v13, s[8:11], s44 offen offset:3072 sc1 lds
    ds_read_b128 a[128:131], v19 offset:2048
    ds_read_b128 a[132:135], v19 offset:3072
    ds_read_b128 a[136:139], v19 offset:12288
    ds_read_b128 a[140:143], v19 offset:13312
    ds_read_b128 a[144:147], v19 offset:22528
    ds_read_b128 a[148:151], v19 offset:23552
    ds_read_b128 a[152:155], v19 offset:32768
    ds_read_b128 a[156:159], v19 offset:33792
    s_add_u32 s40, s40, 16384
    s_add_u32 s44, s44, 16384
    s_mov_b32 m0, s40
    s_nop 0
    buffer_load_dwordx4 v10, s[8:11], s44 offen offset:0 sc1 lds
    buffer_load_dwordx4 v11, s[8:11], s44 offen offset:1024 sc1 lds
    ds_read_b128 a[160:163], v19 offset:4096
    ds_read_b128 a[164:167], v19 offset:5120
    ds_read_b128 a[168:171], v19 offset:14336
    ds_read_b128 a[172:175], v19 offset:15360
    ds_read_b128 a[176:179], v19 offset:24576
    ds_read_b128 a[180:183], v19 offset:25600
    ds_read_b128 a[184:187], v19 offset:34816
    ds_read_b128 a[188:191], v19 offset:35840
    buffer_load_dwordx4 v12, s[8:11], s44 offen offset:2048 sc1 lds
    buffer_load_dwordx4 v13, s[8:11], s44 offen offset:3072 sc1 lds
    ds_read_b128 a[192:195], v19 offset:6144
    ds_read_b128 a[196:199], v19 offset:7168
    ds_read_b128 a[200:203], v19 offset:16384
    ds_read_b128 a[204:207], v19 offset:17408
    ds_read_b128 a[208:211], v19 offset:26624
    ds_read_b128 a[212:215], v19 offset:27648
    ds_read_b128 a[216:219], v19 offset:36864
    ds_read_b128 a[220:223], v19 offset:37888
    s_add_u32 s40, s40, 16384
    s_add_u32 s44, s44, 16384
    s_mov_b32 m0, s40
    s_nop 0
    buffer_load_dwordx4 v10, s[8:11], s44 offen offset:0 sc1 lds
    buffer_load_dwordx4 v11, s[8:11], s44 offen offset:1024 sc1 lds
    ds_read_b128 a[224:227], v19 offset:8192
    ds_read_b128 a[228:231], v19 offset:9216
    ds_read_b128 a[232:235], v19 offset:18432
    ds_read_b128 a[236:239], v19 offset:19456
    ds_read_b128 a[240:243], v19 offset:28672
    ds_read_b128 a[244:247], v19 offset:29696
    ds_read_b128 a[248:251], v19 offset:38912
    ds_read_b128 a[252:255], v19 offset:39936
    buffer_load_dwordx4 v12, s[8:11], s44 offen offset:2048 sc1 lds
    buffer_load_dwordx4 v13, s[8:11], s44 offen offset:3072 sc1 lds
    s_cmp_lg_u32 s4, 0
    s_cbranch_scc1 L_p2_nosb
    v_lshlrev_b32 v130, 2, v2
    v_add_u32 v130, 122880, v130
    ds_read_b32 v64, v130 offset:0
    ds_read_b32 v66, v130 offset:0
    ds_read_b32 v68, v130 offset:64
    ds_read_b32 v70, v130 offset:64
    ds_read_b32 v72, v130 offset:128
    ds_read_b32 v74, v130 offset:128
    ds_read_b32 v76, v130 offset:192
    ds_read_b32 v78, v130 offset:192
    ds_read_b32 v80, v130 offset:256
    ds_read_b32 v82, v130 offset:256
    ds_read_b32 v84, v130 offset:320
    ds_read_b32 v86, v130 offset:320
    ds_read_b32 v88, v130 offset:384
    ds_read_b32 v90, v130 offset:384
    ds_read_b32 v92, v130 offset:448
    ds_read_b32 v94, v130 offset:448
L_p2_nosb:
    s_and_b32 s53, s2, 31
    s_lshl_b32 s53, s53, 7
    s_add_u32 s53, s53, 22462464
    v_mov_b32 v9, 0
    s_mov_b64 exec, 1
    buffer_atomic_add v9, v9, s[8:11], s53 offen sc0 sc1
    s_mov_b64 exec, -1
    s_and_b32 s36, s2, 1
    s_bfe_u32 s37, s2, 0x30003
    s_lshl_b32 s39, s36, 3
    s_add_u32 s39, s39, s37
    s_lshl_b32 s36, s36, 2
    s_and_b32 s37, s37, 3
    s_add_u32 s36, s36, s37
    s_mul_i32 s21, s3, 5120
    s_mul_i32 s20, s39, 40960
    s_add_u32 s20, s20, s21
    s_add_u32 s20, s20, 5505024
    s_cmp_lt_u32 s39, 12
    s_cselect_b32 s35, 0, 0x40000000
    s_add_u32 s39, s20, s35
    s_mul_i32 s26, s36, 54
    s_lshl_b32 s37, s3, 1
    s_add_u32 s26, s26, s37
    s_mul_i32 s26, s26, 5120
    s_add_u32 s26, s26, 9961472
    s_cmp_eq_u32 s3, 3
    s_cselect_b32 s28, 5120, 0
    s_cselect_b32 s29, 2048, 0
    s_sub_u32 s28, s26, s28
    s_waitcnt vmcnt(17)
    ds_read_b128 v[160:163], v14 offset:0
    ds_read_b128 v[164:167], v15 offset:0
    ds_read_b128 v[168:171], v16 offset:0
    ds_read_b128 v[172:175], v17 offset:0
    s_waitcnt vmcnt(13)
    ds_read_b128 v[176:179], v14 offset:16384
    ds_read_b128 v[180:183], v15 offset:16384
    ds_read_b128 v[184:187], v16 offset:16384
    ds_read_b128 v[188:191], v17 offset:16384
    s_waitcnt lgkmcnt(4)
    v_mfma_f32_16x16x32_bf16 v[64:67], v[160:163], a[96:99], v[64:67]
    v_mfma_f32_16x16x32_bf16 v[68:71], v[160:163], a[100:103], v[68:71]
    v_mfma_f32_16x16x32_bf16 v[72:75], v[164:167], a[104:107], v[72:75]
    v_mfma_f32_16x16x32_bf16 v[76:79], v[164:167], a[108:111], v[76:79]
    v_mfma_f32_16x16x32_bf16 v[80:83], v[168:171], a[112:115], v[80:83]
    v_mfma_f32_16x16x32_bf16 v[84:87], v[168:171], a[116:119], v[84:87]
    v_mfma_f32_16x16x32_bf16 v[88:91], v[172:175], a[120:123], v[88:91]
    v_mfma_f32_16x16x32_bf16 v[92:95], v[172:175], a[124:127], v[92:95]
    s_waitcnt vmcnt(9)
    ds_read_b128 v[192:195], v14 offset:32768
    ds_read_b128 v[196:199], v15 offset:32768
    ds_read_b128 v[200:203], v16 offset:32768
    ds_read_b128 v[204:207], v17 offset:32768
    s_waitcnt lgkmcnt(4)
    v_mfma_f32_16x16x32_bf16 v[64:67], v[176:179], a[128:131], v[64:67]
    v_mfma_f32_16x16x32_bf16 v[68:71], v[176:179], a[132:135], v[68:71]
    v_mfma_f32_16x16x32_bf16 v[72:75], v[180:183], a[136:139], v[72:75]
    v_mfma_f32_16x16x32_bf16 v[76:79], v[180:183], a[140:143], v[76:79]
    v_mfma_f32_16x16x32_bf16 v[80:83], v[184:187], a[144:147], v[80:83]
    v_mfma_f32_16x16x32_bf16 v[84:87], v[184:187], a[148:151], v[84:87]
    v_mfma_f32_16x16x32_bf16 v[88:91], v[188:191], a[152:155], v[88:91]
    v_mfma_f32_16x16x32_bf16 v[92:95], v[188:191], a[156:159], v[92:95]
    s_waitcnt vmcnt(5)
    v_add_u32 v14, 49152, v14
    v_add_u32 v15, 49152, v15
    v_add_u32 v16, 49152, v16
    v_add_u32 v17, 49152, v17
    ds_read_b128 v[208:211], v14 offset:0
    ds_read_b128 v[212:215], v15 offset:0
    ds_read_b128 v[216:219], v16 offset:0
    ds_read_b128 v[220:223], v17 offset:0
    s_waitcnt lgkmcnt(4)
    v_mfma_f32_16x16x32_bf16 v[64:67], v[192:195], a[160:163], v[64:67]
    v_mfma_f32_16x16x32_bf16 v[68:71], v[192:195], a[164:167], v[68:71]
    v_mfma_f32_16x16x32_bf16 v[72:75], v[196:199], a[168:171], v[72:75]
    v_mfma_f32_16x16x32_bf16 v[76:79], v[196:199], a[172:175], v[76:79]
    v_mfma_f32_16x16x32_bf16 v[80:83], v[200:203], a[176:179], v[80:83]
    v_mfma_f32_16x16x32_bf16 v[84:87], v[200:203], a[180:183], v[84:87]
    v_mfma_f32_16x16x32_bf16 v[88:91], v[204:207], a[184:187], v[88:91]
    v_mfma_f32_16x16x32_bf16 v[92:95], v[204:207], a[188:191], v[92:95]
    s_waitcnt vmcnt(1)
    ds_read_b128 v[224:227], v14 offset:16384
    ds_read_b128 v[228:231], v15 offset:16384
    ds_read_b128 v[232:235], v16 offset:16384
    ds_read_b128 v[236:239], v17 offset:16384
    s_waitcnt lgkmcnt(4)
    v_mfma_f32_16x16x32_bf16 v[64:67], v[208:211], a[192:195], v[64:67]
    v_mfma_f32_16x16x32_bf16 v[68:71], v[208:211], a[196:199], v[68:71]
    v_mfma_f32_16x16x32_bf16 v[72:75], v[212:215], a[200:203], v[72:75]
    v_mfma_f32_16x16x32_bf16 v[76:79], v[212:215], a[204:207], v[76:79]
    v_mfma_f32_16x16x32_bf16 v[80:83], v[216:219], a[208:211], v[80:83]
    v_mfma_f32_16x16x32_bf16 v[84:87], v[216:219], a[212:215], v[84:87]
    v_mfma_f32_16x16x32_bf16 v[88:91], v[220:223], a[216:219], v[88:91]
    v_mfma_f32_16x16x32_bf16 v[92:95], v[220:223], a[220:223], v[92:95]
    s_waitcnt lgkmcnt(0)
    v_mfma_f32_16x16x32_bf16 v[64:67], v[224:227], a[224:227], v[64:67]
    v_mfma_f32_16x16x32_bf16 v[68:71], v[224:227], a[228:231], v[68:71]
    v_mfma_f32_16x16x32_bf16 v[72:75], v[228:231], a[232:235], v[72:75]
    v_mfma_f32_16x16x32_bf16 v[76:79], v[228:231], a[236:239], v[76:79]
    v_mfma_f32_16x16x32_bf16 v[80:83], v[232:235], a[240:243], v[80:83]
    v_mfma_f32_16x16x32_bf16 v[84:87], v[232:235], a[244:247], v[84:87]
    v_mfma_f32_16x16x32_bf16 v[88:91], v[236:239], a[248:251], v[88:91]
    v_mfma_f32_16x16x32_bf16 v[92:95], v[236:239], a[252:255], v[92:95]
    s_nop 4
    v_pk_add_f32 v[32:33], v[64:65], v[80:81]
    v_pk_add_f32 v[36:37], v[64:65], v[80:81] neg_lo:[0,1] neg_hi:[0,1]
    v_pk_add_f32 v[34:35], v[66:67], v[82:83]
    v_pk_add_f32 v[38:39], v[66:67], v[82:83] neg_lo:[0,1] neg_hi:[0,1]
    v_pk_add_f32 v[48:49], v[68:69], v[84:85]
    v_pk_add_f32 v[52:53], v[68:69], v[84:85] neg_lo:[0,1] neg_hi:[0,1]
    v_pk_add_f32 v[50:51], v[70:71], v[86:87]
    v_pk_add_f32 v[54:55], v[70:71], v[86:87] neg_lo:[0,1] neg_hi:[0,1]
    v_pk_add_f32 v[40:41], v[72:73], v[88:89]
    v_pk_add_f32 v[44:45], v[72:73], v[88:89] neg_lo:[0,1] neg_hi:[0,1]
    v_pk_add_f32 v[42:43], v[74:75], v[90:91]
    v_pk_add_f32 v[46:47], v[74:75], v[90:91] neg_lo:[0,1] neg_hi:[0,1]
    v_pk_add_f32 v[56:57], v[76:77], v[92:93]
    v_pk_add_f32 v[60:61], v[76:77], v[92:93] neg_lo:[0,1] neg_hi:[0,1]
    v_pk_add_f32 v[58:59], v[78:79], v[94:95]
    v_pk_add_f32 v[62:63], v[78:79], v[94:95] neg_lo:[0,1] neg_hi:[0,1]
    v_pk_add_f32 v[136:137], v[32:33], v[40:41]
    v_pk_add_f32 v[138:139], v[34:35], v[42:43]
    v_cvt_pk_bf16_f32 v136, v136, v137
    v_cvt_pk_bf16_f32 v137, v138, v139
    ds_write_b64 v20, v[136:137] offset:16384
    v_pk_add_f32 v[140:141], v[48:49], v[56:57]
    v_pk_add_f32 v[142:143], v[50:51], v[58:59]
    v_cvt_pk_bf16_f32 v140, v140, v141
    v_cvt_pk_bf16_f32 v141, v142, v143
    ds_write_b64 v20, v[140:141] offset:16896
    v_pk_add_f32 v[152:153], v[32:33], v[40:41] neg_lo:[0,1] neg_hi:[0,1]
    v_pk_add_f32 v[154:155], v[34:35], v[42:43] neg_lo:[0,1] neg_hi:[0,1]
    v_cvt_pk_bf16_f32 v152, v152, v153
    v_cvt_pk_bf16_f32 v153, v154, v155
    ds_write_b64 v20, v[152:153] offset:49152
    v_pk_add_f32 v[156:157], v[56:57], v[48:49] neg_lo:[0,1] neg_hi:[0,1]
    v_pk_add_f32 v[158:159], v[58:59], v[50:51] neg_lo:[0,1] neg_hi:[0,1]
    v_cvt_pk_bf16_f32 v156, v156, v157
    v_cvt_pk_bf16_f32 v157, v158, v159
    ds_write_b64 v20, v[156:157] offset:49664
    v_pk_add_f32 v[128:129], v[36:37], v[60:61] neg_lo:[0,1] neg_hi:[0,1]
    v_pk_add_f32 v[130:131], v[38:39], v[62:63] neg_lo:[0,1] neg_hi:[0,1]
    v_cvt_pk_bf16_f32 v128, v128, v129
    v_cvt_pk_bf16_f32 v129, v130, v131
    ds_write_b64 v20, v[128:129] offset:0
    v_pk_add_f32 v[132:133], v[52:53], v[44:45]
    v_pk_add_f32 v[134:135], v[54:55], v[46:47]
    v_cvt_pk_bf16_f32 v132, v132, v133
    v_cvt_pk_bf16_f32 v133, v134, v135
    ds_write_b64 v20, v[132:133] offset:512
    v_pk_add_f32 v[144:145], v[36:37], v[60:61]
    v_pk_add_f32 v[146:147], v[38:39], v[62:63]
    v_cvt_pk_bf16_f32 v144, v144, v145
    v_cvt_pk_bf16_f32 v145, v146, v147
    ds_write_b64 v20, v[144:145] offset:32768
    v_pk_add_f32 v[148:149], v[44:45], v[52:53] neg_lo:[0,1] neg_hi:[0,1]
    v_pk_add_f32 v[150:151], v[46:47], v[54:55] neg_lo:[0,1] neg_hi:[0,1]
    v_cvt_pk_bf16_f32 v148, v148, v149
    v_cvt_pk_bf16_f32 v149, v150, v151
    ds_write_b64 v20, v[148:149] offset:33280
    s_cmp_lg_u32 s5, 0
    s_cbranch_scc1 L_p2_nfx
    s_mov_b32 exec_lo, 0x00010001
    s_mov_b32 exec_hi, 0x00010001
    v_pk_add_f32 v[192:193], v[32:33], v[40:41] neg_lo:[0,1] neg_hi:[0,1]
    v_pk_add_f32 v[194:195], v[34:35], v[42:43] neg_lo:[0,1] neg_hi:[0,1]
    v_cvt_pk_bf16_f32 v192, v192, v193
    v_cvt_pk_bf16_f32 v193, v194, v195
    ds_write_b64 v20, v[192:193] offset:16896
    v_pk_add_f32 v[196:197], v[68:69], v[60:61]
    v_pk_add_f32 v[198:199], v[70:71], v[62:63]
    v_cvt_pk_bf16_f32 v196, v196, v197
    v_cvt_pk_bf16_f32 v197, v198, v199
    ds_write_b64 v20, v[196:197] offset:32768
    v_pk_add_f32 v[200:201], v[56:57], v[84:85]
    v_pk_add_f32 v[202:203], v[58:59], v[86:87]
    v_cvt_pk_bf16_f32 v200, v200, v201
    v_cvt_pk_bf16_f32 v201, v202, v203
    ds_write_b64 v20, v[200:201] offset:33280
    v_pk_add_f32 v[204:205], v[68:69], v[60:61] neg_lo:[0,1] neg_hi:[0,1]
    v_pk_add_f32 v[206:207], v[70:71], v[62:63] neg_lo:[0,1] neg_hi:[0,1]
    v_cvt_pk_bf16_f32 v204, v204, v205
    v_cvt_pk_bf16_f32 v205, v206, v207
    ds_write_b64 v20, v[204:205] offset:49152
    v_pk_add_f32 v[208:209], v[56:57], v[84:85] neg_lo:[0,1] neg_hi:[0,1]
    v_pk_add_f32 v[210:211], v[58:59], v[86:87] neg_lo:[0,1] neg_hi:[0,1]
    v_cvt_pk_bf16_f32 v208, v208, v209
    v_cvt_pk_bf16_f32 v209, v210, v211
    ds_write_b64 v20, v[208:209] offset:49664
    v_cvt_pk_bf16_f32 v36, v36, v37
    v_cvt_pk_bf16_f32 v37, v38, v39
    ds_write_b64 v20, v[36:37] offset:0
    v_cvt_pk_bf16_f32 v44, v44, v45
    v_cvt_pk_bf16_f32 v45, v46, v47
    ds_write_b64 v20, v[44:45] offset:512
    s_mov_b64 exec, -1
L_p2_nfx:
    s_waitcnt lgkmcnt(0)
    s_barrier
    ds_read2st64_b64 v[32:35], v23 offset0:0 offset1:8
    ds_read2st64_b64 v[40:43], v23 offset0:1 offset1:9
    ds_read2st64_b64 v[36:39], v23 offset0:16 offset1:24
    ds_read2st64_b64 v[44:47], v23 offset0:17 offset1:25
    s_waitcnt vmcnt(0)
    v_readfirstlane_b32 s67, v9
    v_add_u32 v19, 65536, v4
    s_cmp_ge_u32 s67, 12
    s_cselect_b32 s67, 1, 0
    s_cmp_eq_u32 s67, 0
    s_cbranch_scc1 L_pf9
    s_add_u32 m0, s21, 81920
    s_add_u32 s41, s20, 0
    buffer_load_dwordx4 v4, s[8:11], s41 offen offset:0 sc1 lds
    buffer_load_dwordx4 v4, s[8:11], s41 offen offset:1024 sc1 lds
    buffer_load_dwordx4 v4, s[8:11], s41 offen offset:2048 sc1 lds
    buffer_load_dwordx4 v4, s[8:11], s41 offen offset:3072 sc1 lds
    s_add_u32 m0, s21, 86016
    s_add_u32 s41, s20, 4096
    buffer_load_dwordx4 v4, s[8:11], s41 offen offset:0 sc1 lds
    s_add_u32 m0, s21, 102400
    s_add_u32 s41, s20, 655360
    buffer_load_dwordx4 v4, s[8:11], s41 offen offset:0 sc1 lds
    buffer_load_dwordx4 v4, s[8:11], s41 offen offset:1024 sc1 lds
    buffer_load_dwordx4 v4, s[8:11], s41 offen offset:2048 sc1 lds
L_pf9:
    s_waitcnt lgkmcnt(0)
    v_mfma_f32_16x16x32_bf16 v[64:67], a[64:67], v[32:35], 0
    v_mfma_f32_16x16x32_bf16 v[68:71], a[64:67], v[40:43], 0
    v_mfma_f32_16x16x32_bf16 v[64:67], a[68:71], v[36:39], v[64:67]
    v_mfma_f32_16x16x32_bf16 v[68:71], a[68:71], v[44:47], v[68:71]
    v_mfma_f32_16x16x32_bf16 v[72:75], a[72:75], v[32:35], 0
    v_mfma_f32_16x16x32_bf16 v[76:79], a[72:75], v[40:43], 0
    v_mfma_f32_16x16x32_bf16 v[72:75], a[76:79], v[36:39], v[72:75]
    v_mfma_f32_16x16x32_bf16 v[76:79], a[76:79], v[44:47], v[76:79]
    v_mfma_f32_16x16x32_bf16 v[80:83], a[80:83], v[32:35], 0
    v_mfma_f32_16x16x32_bf16 v[84:87], a[80:83], v[40:43], 0
    s_nop 0
    v_pk_mul_f32 v[128:129], v[64:65], v[96:97] op_sel:[0,0] op_sel_hi:[0,1]
    v_pk_mul_f32 v[130:131], v[68:69], v[240:241] op_sel:[0,0] op_sel_hi:[0,1]
    v_pk_fma_f32 v[128:129], v[64:65], v[96:97], v[128:129] op_sel:[1,1,0] op_sel_hi:[1,0,1] neg_lo:[1,0,0]
    v_mfma_f32_16x16x32_bf16 v[80:83], a[84:87], v[36:39], v[80:83]
    v_pk_fma_f32 v[130:131], v[68:69], v[240:241], v[130:131] op_sel:[1,1,0] op_sel_hi:[1,0,1] neg_lo:[1,0,0]
    v_pk_fma_f32 v[128:129], v[68:69], v[98:99], v[128:129] op_sel:[0,1,0] op_sel_hi:[0,0,1] neg_hi:[1,0,0]
    s_branch L_pg2c
.p2align 12
L_pg2:
    s_setpc_b64 s[60:61]
L_pg2c:
    v_pk_fma_f32 v[130:131], v[64:65], v[98:99], v[130:131] op_sel:[0,1,0] op_sel_hi:[0,0,1] neg_lo:[1,0,0]
    v_pk_fma_f32 v[128:129], v[68:69], v[98:99], v[128:129] op_sel:[1,0,0] op_sel_hi:[1,1,1]
    v_mfma_f32_16x16x32_bf16 v[84:87], a[84:87], v[44:47], v[84:87]
    v_pk_fma_f32 v[130:131], v[64:65], v[98:99], v[130:131] op_sel:[1,0,0] op_sel_hi:[1,1,1] neg_lo:[1,0,0] neg_hi:[1,0,0]
    v_cvt_pk_bf16_f32 v48, v128, v129
    v_cvt_pk_bf16_f32 v56, v130, v131
    v_pk_mul_f32 v[132:133], v[66:67], v[100:101] op_sel:[0,0] op_sel_hi:[0,1]
    v_pk_mul_f32 v[134:135], v[70:71], v[242:243] op_sel:[0,0] op_sel_hi:[0,1]
    v_pk_fma_f32 v[132:133], v[66:67], v[100:101], v[132:133] op_sel:[1,1,0] op_sel_hi:[1,0,1] neg_lo:[1,0,0]
    v_mfma_f32_16x16x32_bf16 v[88:91], a[88:91], v[32:35], 0
    v_pk_fma_f32 v[134:135], v[70:71], v[242:243], v[134:135] op_sel:[1,1,0] op_sel_hi:[1,0,1] neg_lo:[1,0,0]
    v_pk_fma_f32 v[132:133], v[70:71], v[102:103], v[132:133] op_sel:[0,1,0] op_sel_hi:[0,0,1] neg_hi:[1,0,0]
    v_pk_fma_f32 v[134:135], v[66:67], v[102:103], v[134:135] op_sel:[0,1,0] op_sel_hi:[0,0,1] neg_lo:[1,0,0]
    v_pk_fma_f32 v[132:133], v[70:71], v[102:103], v[132:133] op_sel:[1,0,0] op_sel_hi:[1,1,1]
    v_mfma_f32_16x16x32_bf16 v[92:95], a[88:91], v[40:43], 0
    v_pk_fma_f32 v[134:135], v[66:67], v[102:103], v[134:135] op_sel:[1,0,0] op_sel_hi:[1,1,1] neg_lo:[1,0,0] neg_hi:[1,0,0]
    v_cvt_pk_bf16_f32 v49, v132, v133
    v_cvt_pk_bf16_f32 v57, v134, v135
    v_pk_mul_f32 v[128:129], v[72:73], v[104:105] op_sel:[0,0] op_sel_hi:[0,1]
    v_pk_mul_f32 v[130:131], v[76:77], v[244:245] op_sel:[0,0] op_sel_hi:[0,1]
    v_pk_fma_f32 v[128:129], v[72:73], v[104:105], v[128:129] op_sel:[1,1,0] op_sel_hi:[1,0,1] neg_lo:[1,0,0]
    v_mfma_f32_16x16x32_bf16 v[88:91], a[92:95], v[36:39], v[88:91]
    v_pk_fma_f32 v[130:131], v[76:77], v[244:245], v[130:131] op_sel:[1,1,0] op_sel_hi:[1,0,1] neg_lo:[1,0,0]
    v_pk_fma_f32 v[128:129], v[76:77], v[106:107], v[128:129] op_sel:[0,1,0] op_sel_hi:[0,0,1] neg_hi:[1,0,0]
    v_pk_fma_f32 v[130:131], v[72:73], v[106:107], v[130:131] op_sel:[0,1,0] op_sel_hi:[0,0,1] neg_lo:[1,0,0]
    v_pk_fma_f32 v[128:129], v[76:77], v[106:107], v[128:129] op_sel:[1,0,0] op_sel_hi:[1,1,1]
    v_mfma_f32_16x16x32_bf16 v[92:95], a[92:95], v[44:47], v[92:95]
    v_pk_fma_f32 v[130:131], v[72:73], v[106:107], v[130:131] op_sel:[1,0,0] op_sel_hi:[1,1,1] neg_lo:[1,0,0] neg_hi:[1,0,0]
    v_cvt_pk_bf16_f32 v50, v128, v129
    v_cvt_pk_bf16_f32 v58, v130, v131
    v_pk_mul_f32 v[132:133], v[74:75], v[108:109] op_sel:[0,0] op_sel_hi:[0,1]
    v_pk_mul_f32 v[134:135], v[78:79], v[246:247] op_sel:[0,0] op_sel_hi:[0,1]
    v_pk_fma_f32 v[132:133], v[74:75], v[108:109], v[132:133] op_sel:[1,1,0] op_sel_hi:[1,0,1] neg_lo:[1,0,0]
    v_pk_fma_f32 v[134:135], v[78:79], v[246:247], v[134:135] op_sel:[1,1,0] op_sel_hi:[1,0,1] neg_lo:[1,0,0]
    v_pk_fma_f32 v[132:133], v[78:79], v[110:111], v[132:133] op_sel:[0,1,0] op_sel_hi:[0,0,1] neg_hi:[1,0,0]
    v_pk_fma_f32 v[134:135], v[74:75], v[110:111], v[134:135] op_sel:[0,1,0] op_sel_hi:[0,0,1] neg_lo:[1,0,0]
    v_pk_fma_f32 v[132:133], v[78:79], v[110:111], v[132:133] op_sel:[1,0,0] op_sel_hi:[1,1,1]
    v_pk_fma_f32 v[134:135], v[74:75], v[110:111], v[134:135] op_sel:[1,0,0] op_sel_hi:[1,1,1] neg_lo:[1,0,0] neg_hi:[1,0,0]
    v_cvt_pk_bf16_f32 v51, v132, v133
    v_cvt_pk_bf16_f32 v59, v134, v135
    s_cmp_eq_u32 s67, 0
    s_cbranch_scc1 L_pf10
    buffer_load_dwordx4 v4, s[8:11], s41 offen offset:3072 sc1 lds
    s_add_u32 m0, s21, 106496
    s_add_u32 s41, s20, 659456
    buffer_load_dwordx4 v4, s[8:11], s41 offen offset:0 sc1 lds
    s_add_u32 m0, s21, 122880
    s_add_u32 s41, s20, 1310720
    buffer_load_dwordx4 v4, s[8:11], s41 offen offset:0 sc1 lds
    buffer_load_dwordx4 v4, s[8:11], s41 offen offset:1024 sc1 lds
    buffer_load_dwordx4 v4, s[8:11], s41 offen offset:2048 sc1 lds
    buffer_load_dwordx4 v4, s[8:11], s41 offen offset:3072 sc1 lds
    s_add_u32 m0, s21, 126976
    s_add_u32 s41, s20, 1314816
    buffer_load_dwordx4 v4, s[8:11], s41 offen offset:0 sc1 lds
L_pf10:
    ds_write_b128 v21, v[48:51] offset:0
    ds_write_b128 v21, v[56:59] offset:2048
    v_pk_mul_f32 v[128:129], v[80:81], v[112:113] op_sel:[0,0] op_sel_hi:[0,1]
    v_pk_mul_f32 v[130:131], v[84:85], v[248:249] op_sel:[0,0] op_sel_hi:[0,1]
    v_pk_fma_f32 v[128:129], v[80:81], v[112:113], v[128:129] op_sel:[1,1,0] op_sel_hi:[1,0,1] neg_lo:[1,0,0]
    v_pk_fma_f32 v[130:131], v[84:85], v[248:249], v[130:131] op_sel:[1,1,0] op_sel_hi:[1,0,1] neg_lo:[1,0,0]
    v_pk_fma_f32 v[128:129], v[84:85], v[114:115], v[128:129] op_sel:[0,1,0] op_sel_hi:[0,0,1] neg_hi:[1,0,0]
    v_pk_fma_f32 v[130:131], v[80:81], v[114:115], v[130:131] op_sel:[0,1,0] op_sel_hi:[0,0,1] neg_lo:[1,0,0]
    v_pk_fma_f32 v[128:129], v[84:85], v[114:115], v[128:129] op_sel:[1,0,0] op_sel_hi:[1,1,1]
    v_pk_fma_f32 v[130:131], v[80:81], v[114:115], v[130:131] op_sel:[1,0,0] op_sel_hi:[1,1,1] neg_lo:[1,0,0] neg_hi:[1,0,0]
    v_cvt_pk_bf16_f32 v52, v128, v129
    v_cvt_pk_bf16_f32 v60, v130, v131
    v_pk_mul_f32 v[132:133], v[82:83], v[116:117] op_sel:[0,0] op_sel_hi:[0,1]
    v_pk_mul_f32 v[134:135], v[86:87], v[250:251] op_sel:[0,0] op_sel_hi:[0,1]
    v_pk_fma_f32 v[132:133], v[82:83], v[116:117], v[132:133] op_sel:[1,1,0] op_sel_hi:[1,0,1] neg_lo:[1,0,0]
    v_pk_fma_f32 v[134:135], v[86:87], v[250:251], v[134:135] op_sel:[1,1,0] op_sel_hi:[1,0,1] neg_lo:[1,0,0]
    v_pk_fma_f32 v[132:133], v[86:87], v[118:119], v[132:133] op_sel:[0,1,0] op_sel_hi:[0,0,1] neg_hi:[1,0,0]
    v_pk_fma_f32 v[134:135], v[82:83], v[118:119], v[134:135] op_sel:[0,1,0] op_sel_hi:[0,0,1] neg_lo:[1,0,0]
    v_pk_fma_f32 v[132:133], v[86:87], v[118:119], v[132:133] op_sel:[1,0,0] op_sel_hi:[1,1,1]
    v_pk_fma_f32 v[134:135], v[82:83], v[118:119], v[134:135] op_sel:[1,0,0] op_sel_hi:[1,1,1] neg_lo:[1,0,0] neg_hi:[1,0,0]
    v_cvt_pk_bf16_f32 v53, v132, v133
    v_cvt_pk_bf16_f32 v61, v134, v135
    v_pk_mul_f32 v[128:129], v[88:89], v[120:121] op_sel:[0,0] op_sel_hi:[0,1]
    v_pk_mul_f32 v[130:131], v[92:93], v[252:253] op_sel:[0,0] op_sel_hi:[0,1]
    v_pk_fma_f32 v[128:129], v[88:89], v[120:121], v[128:129] op_sel:[1,1,0] op_sel_hi:[1,0,1] neg_lo:[1,0,0]
    v_pk_fma_f32 v[130:131], v[92:93], v[252:253], v[130:131] op_sel:[1,1,0] op_sel_hi:[1,0,1] neg_lo:[1,0,0]
    v_pk_fma_f32 v[128:129], v[92:93], v[122:123], v[128:129] op_sel:[0,1,0] op_sel_hi:[0,0,1] neg_hi:[1,0,0]
    v_pk_fma_f32 v[130:131], v[88:89], v[122:123], v[130:131] op_sel:[0,1,0] op_sel_hi:[0,0,1] neg_lo:[1,0,0]
    v_pk_fma_f32 v[128:129], v[92:93], v[122:123], v[128:129] op_sel:[1,0,0] op_sel_hi:[1,1,1]
    v_pk_fma_f32 v[130:131], v[88:89], v[122:123], v[130:131] op_sel:[1,0,0] op_sel_hi:[1,1,1] neg_lo:[1,0,0] neg_hi:[1,0,0]
    v_cvt_pk_bf16_f32 v54, v128, v129
    v_cvt_pk_bf16_f32 v62, v130, v131
    v_pk_mul_f32 v[132:133], v[90:91], v[124:125] op_sel:[0,0] op_sel_hi:[0,1]
    v_pk_mul_f32 v[134:135], v[94:95], v[254:255] op_sel:[0,0] op_sel_hi:[0,1]
    v_pk_fma_f32 v[132:133], v[90:91], v[124:125], v[132:133] op_sel:[1,1,0] op_sel_hi:[1,0,1] neg_lo:[1,0,0]
    v_pk_fma_f32 v[134:135], v[94:95], v[254:255], v[134:135] op_sel:[1,1,0] op_sel_hi:[1,0,1] neg_lo:[1,0,0]
    v_pk_fma_f32 v[132:133], v[94:95], v[126:127], v[132:133] op_sel:[0,1,0] op_sel_hi:[0,0,1] neg_hi:[1,0,0]
    v_pk_fma_f32 v[134:135], v[90:91], v[126:127], v[134:135] op_sel:[0,1,0] op_sel_hi:[0,0,1] neg_lo:[1,0,0]
    v_pk_fma_f32 v[132:133], v[94:95], v[126:127], v[132:133] op_sel:[1,0,0] op_sel_hi:[1,1,1]
    v_pk_fma_f32 v[134:135], v[90:91], v[126:127], v[134:135] op_sel:[1,0,0] op_sel_hi:[1,1,1] neg_lo:[1,0,0] neg_hi:[1,0,0]
    v_cvt_pk_bf16_f32 v55, v132, v133
    v_cvt_pk_bf16_f32 v63, v134, v135
    ds_write_b128 v21, v[52:55] offset:1024
    ds_write_b128 v21, v[60:63] offset:3072
    s_waitcnt lgkmcnt(0)
    s_barrier
    ds_read_b128 a[112:115], v19 offset:4096
    ds_read_b128 a[144:147], v19 offset:12288
    ds_read_b128 a[96:99], v19 offset:0
    ds_read_b128 a[128:131], v19 offset:8192
    ds_read_b128 a[120:123], v19 offset:6144
    ds_read_b128 a[152:155], v19 offset:14336
    ds_read_b128 a[104:107], v19 offset:2048
    ds_read_b128 a[136:139], v19 offset:10240
    ds_read_b128 a[116:119], v19 offset:5120
    ds_read_b128 a[148:151], v19 offset:13312
    ds_read_b128 a[100:103], v19 offset:1024
    ds_read_b128 a[132:135], v19 offset:9216
    ds_read_b128 a[124:127], v19 offset:7168
    ds_read_b128 a[156:159], v19 offset:15360
    ds_read_b128 a[108:111], v19 offset:3072
    ds_read_b128 a[140:143], v19 offset:11264
    s_waitcnt lgkmcnt(14)
    v_mfma_f32_16x16x32_bf16 v[72:75], a[112:115], a[56:59], 0
    v_mfma_f32_16x16x32_bf16 v[88:91], a[144:147], a[56:59], 0
    s_waitcnt lgkmcnt(12)
    v_mfma_f32_16x16x32_bf16 v[64:67], a[96:99], a[56:59], 0
    v_mfma_f32_16x16x32_bf16 v[80:83], a[128:131], a[56:59], 0
    s_waitcnt lgkmcnt(10)
    v_mfma_f32_16x16x32_bf16 v[76:79], a[120:123], a[56:59], 0
    v_mfma_f32_16x16x32_bf16 v[92:95], a[152:155], a[56:59], 0
    s_waitcnt lgkmcnt(8)
    v_mfma_f32_16x16x32_bf16 v[68:71], a[104:107], a[56:59], 0
    v_mfma_f32_16x16x32_bf16 v[84:87], a[136:139], a[56:59], 0
    s_waitcnt lgkmcnt(6)
    v_mfma_f32_16x16x32_bf16 v[72:75], a[116:119], a[60:63], v[72:75]
    v_mfma_f32_16x16x32_bf16 v[88:91], a[148:151], a[60:63], v[88:91]
    s_waitcnt lgkmcnt(4)
    v_mfma_f32_16x16x32_bf16 v[64:67], a[100:103], a[60:63], v[64:67]
    v_mfma_f32_16x16x32_bf16 v[80:83], a[132:135], a[60:63], v[80:83]
    s_waitcnt lgkmcnt(2)
    v_mfma_f32_16x16x32_bf16 v[76:79], a[124:127], a[60:63], v[76:79]
    v_mfma_f32_16x16x32_bf16 v[92:95], a[156:159], a[60:63], v[92:95]
    s_waitcnt lgkmcnt(0)
    v_mfma_f32_16x16x32_bf16 v[68:71], a[108:111], a[60:63], v[68:71]
    v_mfma_f32_16x16x32_bf16 v[84:87], a[140:143], a[60:63], v[84:87]
    v_pk_add_f32 v[32:33], v[72:73], v[88:89]
    v_pk_add_f32 v[36:37], v[72:73], v[88:89] neg_lo:[0,1] neg_hi:[0,1]
    v_pk_add_f32 v[34:35], v[74:75], v[90:91]
    v_pk_add_f32 v[38:39], v[74:75], v[90:91] neg_lo:[0,1] neg_hi:[0,1]
    v_pk_add_f32 v[40:41], v[64:65], v[80:81]
    v_pk_add_f32 v[44:45], v[64:65], v[80:81] neg_lo:[0,1] neg_hi:[0,1]
    v_pk_add_f32 v[42:43], v[66:67], v[82:83]
    v_pk_add_f32 v[46:47], v[66:67], v[82:83] neg_lo:[0,1] neg_hi:[0,1]
    v_pk_add_f32 v[48:49], v[76:77], v[92:93]
    v_pk_add_f32 v[52:53], v[76:77], v[92:93] neg_lo:[0,1] neg_hi:[0,1]
    v_pk_add_f32 v[50:51], v[78:79], v[94:95]
    v_pk_add_f32 v[54:55], v[78:79], v[94:95] neg_lo:[0,1] neg_hi:[0,1]
    v_pk_add_f32 v[56:57], v[68:69], v[84:85]
    v_pk_add_f32 v[60:61], v[68:69], v[84:85] neg_lo:[0,1] neg_hi:[0,1]
    v_pk_add_f32 v[58:59], v[70:71], v[86:87]
    v_pk_add_f32 v[62:63], v[70:71], v[86:87] neg_lo:[0,1] neg_hi:[0,1]
    v_pk_add_f32 v[128:129], v[32:33], v[40:41]
    v_pk_add_f32 v[130:131], v[34:35], v[42:43]
    v_pk_add_f32 v[132:133], v[52:53], v[60:61]
    v_pk_add_f32 v[134:135], v[54:55], v[62:63]
    v_pk_add_f32 v[144:145], v[32:33], v[40:41] neg_lo:[0,1] neg_hi:[0,1]
    v_pk_add_f32 v[146:147], v[34:35], v[42:43] neg_lo:[0,1] neg_hi:[0,1]
    v_pk_add_f32 v[148:149], v[52:53], v[60:61] neg_lo:[0,1] neg_hi:[0,1]
    v_pk_add_f32 v[150:151], v[54:55], v[62:63] neg_lo:[0,1] neg_hi:[0,1]
    v_pk_add_f32 v[136:137], v[36:37], v[56:57]
    v_pk_add_f32 v[138:139], v[38:39], v[58:59]
    v_pk_add_f32 v[140:141], v[48:49], v[44:45] neg_lo:[0,1] neg_hi:[0,1]
    v_pk_add_f32 v[142:143], v[50:51], v[46:47] neg_lo:[0,1] neg_hi:[0,1]
    v_pk_add_f32 v[152:153], v[36:37], v[56:57] neg_lo:[0,1] neg_hi:[0,1]
    v_pk_add_f32 v[154:155], v[38:39], v[58:59] neg_lo:[0,1] neg_hi:[0,1]
    v_pk_add_f32 v[156:157], v[48:49], v[44:45]
    v_pk_add_f32 v[158:159], v[50:51], v[46:47]
    s_cmp_lg_u32 s5, 0
    s_cbranch_scc1 L_p2_nfy
    s_mov_b64 exec, 0xffff
    v_add_f32 v32, v72, v76
    v_sub_f32 v33, v72, v76
    v_sub_f32 v34, v80, v88
    v_add_f32 v35, v84, v92
    v_add_f32 v128, v32, v64
    v_sub_f32 v144, v32, v64
    v_add_f32 v136, v33, v68
    v_sub_f32 v152, v33, v68
    v_add_f32 v132, v80, v88
    v_sub_f32 v148, v84, v92
    v_add_f32 v140, v35, v34
    v_sub_f32 v156, v35, v34
L_p2_nfy:
    s_mov_b32 exec_lo, s49
    s_mov_b32 exec_hi, s49
    v_cvt_pk_bf16_f32 v64, v128, v129
    v_cvt_pk_bf16_f32 v65, v130, v131
    v_cvt_pk_bf16_f32 v66, v132, v133
    v_cvt_pk_bf16_f32 v67, v134, v135
    buffer_store_dwordx4 v[64:67], v5, s[8:11], s48 offen sc1
    s_add_u32 s48, s48, 20480
    v_cvt_pk_bf16_f32 v68, v136, v137
    v_cvt_pk_bf16_f32 v69, v138, v139
    v_cvt_pk_bf16_f32 v70, v140, v141
    v_cvt_pk_bf16_f32 v71, v142, v143
    buffer_store_dwordx4 v[68:71], v5, s[8:11], s48 offen sc1
    s_add_u32 s48, s48, 20480
    v_cvt_pk_bf16_f32 v72, v144, v145
    v_cvt_pk_bf16_f32 v73, v146, v147
    v_cvt_pk_bf16_f32 v74, v148, v149
    v_cvt_pk_bf16_f32 v75, v150, v151
    buffer_store_dwordx4 v[72:75], v5, s[8:11], s48 offen sc1
    s_add_u32 s48, s48, 20480
    v_cvt_pk_bf16_f32 v76, v152, v153
    v_cvt_pk_bf16_f32 v77, v154, v155
    v_cvt_pk_bf16_f32 v78, v156, v157
    v_cvt_pk_bf16_f32 v79, v158, v159
    buffer_store_dwordx4 v[76:79], v5, s[8:11], s48 offen sc1
    s_mov_b64 exec, -1
    s_waitcnt vmcnt(0) lgkmcnt(0)
    s_barrier
    s_cmp_lg_u32 s3, 0
    s_cbranch_scc1 L_sg11
    v_lshlrev_b32 v6, 10, v1
    s_bfe_u32 s52, s2, 0x30003
    s_lshl_b32 s52, s52, 7
    s_add_u32 s52, s52, 22437888
    s_mov_b64 exec, 0xff
    v_mov_b32 v7, 1
    buffer_atomic_add v7, v6, s[8:11], s52 offen sc1
    s_mov_b64 exec, -1
L_sg11:
L_p3:
    s_cmp_lg_u32 s67, 0
    s_cbranch_scc1 L_p3_pf
    s_and_b32 s53, s2, 31
    s_lshl_b32 s53, s53, 7
    s_add_u32 s53, s53, 22462464
    v_mov_b32 v7, 0
    s_mov_b64 exec, 1
    buffer_atomic_add v7, v7, s[8:11], s53 offen sc0 sc1
    s_mov_b64 exec, -1
    s_and_b32 s36, s2, 1
    s_bfe_u32 s37, s2, 0x30003
    s_lshl_b32 s39, s36, 3
    s_add_u32 s39, s39, s37
    s_lshl_b32 s36, s36, 2
    s_and_b32 s37, s37, 3
    s_add_u32 s36, s36, s37
    s_mul_i32 s21, s3, 5120
    s_mul_i32 s20, s39, 40960
    s_add_u32 s20, s20, s21
    s_add_u32 s20, s20, 5505024
    s_cmp_lt_u32 s39, 12
    s_cselect_b32 s35, 0, 0x40000000
    s_add_u32 s39, s20, s35
    s_mul_i32 s26, s36, 54
    s_lshl_b32 s37, s3, 1
    s_add_u32 s26, s26, s37
    s_mul_i32 s26, s26, 5120
    s_add_u32 s26, s26, 9961472
    s_cmp_eq_u32 s3, 3
    s_cselect_b32 s28, 5120, 0
    s_cselect_b32 s29, 2048, 0
    s_sub_u32 s28, s26, s28
    s_waitcnt vmcnt(0)
    s_mov_b32 s56, 20000
    s_branch L_cc12c
L_cc12:
    s_sleep 4
    s_and_b32 s53, s2, 31
    s_lshl_b32 s53, s53, 7
    s_add_u32 s53, s53, 22462464
    v_mov_b32 v7, 0
    s_mov_b64 exec, 1
    buffer_atomic_add v7, v7, s[8:11], s53 offen sc0 sc1
    s_mov_b64 exec, -1
    s_waitcnt vmcnt(0)
L_cc12c:
    v_readfirstlane_b32 s54, v7
    s_sub_u32 s56, s56, 1
    s_cselect_b32 s54, 12, s54
    s_cmp_lt_u32 s54, 12
    s_cbranch_scc1 L_cc12
    s_add_u32 m0, s21, 81920
    s_add_u32 s41, s20, 0
    buffer_load_dwordx4 v4, s[8:11], s41 offen offset:0 sc1 lds
    buffer_load_dwordx4 v4, s[8:11], s41 offen offset:1024 sc1 lds
    buffer_load_dwordx4 v4, s[8:11], s41 offen offset:2048 sc1 lds
    buffer_load_dwordx4 v4, s[8:11], s41 offen offset:3072 sc1 lds
    s_add_u32 m0, s21, 86016
    s_add_u32 s41, s20, 4096
    buffer_load_dwordx4 v4, s[8:11], s41 offen offset:0 sc1 lds
    s_add_u32 m0, s21, 102400
    s_add_u32 s41, s20, 655360
    buffer_load_dwordx4 v4, s[8:11], s41 offen offset:0 sc1 lds
    buffer_load_dwordx4 v4, s[8:11], s41 offen offset:1024 sc1 lds
    buffer_load_dwordx4 v4, s[8:11], s41 offen offset:2048 sc1 lds
    buffer_load_dwordx4 v4, s[8:11], s41 offen offset:3072 sc1 lds
    s_add_u32 m0, s21, 106496
    s_add_u32 s41, s20, 659456
    buffer_load_dwordx4 v4, s[8:11], s41 offen offset:0 sc1 lds
    s_add_u32 m0, s21, 122880
    s_add_u32 s41, s20, 1310720
    buffer_load_dwordx4 v4, s[8:11], s41 offen offset:0 sc1 lds
    buffer_load_dwordx4 v4, s[8:11], s41 offen offset:1024 sc1 lds
    buffer_load_dwordx4 v4, s[8:11], s41 offen offset:2048 sc1 lds
    buffer_load_dwordx4 v4, s[8:11], s41 offen offset:3072 sc1 lds
    s_add_u32 m0, s21, 126976
    s_add_u32 s41, s20, 1314816
    buffer_load_dwordx4 v4, s[8:11], s41 offen offset:0 sc1 lds
L_p3_pf:
    s_bfe_u32 s4, s2, 0x20001
    s_lshl_b32 s4, s4, 2
    s_lshr_b32 s5, s2, 6
    s_add_u32 s4, s4, s5
    s_bfe_u32 s5, s2, 0x10005
    s_lshl_b32 s6, s4, 1
    s_add_u32 s5, s5, s6
    s_and_b32 s7, s2, 1
    s_bfe_u32 s6, s2, 0x20003
    s_lshl_b32 s36, s7, 2
    s_add_u32 s6, s6, s36
    s_bfe_u32 s36, s2, 0x30003
    s_lshl_b32 s7, s7, 3
    s_add_u32 s7, s7, s36
    s_lshl_b32 s52, s3, 4
    v_add_u32 v21, s52, v2
    s_mov_b32 s52, 40960
    v_mul_lo_u32 v23, v21, s52
    v_mul_u32_u24 v7, 40, v3
    v_add_u32 v23, v23, v7
    s_mul_i32 s38, s5, 1280
    s_mul_i32 s52, s6, 160
    s_add_u32 s38, s38, s52
    buffer_load_dwordx4 v[104:107], v23, s[12:15], s38 offen
    buffer_load_dwordx4 v[108:111], v23, s[12:15], s38 offen offset:16
    buffer_load_dwordx2 v[112:113], v23, s[12:15], s38 offen offset:32
    v_mul_u32_u24 v6, 13, v1
    v_lshrrev_b32 v6, 8, v6
    v_lshl_add_u32 v7, v6, 1, 2
    v_min_u32 v7, 5, v7
    v_mul_u32_u24 v7, 2560, v7
    v_mul_u32_u24 v6, 320, v6
    v_sub_u32 v22, v4, v6
    v_add_u32 v22, v22, v7
    v_lshrrev_b32 v13, 2, v2
    v_mul_u32_u24 v14, 5, v13
    v_and_b32 v12, 3, v2
    v_add_u32 v12, v12, v14
    v_add_u32 v14, 4, v14
    v_cvt_f32_u32 v13, v3
    v_mul_f32 v13, 4.0, v13
    s_mul_i32 s52, s6, 80
    s_and_b32 s53, s3, 1
    s_cselect_b32 s53, 0x3f35, 0
    s_cselect_b32 s54, 0, 0x3f80
    s_or_b32 s53, s53, s54
    v_lshl_add_u32 v65, v12, 2, s3
    v_add_u32 v64, s52, v65
    v_cvt_f32_u32 v64, v64
    v_cvt_f32_u32 v65, v65
    v_mul_f32 v64, 0x3acccccd, v64
    v_mul_f32 v65, 0x3ccccccd, v65
    v_mul_f32 v66, v13, v64
    v_and_b32 v12, 1, v12
    v_lshl_or_b32 v12, v12, 15, s53
    v_lshl_add_u32 v68, v14, 2, s3
    v_add_u32 v67, s52, v68
    v_cvt_f32_u32 v67, v67
    v_cvt_f32_u32 v68, v68
    v_mul_f32 v67, 0x3acccccd, v67
    v_mul_f32 v68, 0x3ccccccd, v68
    v_mul_f32 v69, v13, v67
    v_and_b32 v14, 1, v14
    v_lshl_or_b32 v14, v14, 15, s53
    s_mov_b32 s48, 0x40400000
    s_mov_b32 s58, 0x07060100
    s_mov_b32 s59, 0x07060302
    v_fma_f32 v72, 0, v65, v66
    v_fmamk_f32 v73, v64, 0x3f800000, v72
    v_fmamk_f32 v74, v64, 0x40000000, v72
    v_fmamk_f32 v75, v64, 0x40400000, v72
    v_sin_f32 v76, v72
    v_cos_f32 v72, v72
    v_sin_f32 v77, v73
    v_cos_f32 v73, v73
    v_sin_f32 v78, v74
    v_cos_f32 v74, v74
    v_sin_f32 v79, v75
    v_cos_f32 v75, v75
    v_cvt_pk_bf16_f32 v130, v76, v77
    v_cvt_pk_bf16_f32 v128, v72, v73
    v_cvt_pk_bf16_f32 v131, v78, v79
    v_cvt_pk_bf16_f32 v129, v74, v75
    v_fma_f32 v72, 0, v68, v69
    v_fmamk_f32 v73, v67, 0x3f800000, v72
    v_fmamk_f32 v74, v67, 0x40000000, v72
    v_fmamk_f32 v75, v67, 0x40400000, v72
    v_sin_f32 v76, v72
    v_cos_f32 v72, v72
    v_sin_f32 v77, v73
    v_cos_f32 v73, v73
    v_sin_f32 v78, v74
    v_cos_f32 v74, v74
    v_sin_f32 v79, v75
    v_cos_f32 v75, v75
    v_cvt_pk_bf16_f32 v134, v76, v77
    v_cvt_pk_bf16_f32 v132, v72, v73
    v_cvt_pk_bf16_f32 v135, v78, v79
    v_cvt_pk_bf16_f32 v133, v74, v75
    s_and_b32 s53, s2, 31
    s_lshl_b32 s53, s53, 7
    s_add_u32 s53, s53, 22450176
    v_mov_b32 v7, 0
    s_mov_b64 exec, 1
    buffer_atomic_add v7, v7, s[8:11], s53 offen sc0 sc1
    s_mov_b64 exec, -1
    v_fma_f32 v72, 1.0, v65, v66
    v_fmamk_f32 v73, v64, 0x3f800000, v72
    v_fmamk_f32 v74, v64, 0x40000000, v72
    v_fmamk_f32 v75, v64, 0x40400000, v72
    v_sin_f32 v76, v72
    v_cos_f32 v72, v72
    v_sin_f32 v77, v73
    v_cos_f32 v73, v73
    v_sin_f32 v78, v74
    v_cos_f32 v74, v74
    v_sin_f32 v79, v75
    v_cos_f32 v75, v75
    v_cvt_pk_bf16_f32 v138, v76, v77
    v_cvt_pk_bf16_f32 v136, v72, v73
    v_cvt_pk_bf16_f32 v139, v78, v79
    v_cvt_pk_bf16_f32 v137, v74, v75
    v_fma_f32 v72, 1.0, v68, v69
    v_fmamk_f32 v73, v67, 0x3f800000, v72
    v_fmamk_f32 v74, v67, 0x40000000, v72
    v_fmamk_f32 v75, v67, 0x40400000, v72
    v_sin_f32 v76, v72
    v_cos_f32 v72, v72
    v_sin_f32 v77, v73
    v_cos_f32 v73, v73
    v_sin_f32 v78, v74
    v_cos_f32 v74, v74
    v_sin_f32 v79, v75
    v_cos_f32 v75, v75
    v_cvt_pk_bf16_f32 v142, v76, v77
    v_cvt_pk_bf16_f32 v140, v72, v73
    v_cvt_pk_bf16_f32 v143, v78, v79
    v_cvt_pk_bf16_f32 v141, v74, v75
    v_fma_f32 v72, 2.0, v65, v66
    v_fmamk_f32 v73, v64, 0x3f800000, v72
    v_fmamk_f32 v74, v64, 0x40000000, v72
    v_fmamk_f32 v75, v64, 0x40400000, v72
    v_sin_f32 v76, v72
    v_cos_f32 v72, v72
    v_sin_f32 v77, v73
    v_cos_f32 v73, v73
    v_sin_f32 v78, v74
    v_cos_f32 v74, v74
    v_sin_f32 v79, v75
    v_cos_f32 v75, v75
    v_cvt_pk_bf16_f32 v146, v76, v77
    v_cvt_pk_bf16_f32 v144, v72, v73
    v_cvt_pk_bf16_f32 v147, v78, v79
    v_cvt_pk_bf16_f32 v145, v74, v75
    v_fma_f32 v72, 2.0, v68, v69
    v_fmamk_f32 v73, v67, 0x3f800000, v72
    v_fmamk_f32 v74, v67, 0x40000000, v72
    v_fmamk_f32 v75, v67, 0x40400000, v72
    v_sin_f32 v76, v72
    v_cos_f32 v72, v72
    v_sin_f32 v77, v73
    v_cos_f32 v73, v73
    v_sin_f32 v78, v74
    v_cos_f32 v74, v74
    v_sin_f32 v79, v75
    v_cos_f32 v75, v75
    v_cvt_pk_bf16_f32 v150, v76, v77
    v_cvt_pk_bf16_f32 v148, v72, v73
    v_cvt_pk_bf16_f32 v151, v78, v79
    v_cvt_pk_bf16_f32 v149, v74, v75
    s_waitcnt vmcnt(0)
    s_mov_b32 s56, 20000
    s_branch L_cc13c
L_cc13:
    s_sleep 2
    s_and_b32 s53, s2, 31
    s_lshl_b32 s53, s53, 7
    s_add_u32 s53, s53, 22450176
    v_mov_b32 v7, 0
    s_mov_b64 exec, 1
    buffer_atomic_add v7, v7, s[8:11], s53 offen sc0 sc1
    s_mov_b64 exec, -1
    s_waitcnt vmcnt(0)
L_cc13c:
    v_readfirstlane_b32 s54, v7
    s_sub_u32 s56, s56, 1
    s_cselect_b32 s54, 91, s54
    s_cmp_lt_u32 s54, 91
    s_cbranch_scc1 L_cc13
    s_mul_i32 s52, s6, 320
    s_add_u32 s52, s52, 21889024
    s_mov_b32 m0, 159104
    s_nop 0
    buffer_load_dwordx4 v22, s[8:11], s52 offen sc1 lds
    s_add_u32 s42, s26, 0
    buffer_load_dwordx4 a[160:163], v4, s[8:11], s42 offen offset:0 sc1
    buffer_load_dwordx4 a[164:167], v4, s[8:11], s42 offen offset:1024 sc1
    buffer_load_dwordx4 a[168:171], v4, s[8:11], s42 offen offset:2048 sc1
    buffer_load_dwordx4 a[172:175], v4, s[8:11], s42 offen offset:3072 sc1
    s_add_u32 s42, s26, 4096
    buffer_load_dwordx4 a[176:179], v4, s[8:11], s42 offen offset:0 sc1
    s_add_u32 s42, s26, 5120
    buffer_load_dwordx4 a[180:183], v4, s[8:11], s42 offen offset:0 sc1
    buffer_load_dwordx4 a[184:187], v4, s[8:11], s42 offen offset:1024 sc1
    v_fma_f32 v72, s48, v65, v66
    v_fmamk_f32 v73, v64, 0x3f800000, v72
    v_fmamk_f32 v74, v64, 0x40000000, v72
    v_fmamk_f32 v75, v64, 0x40400000, v72
    v_sin_f32 v76, v72
    v_cos_f32 v72, v72
    v_sin_f32 v77, v73
    v_cos_f32 v73, v73
    v_sin_f32 v78, v74
    v_cos_f32 v74, v74
    v_sin_f32 v79, v75
    v_cos_f32 v75, v75
    v_cvt_pk_bf16_f32 v154, v76, v77
    v_cvt_pk_bf16_f32 v152, v72, v73
    v_cvt_pk_bf16_f32 v155, v78, v79
    v_cvt_pk_bf16_f32 v153, v74, v75
    buffer_load_dwordx4 a[188:191], v4, s[8:11], s42 offen offset:2048 sc1
    buffer_load_dwordx4 a[192:195], v4, s[8:11], s42 offen offset:3072 sc1
    v_fma_f32 v72, s48, v68, v69
    v_fmamk_f32 v73, v67, 0x3f800000, v72
    v_fmamk_f32 v74, v67, 0x40000000, v72
    v_fmamk_f32 v75, v67, 0x40400000, v72
    v_sin_f32 v76, v72
    v_cos_f32 v72, v72
    v_sin_f32 v77, v73
    v_cos_f32 v73, v73
    v_sin_f32 v78, v74
    v_cos_f32 v74, v74
    v_sin_f32 v79, v75
    v_cos_f32 v75, v75
    v_cvt_pk_bf16_f32 v158, v76, v77
    v_cvt_pk_bf16_f32 v156, v72, v73
    v_cvt_pk_bf16_f32 v159, v78, v79
    v_cvt_pk_bf16_f32 v157, v74, v75
    s_add_u32 s42, s26, 9216
    buffer_load_dwordx4 a[196:199], v4, s[8:11], s42 offen offset:0 sc1
    s_add_u32 s42, s26, 40960
    buffer_load_dwordx4 a[200:203], v4, s[8:11], s42 offen offset:0 sc1
    v_fma_f32 v72, 4.0, v65, v66
    v_fmamk_f32 v73, v64, 0x3f800000, v72
    v_fmamk_f32 v74, v64, 0x40000000, v72
    v_fmamk_f32 v75, v64, 0x40400000, v72
    v_sin_f32 v76, v72
    v_cos_f32 v72, v72
    v_sin_f32 v77, v73
    v_cos_f32 v73, v73
    v_sin_f32 v78, v74
    v_cos_f32 v74, v74
    v_sin_f32 v79, v75
    v_cos_f32 v75, v75
    v_cvt_pk_bf16_f32 v162, v76, v77
    v_cvt_pk_bf16_f32 v160, v72, v73
    v_cvt_pk_bf16_f32 v163, v78, v79
    v_cvt_pk_bf16_f32 v161, v74, v75
    buffer_load_dwordx4 a[204:207], v4, s[8:11], s42 offen offset:1024 sc1
    buffer_load_dwordx4 a[208:211], v4, s[8:11], s42 offen offset:2048 sc1
    v_fma_f32 v72, 4.0, v68, v69
    v_fmamk_f32 v73, v67, 0x3f800000, v72
    v_fmamk_f32 v74, v67, 0x40000000, v72
    v_fmamk_f32 v75, v67, 0x40400000, v72
    v_sin_f32 v76, v72
    v_cos_f32 v72, v72
    v_sin_f32 v77, v73
    v_cos_f32 v73, v73
    v_sin_f32 v78, v74
    v_cos_f32 v74, v74
    v_sin_f32 v79, v75
    v_cos_f32 v75, v75
    v_cvt_pk_bf16_f32 v166, v76, v77
    v_cvt_pk_bf16_f32 v164, v72, v73
    v_cvt_pk_bf16_f32 v167, v78, v79
    v_cvt_pk_bf16_f32 v165, v74, v75
    buffer_load_dwordx4 a[212:215], v4, s[8:11], s42 offen offset:3072 sc1
    s_mov_b64 exec, 0xffff
    v_perm_b32 v130, v130, v12, s58
    v_perm_b32 v134, v134, v14, s58
    s_mov_b64 exec, -1
    v_sub_u32 v6, 0, v3
    v_xor_b32 v6, v6, v1
    v_and_b32 v6, 3, v6
    v_lshrrev_b32 v5, 2, v1
    v_lshlrev_b32 v5, 6, v5
    v_lshl_add_u32 v5, v6, 4, v5
    s_mul_i32 s44, s5, 82048
    s_mul_i32 s40, s3, 20480
    s_add_u32 s44, s44, 2686976
    s_add_u32 s44, s44, s40
    v_lshrrev_b32 v14, 2, v2
    v_sub_u32 v14, 0, v14
    v_xor_b32 v14, v14, v3
    v_and_b32 v14, 3, v14
    v_lshlrev_b32 v16, 6, v2
    v_lshl_add_u32 v16, v14, 4, v16
    v_add_u32 v16, s40, v16
    s_and_b32 s53, s2, 31
    s_lshl_b32 s53, s53, 7
    s_add_u32 s53, s53, 22454272
    v_mov_b32 v15, 0
    s_mov_b64 exec, 1
    buffer_atomic_add v15, v15, s[8:11], s53 offen sc0 sc1
    s_mov_b64 exec, -1
    s_nop 1
    v_lshlrev_b32 v6, 7, v1
    s_cmp_lg_u32 s3, 0
    s_cbranch_scc1 L_gi14
    v_mov_b32 v8, 24
    v_writelane_b32 v8, 21, 4
    v_writelane_b32 v8, 16, 5
    v_writelane_b32 v8, 16, 6
    v_writelane_b32 v8, 16, 7
    s_and_b32 s66, s2, 7
    s_lshl_b32 s66, s66, 10
    s_add_u32 s66, s66, 22437888
    s_mov_b64 exec, 0xff
    v_mov_b32 v7, 0
    buffer_atomic_add v7, v6, s[8:11], s66 offen sc0 sc1
    s_mov_b64 exec, -1
L_gi14:
    s_cmp_lg_u32 s3, 0
    s_cbranch_scc1 L_gw15x
    s_mov_b32 s52, 20000
    s_mov_b64 exec, 0xff
    s_branch L_gw15f
L_gw15:
    s_sleep 1
    v_mov_b32 v7, 0
    buffer_atomic_add v7, v6, s[8:11], s66 offen sc0 sc1
L_gw15f:
    s_waitcnt vmcnt(0)
    v_cmp_lt_u32 vcc, v7, v8
    s_sub_u32 s52, s52, 1
    s_cselect_b32 s54, 0, vcc_lo
    s_mov_b32 exec_lo, s54
    s_cmp_lg_u32 s54, 0
    s_cbranch_scc1 L_gw15
    s_mov_b64 exec, -1
L_gw15x:
    s_branch L_pg3c
.p2align 12
L_pg3:
    s_setpc_b64 s[60:61]
L_pg3c:
    s_barrier
    s_mov_b32 m0, s40
    s_nop 0
    buffer_load_dwordx4 v5, s[8:11], s44 offen offset:0 sc1 lds
    buffer_load_dwordx4 v5, s[8:11], s44 offen offset:1024 sc1 lds
    buffer_load_dwordx4 v5, s[8:11], s44 offen offset:2048 sc1 lds
    buffer_load_dwordx4 v5, s[8:11], s44 offen offset:3072 sc1 lds
    s_add_u32 s40, s40, 4096
    s_add_u32 s44, s44, 4096
    s_mov_b32 m0, s40
    s_nop 0
    buffer_load_dwordx4 v5, s[8:11], s44 offen offset:0 sc1 lds
    buffer_load_dwordx4 v5, s[8:11], s44 offen offset:1024 sc1 lds
    buffer_load_dwordx4 v5, s[8:11], s44 offen offset:2048 sc1 lds
    buffer_load_dwordx4 v5, s[8:11], s44 offen offset:3072 sc1 lds
    s_add_u32 s40, s40, 4096
    s_add_u32 s44, s44, 4096
    s_mov_b32 m0, s40
    s_nop 0
    buffer_load_dwordx4 v5, s[8:11], s44 offen offset:0 sc1 lds
    buffer_load_dwordx4 v5, s[8:11], s44 offen offset:1024 sc1 lds
    s_waitcnt vmcnt(25)
    v_mul_u32_u24 v8, 80, v3
    v_add_u32 v8, 159104, v8
    ds_read_b128 v[84:87], v8 offset:320
    ds_read_b128 v[64:67], v8 offset:0
    ds_read_b128 v[88:91], v8 offset:336
    ds_read_b128 v[68:71], v8 offset:16
    ds_read_b128 v[92:95], v8 offset:352
    ds_read_b128 v[72:75], v8 offset:32
    ds_read_b128 v[96:99], v8 offset:368
    ds_read_b128 v[76:79], v8 offset:48
    ds_read_b128 v[100:103], v8 offset:384
    ds_read_b128 v[80:83], v8 offset:64
    v_cvt_f32_u32 v14, v21
    v_mul_f32 v14, 0x3c800000, v14
    v_mul_f32 v9, 0.5, v13
    v_mul_f32 v9, v14, v9
    v_fmamk_f32 v32, v14, 0x00000000, v9
    v_fmamk_f32 v33, v14, 0x3f800000, v9
    v_fmamk_f32 v34, v14, 0x41000000, v9
    v_fmamk_f32 v35, v14, 0x41100000, v9
    v_sin_f32 v36, v32
    v_cos_f32 v32, v32
    buffer_load_dwordx4 v5, s[8:11], s44 offen offset:2048 sc1 lds
    v_sin_f32 v37, v33
    v_cos_f32 v33, v33
    v_sin_f32 v38, v34
    v_cos_f32 v34, v34
    v_sin_f32 v39, v35
    v_cos_f32 v35, v35
    v_cvt_pk_bf16_f32 v24, v32, -v36
    v_cvt_pk_bf16_f32 v25, v33, -v37
    v_cvt_pk_bf16_f32 v26, v34, -v38
    v_cvt_pk_bf16_f32 v27, v35, -v39
    buffer_load_dwordx4 v5, s[8:11], s44 offen offset:3072 sc1 lds
    v_fmamk_f32 v32, v14, 0x41800000, v9
    v_fmamk_f32 v33, v14, 0x41880000, v9
    v_fmamk_f32 v34, v14, 0x41c00000, v9
    v_fmamk_f32 v35, v14, 0x41c80000, v9
    v_sin_f32 v36, v32
    v_cos_f32 v32, v32
    v_sin_f32 v37, v33
    v_cos_f32 v33, v33
    v_sin_f32 v38, v34
    v_cos_f32 v34, v34
    s_add_u32 s40, s40, 4096
    s_add_u32 s44, s44, 4096
    s_mov_b32 m0, s40
    s_nop 0
    buffer_load_dwordx4 v5, s[8:11], s44 offen offset:0 sc1 lds
    v_sin_f32 v39, v35
    v_cos_f32 v35, v35
    v_cvt_pk_bf16_f32 v28, v32, -v36
    v_cvt_pk_bf16_f32 v29, v33, -v37
    v_cvt_pk_bf16_f32 v30, v34, -v38
    v_cvt_pk_bf16_f32 v31, v35, -v39
    v_lshlrev_b32 v14, 31, v2
    v_or_b32 v14, 0x3f803f80, v14
    s_mov_b32 s54, 0xffff
    s_mov_b32 s55, 0
    buffer_load_dwordx4 v5, s[8:11], s44 offen offset:1024 sc1 lds
    v_cndmask_b32 v24, v24, v14, s[54:55]
    v_lshlrev_b32 v228, 16, v104
    v_and_b32 v229, 0xffff0000, v104
    v_lshlrev_b32 v230, 16, v105
    v_and_b32 v231, 0xffff0000, v105
    v_lshlrev_b32 v232, 16, v106
    v_and_b32 v233, 0xffff0000, v106
    v_lshlrev_b32 v234, 16, v107
    v_and_b32 v235, 0xffff0000, v107
    v_lshlrev_b32 v236, 16, v108
    buffer_load_dwordx4 v5, s[8:11], s44 offen offset:2048 sc1 lds
    v_and_b32 v237, 0xffff0000, v108
    v_lshlrev_b32 v238, 16, v109
    v_and_b32 v239, 0xffff0000, v109
    v_lshlrev_b32 v240, 16, v110
    v_and_b32 v241, 0xffff0000, v110
    v_lshlrev_b32 v242, 16, v111
    v_and_b32 v243, 0xffff0000, v111
    v_lshlrev_b32 v244, 16, v112
    v_and_b32 v245, 0xffff0000, v112
    v_lshlrev_b32 v246, 16, v113
    buffer_load_dwordx4 v5, s[8:11], s44 offen offset:3072 sc1 lds
    v_and_b32 v247, 0xffff0000, v113
    s_mov_b32 s52, 0x35cccccd
    s_mov_b32 s53, 0x35cccccd
    s_waitcnt lgkmcnt(0)
    v_pk_mul_f32 v[104:105], v[228:229], v[84:85]
    v_pk_mul_f32 v[106:107], v[230:231], v[86:87]
    v_pk_mul_f32 v[108:109], v[232:233], v[88:89]
    v_pk_mul_f32 v[110:111], v[234:235], v[90:91]
    v_pk_mul_f32 v[112:113], v[236:237], v[92:93]
    v_pk_mul_f32 v[114:115], v[238:239], v[94:95]
    s_add_u32 s40, s40, 4096
    s_add_u32 s44, s44, 4096
    s_mov_b32 m0, s40
    s_nop 0
    buffer_load_dwordx4 v5, s[8:11], s44 offen offset:0 sc1 lds
    v_pk_mul_f32 v[116:117], v[240:241], v[96:97]
    v_pk_mul_f32 v[118:119], v[242:243], v[98:99]
    v_pk_mul_f32 v[120:121], v[244:245], v[100:101]
    v_pk_mul_f32 v[122:123], v[246:247], v[102:103]
    v_pk_mul_f32 v[64:65], v[64:65], s[52:53]
    v_pk_mul_f32 v[66:67], v[66:67], s[52:53]
    v_pk_mul_f32 v[68:69], v[68:69], s[52:53]
    v_pk_mul_f32 v[70:71], v[70:71], s[52:53]
    v_pk_mul_f32 v[72:73], v[72:73], s[52:53]
    v_pk_mul_f32 v[74:75], v[74:75], s[52:53]
    buffer_load_dwordx4 v5, s[8:11], s44 offen offset:1024 sc1 lds
    v_pk_mul_f32 v[76:77], v[76:77], s[52:53]
    v_pk_mul_f32 v[78:79], v[78:79], s[52:53]
    v_pk_mul_f32 v[80:81], v[80:81], s[52:53]
    v_pk_mul_f32 v[82:83], v[82:83], s[52:53]
    v_pk_mul_f32 v[84:85], v[84:85], v[64:65]
    v_pk_mul_f32 v[86:87], v[86:87], v[66:67]
    v_pk_mul_f32 v[88:89], v[88:89], v[68:69]
    v_pk_mul_f32 v[90:91], v[90:91], v[70:71]
    v_pk_mul_f32 v[92:93], v[92:93], v[72:73]
    v_pk_mul_f32 v[94:95], v[94:95], v[74:75]
    buffer_load_dwordx4 v5, s[8:11], s44 offen offset:2048 sc1 lds
    v_pk_mul_f32 v[96:97], v[96:97], v[76:77]
    v_pk_mul_f32 v[98:99], v[98:99], v[78:79]
    v_pk_mul_f32 v[100:101], v[100:101], v[80:81]
    v_pk_mul_f32 v[102:103], v[102:103], v[82:83]
    buffer_load_dwordx4 v5, s[8:11], s44 offen offset:3072 sc1 lds
    s_waitcnt vmcnt(20)
    s_mov_b32 s56, 20000
    s_branch L_cc16c
L_cc16:
    s_sleep 4
    s_and_b32 s53, s2, 31
    s_lshl_b32 s53, s53, 7
    s_add_u32 s53, s53, 22454272
    v_mov_b32 v15, 0
    s_mov_b64 exec, 1
    buffer_atomic_add v15, v15, s[8:11], s53 offen sc0 sc1
    s_mov_b64 exec, -1
    s_waitcnt vmcnt(0)
L_cc16c:
    v_readfirstlane_b32 s54, v15
    s_sub_u32 s56, s56, 1
    s_cselect_b32 s54, 54, s54
    s_cmp_lt_u32 s54, 54
    s_cbranch_scc1 L_cc16
    v_and_b32 v17, 1, v3
    s_lshl_b32 s52, s3, 1
    v_add_u32 v17, s52, v17
    v_lshlrev_b32 v22, 12, v17
    v_lshl_add_u32 v22, v2, 4, v22
    v_lshrrev_b32 v8, 5, v1
    s_mov_b32 s52, 110592
    v_mad_u32_u24 v22, v8, s52, v22
    s_lshl_b32 s52, s7, 8
    s_add_u32 s52, s52, 21954560
    buffer_load_dwordx4 a[144:147], v22, s[8:11], s52 offen sc1
    s_add_u32 s52, s52, 27648
    buffer_load_dwordx4 a[148:151], v22, s[8:11], s52 offen sc1
    s_add_u32 s52, s52, 27648
    buffer_load_dwordx4 a[152:155], v22, s[8:11], s52 offen sc1
    s_add_u32 s52, s52, 27648
    buffer_load_dwordx4 a[156:159], v22, s[8:11], s52 offen sc1
    s_barrier
    s_waitcnt vmcnt(20)
    ds_read_b128 a[0:3], v16 offset:0
    ds_read_b128 a[4:7], v16 offset:1024
    ds_read_b128 a[8:11], v16 offset:2048
    ds_read_b128 a[12:15], v16 offset:3072
    s_waitcnt vmcnt(16)
    ds_read_b128 a[16:19], v16 offset:4096
    ds_read_b128 a[20:23], v16 offset:5120
    ds_read_b128 a[24:27], v16 offset:6144
    ds_read_b128 a[28:31], v16 offset:7168
    s_waitcnt lgkmcnt(4)
    v_mfma_f32_16x16x32_bf16 v[32:35], a[0:3], v[128:131], 0
    s_lshl_b32 s52, s3, 12
    v_mfma_f32_16x16x32_bf16 v[48:51], a[0:3], v[132:135], 0
    s_add_u32 s52, s52, 143360
    v_mfma_f32_16x16x32_bf16 v[36:39], a[4:7], v[128:131], 0
    v_add_u32 v18, s52, v4
    v_mfma_f32_16x16x32_bf16 v[52:55], a[4:7], v[132:135], 0
    v_add_u32 v19, 143360, v4
    v_mfma_f32_16x16x32_bf16 v[40:43], a[8:11], v[128:131], 0
    s_lshr_b32 s22, s3, 1
    v_mfma_f32_16x16x32_bf16 v[56:59], a[8:11], v[132:135], 0
    s_lshl_b32 s52, s5, 1
    v_mfma_f32_16x16x32_bf16 v[44:47], a[12:15], v[128:131], 0
    s_add_u32 s22, s22, s52
    v_mfma_f32_16x16x32_bf16 v[60:63], a[12:15], v[132:135], 0
    s_and_b32 s52, s3, 1
    s_waitcnt vmcnt(12)
    ds_read_b128 a[32:35], v16 offset:8192
    ds_read_b128 a[36:39], v16 offset:9216
    ds_read_b128 a[40:43], v16 offset:10240
    ds_read_b128 a[44:47], v16 offset:11264
    s_waitcnt lgkmcnt(4)
    v_mfma_f32_16x16x32_bf16 v[32:35], a[16:19], v[136:139], v[32:35]
    s_lshl_b32 s52, s52, 4
    v_mfma_f32_16x16x32_bf16 v[48:51], a[16:19], v[140:143], v[48:51]
    v_add_u32 v10, s52, v2
    v_mfma_f32_16x16x32_bf16 v[36:39], a[20:23], v[136:139], v[36:39]
    v_lshlrev_b32 v11, 4, v10
    v_mfma_f32_16x16x32_bf16 v[52:55], a[20:23], v[140:143], v[52:55]
    v_lshl_add_u32 v12, v3, 10, v11
    v_mfma_f32_16x16x32_bf16 v[40:43], a[24:27], v[136:139], v[40:43]
    v_lshrrev_b32 v20, 1, v3
    v_mfma_f32_16x16x32_bf16 v[56:59], a[24:27], v[140:143], v[56:59]
    v_lshl_add_u32 v20, v20, 9, v11
    v_mfma_f32_16x16x32_bf16 v[44:47], a[28:31], v[136:139], v[44:47]
    v_and_b32 v14, 1, v3
    v_mfma_f32_16x16x32_bf16 v[60:63], a[28:31], v[140:143], v[60:63]
    v_lshl_add_u32 v20, v14, 3, v20
    s_waitcnt vmcnt(8)
    ds_read_b128 a[48:51], v16 offset:12288
    ds_read_b128 a[52:55], v16 offset:13312
    ds_read_b128 a[56:59], v16 offset:14336
    ds_read_b128 a[60:63], v16 offset:15360
    s_waitcnt lgkmcnt(4)
    v_mfma_f32_16x16x32_bf16 v[32:35], a[32:35], v[144:147], v[32:35]
    v_lshlrev_b32 v10, 3, v10
    v_mfma_f32_16x16x32_bf16 v[48:51], a[32:35], v[148:151], v[48:51]
    s_mul_i32 s46, s22, 40960
    v_mfma_f32_16x16x32_bf16 v[36:39], a[36:39], v[144:147], v[36:39]
    s_mul_i32 s47, s6, 5120
    v_mfma_f32_16x16x32_bf16 v[52:55], a[36:39], v[148:151], v[52:55]
    s_add_u32 s46, s46, s47
    v_mfma_f32_16x16x32_bf16 v[40:43], a[40:43], v[144:147], v[40:43]
    s_add_u32 s46, s46, 12189696
    v_mfma_f32_16x16x32_bf16 v[56:59], a[40:43], v[148:151], v[56:59]
    s_add_u32 s47, s46, 4096
    v_mfma_f32_16x16x32_bf16 v[44:47], a[44:47], v[144:147], v[44:47]
    s_lshl_b32 s48, s22, 11
    v_mfma_f32_16x16x32_bf16 v[60:63], a[44:47], v[148:151], v[60:63]
    s_lshl_b32 s52, s6, 8
    s_waitcnt vmcnt(4)
    ds_read_b128 a[64:67], v16 offset:16384
    ds_read_b128 a[68:71], v16 offset:17408
    ds_read_b128 a[72:75], v16 offset:18432
    ds_read_b128 a[76:79], v16 offset:19456
    s_waitcnt lgkmcnt(4)
    v_mfma_f32_16x16x32_bf16 v[32:35], a[48:51], v[152:155], v[32:35]
    s_add_u32 s48, s48, s52
    v_mfma_f32_16x16x32_bf16 v[48:51], a[48:51], v[156:159], v[48:51]
    s_add_u32 s48, s48, 22216704
    v_mfma_f32_16x16x32_bf16 v[36:39], a[52:55], v[152:155], v[36:39]
    s_lshl_b32 s31, s22, 8
    v_mfma_f32_16x16x32_bf16 v[52:55], a[52:55], v[156:159], v[52:55]
    s_add_u32 s31, s31, 22347776
    v_mfma_f32_16x16x32_bf16 v[40:43], a[56:59], v[152:155], v[40:43]
    v_mov_b32 v13, 0
    v_mfma_f32_16x16x32_bf16 v[56:59], a[56:59], v[156:159], v[56:59]
    v_mov_b32 v14, 1
    v_mfma_f32_16x16x32_bf16 v[44:47], a[60:63], v[152:155], v[44:47]
    v_mfma_f32_16x16x32_bf16 v[60:63], a[60:63], v[156:159], v[60:63]
    s_waitcnt lgkmcnt(0)
    v_mfma_f32_16x16x32_bf16 v[32:35], a[64:67], v[160:163], v[32:35]
    v_mfma_f32_16x16x32_bf16 v[48:51], a[64:67], v[164:167], v[48:51]
    v_mfma_f32_16x16x32_bf16 v[36:39], a[68:71], v[160:163], v[36:39]
    v_mfma_f32_16x16x32_bf16 v[52:55], a[68:71], v[164:167], v[52:55]
    v_mfma_f32_16x16x32_bf16 v[40:43], a[72:75], v[160:163], v[40:43]
    v_mfma_f32_16x16x32_bf16 v[56:59], a[72:75], v[164:167], v[56:59]
    v_mfma_f32_16x16x32_bf16 v[44:47], a[76:79], v[160:163], v[44:47]
    v_mfma_f32_16x16x32_bf16 v[60:63], a[76:79], v[164:167], v[60:63]
    s_add_u32 s42, s26, 45056
    buffer_load_dwordx4 a[216:219], v4, s[8:11], s42 offen offset:0 sc1
    s_add_u32 s42, s26, 46080
    buffer_load_dwordx4 a[220:223], v4, s[8:11], s42 offen offset:0 sc1
    buffer_load_dwordx4 a[224:227], v4, s[8:11], s42 offen offset:1024 sc1
    buffer_load_dwordx4 a[228:231], v4, s[8:11], s42 offen offset:2048 sc1
    buffer_load_dwordx4 a[232:235], v4, s[8:11], s42 offen offset:3072 sc1
    s_add_u32 s42, s26, 50176
    buffer_load_dwordx4 a[236:239], v4, s[8:11], s42 offen offset:0 sc1
    v_cvt_pk_bf16_f32 v128, v32, v33
    v_cvt_pk_bf16_f32 v129, v34, v35
    v_cvt_pk_bf16_f32 v130, v36, v37
    v_cvt_pk_bf16_f32 v131, v38, v39
    ds_write_b128 v18, v[128:131] offset:0
    v_cvt_pk_bf16_f32 v136, v48, v49
    v_cvt_pk_bf16_f32 v137, v50, v51
    v_cvt_pk_bf16_f32 v138, v52, v53
    v_cvt_pk_bf16_f32 v139, v54, v55
    ds_write_b128 v18, v[136:139] offset:2048
    v_cvt_pk_bf16_f32 v132, v40, v41
    v_cvt_pk_bf16_f32 v133, v42, v43
    v_cvt_pk_bf16_f32 v134, v44, v45
    v_cvt_pk_bf16_f32 v135, v46, v47
    ds_write_b128 v18, v[132:135] offset:1024
    v_cvt_pk_bf16_f32 v140, v56, v57
    v_cvt_pk_bf16_f32 v141, v58, v59
    v_cvt_pk_bf16_f32 v142, v60, v61
    v_cvt_pk_bf16_f32 v143, v62, v63
    ds_write_b128 v18, v[140:143] offset:3072
    s_waitcnt lgkmcnt(0)
    s_barrier
    ds_read_b128 a[80:83], v19 offset:0
    ds_read_b128 a[84:87], v19 offset:1024
    ds_read_b128 a[96:99], v19 offset:4096
    ds_read_b128 a[100:103], v19 offset:5120
    ds_read_b128 a[112:115], v19 offset:8192
    ds_read_b128 a[116:119], v19 offset:9216
    ds_read_b128 a[128:131], v19 offset:12288
    ds_read_b128 a[132:135], v19 offset:13312
    ds_read_b128 a[88:91], v19 offset:2048
    ds_read_b128 a[92:95], v19 offset:3072
    ds_read_b128 a[104:107], v19 offset:6144
    ds_read_b128 a[108:111], v19 offset:7168
    ds_read_b128 a[120:123], v19 offset:10240
    ds_read_b128 a[124:127], v19 offset:11264
    ds_read_b128 a[136:139], v19 offset:14336
    ds_read_b128 a[140:143], v19 offset:15360
    s_waitcnt lgkmcnt(14)
    v_mfma_f32_16x16x32_bf16 v[32:35], a[80:83], v[24:27], 0
    v_mfma_f32_16x16x32_bf16 v[32:35], a[84:87], v[28:31], v[32:35]
    s_add_u32 m0, s21, 0
    s_add_u32 s41, s20, 20480
    buffer_load_dwordx4 v4, s[8:11], s41 offen offset:0 sc1 lds
    s_waitcnt lgkmcnt(12)
    v_mfma_f32_16x16x32_bf16 v[40:43], a[96:99], v[24:27], 0
    v_mfma_f32_16x16x32_bf16 v[40:43], a[100:103], v[28:31], v[40:43]
    buffer_load_dwordx4 v4, s[8:11], s41 offen offset:1024 sc1 lds
    s_waitcnt lgkmcnt(10)
    v_mfma_f32_16x16x32_bf16 v[48:51], a[112:115], v[24:27], 0
    v_mfma_f32_16x16x32_bf16 v[48:51], a[116:119], v[28:31], v[48:51]
    buffer_load_dwordx4 v4, s[8:11], s41 offen offset:2048 sc1 lds
    s_waitcnt lgkmcnt(8)
    v_mfma_f32_16x16x32_bf16 v[56:59], a[128:131], v[24:27], 0
    v_mfma_f32_16x16x32_bf16 v[56:59], a[132:135], v[28:31], v[56:59]
    buffer_load_dwordx4 v4, s[8:11], s41 offen offset:3072 sc1 lds
    s_waitcnt lgkmcnt(6)
    v_mfma_f32_16x16x32_bf16 v[36:39], a[88:91], v[24:27], 0
    v_mfma_f32_16x16x32_bf16 v[36:39], a[92:95], v[28:31], v[36:39]
    s_add_u32 m0, s21, 4096
    s_add_u32 s41, s20, 24576
    buffer_load_dwordx4 v4, s[8:11], s41 offen offset:0 sc1 lds
    s_waitcnt lgkmcnt(4)
    v_mfma_f32_16x16x32_bf16 v[44:47], a[104:107], v[24:27], 0
    v_mfma_f32_16x16x32_bf16 v[44:47], a[108:111], v[28:31], v[44:47]
    s_waitcnt lgkmcnt(2)
    v_mfma_f32_16x16x32_bf16 v[52:55], a[120:123], v[24:27], 0
    v_mfma_f32_16x16x32_bf16 v[52:55], a[124:127], v[28:31], v[52:55]
    s_waitcnt lgkmcnt(0)
    v_mfma_f32_16x16x32_bf16 v[60:63], a[136:139], v[24:27], 0
    v_mfma_f32_16x16x32_bf16 v[60:63], a[140:143], v[28:31], v[60:63]
    v_fmac_f32 v104, v84, v32
    v_fmac_f32 v105, v85, v40
    v_fmac_f32 v106, v86, v48
    v_fmac_f32 v107, v87, v56
    v_fmac_f32 v108, v88, v33
    v_fmac_f32 v109, v89, v41
    v_fmac_f32 v110, v90, v49
    v_fmac_f32 v111, v91, v57
    v_fmac_f32 v112, v92, v34
    v_fmac_f32 v113, v93, v42
    v_fmac_f32 v114, v94, v50
    v_fmac_f32 v115, v95, v58
    v_fmac_f32 v116, v96, v35
    v_fmac_f32 v117, v97, v43
    v_fmac_f32 v118, v98, v51
    v_fmac_f32 v119, v99, v59
    v_cvt_pk_bf16_f32 v128, v104, v105
    v_cvt_pk_bf16_f32 v129, v106, v107
    v_cvt_pk_bf16_f32 v130, v108, v109
    v_cvt_pk_bf16_f32 v131, v110, v111
    buffer_store_dwordx4 v[128:131], v12, s[8:11], s46 offen sc1
    v_cvt_pk_bf16_f32 v132, v112, v113
    v_cvt_pk_bf16_f32 v133, v114, v115
    v_cvt_pk_bf16_f32 v134, v116, v117
    v_cvt_pk_bf16_f32 v135, v118, v119
    buffer_store_dwordx4 v[132:135], v12, s[8:11], s46 offen offset:512 sc1
    v_fmac_f32 v120, v100, v36
    v_fmac_f32 v121, v101, v44
    v_fmac_f32 v122, v102, v52
    v_fmac_f32 v123, v103, v60
    v_cvt_pk_bf16_f32 v136, v120, v121
    v_cvt_pk_bf16_f32 v137, v122, v123
    buffer_store_dwordx2 v[136:137], v20, s[8:11], s47 offen sc1
    v_fmac_f32 v228, v64, v32
    v_fmac_f32 v229, v65, v40
    v_fmac_f32 v230, v66, v48
    v_fmac_f32 v231, v67, v56
    v_fmac_f32 v232, v68, v33
    v_fmac_f32 v233, v69, v41
    v_fmac_f32 v234, v70, v49
    v_fmac_f32 v235, v71, v57
    v_fmac_f32 v236, v72, v34
    v_fmac_f32 v237, v73, v42
    v_fmac_f32 v238, v74, v50
    v_fmac_f32 v239, v75, v58
    v_fmac_f32 v240, v76, v35
    v_fmac_f32 v241, v77, v43
    v_fmac_f32 v242, v78, v51
    v_fmac_f32 v243, v79, v59
    v_fmac_f32 v244, v80, v36
    v_fmac_f32 v245, v81, v44
    v_fmac_f32 v246, v82, v52
    v_fmac_f32 v247, v83, v60
    v_pk_add_f32 v[6:7], v[228:229], v[230:231]
    v_pk_mul_f32 v[8:9], v[228:229], v[228:229]
    v_pk_fma_f32 v[8:9], v[230:231], v[230:231], v[8:9]
    v_pk_add_f32 v[6:7], v[6:7], v[232:233]
    v_pk_fma_f32 v[8:9], v[232:233], v[232:233], v[8:9]
    v_pk_add_f32 v[6:7], v[6:7], v[234:235]
    v_pk_fma_f32 v[8:9], v[234:235], v[234:235], v[8:9]
    v_pk_add_f32 v[6:7], v[6:7], v[236:237]
    v_pk_fma_f32 v[8:9], v[236:237], v[236:237], v[8:9]
    v_pk_add_f32 v[6:7], v[6:7], v[238:239]
    v_pk_fma_f32 v[8:9], v[238:239], v[238:239], v[8:9]
    v_pk_add_f32 v[6:7], v[6:7], v[240:241]
    v_pk_fma_f32 v[8:9], v[240:241], v[240:241], v[8:9]
    v_pk_add_f32 v[6:7], v[6:7], v[242:243]
    v_pk_fma_f32 v[8:9], v[242:243], v[242:243], v[8:9]
    v_pk_add_f32 v[6:7], v[6:7], v[244:245]
    v_pk_fma_f32 v[8:9], v[244:245], v[244:245], v[8:9]
    v_pk_add_f32 v[6:7], v[6:7], v[246:247]
    v_pk_fma_f32 v[8:9], v[246:247], v[246:247], v[8:9]
    v_add_f32 v6, v6, v7
    v_add_f32 v7, v8, v9
    v_mov_b32 v8, v6
    v_mov_b32 v9, v7
    s_nop 0
    v_permlane32_swap_b32 v6, v8
    v_permlane32_swap_b32 v7, v9
    v_pk_add_f32 v[6:7], v[6:7], v[8:9]
    v_mov_b32 v8, v6
    v_mov_b32 v9, v7
    s_nop 0
    v_permlane16_swap_b32 v6, v8
    v_permlane16_swap_b32 v7, v9
    v_pk_add_f32 v[6:7], v[6:7], v[8:9]
    s_mov_b64 exec, 0xffff
    buffer_store_dwordx2 v[6:7], v10, s[8:11], s48 offen sc1
    s_mov_b64 exec, -1
    s_add_u32 m0, s21, 20480
    s_add_u32 s41, s20, 675840
    buffer_load_dwordx4 v4, s[8:11], s41 offen offset:0 sc1 lds
    buffer_load_dwordx4 v4, s[8:11], s41 offen offset:1024 sc1 lds
    buffer_load_dwordx4 v4, s[8:11], s41 offen offset:2048 sc1 lds
    buffer_load_dwordx4 v4, s[8:11], s41 offen offset:3072 sc1 lds
    s_add_u32 m0, s21, 24576
    s_add_u32 s41, s20, 679936
    buffer_load_dwordx4 v4, s[8:11], s41 offen offset:0 sc1 lds
    v_cvt_pk_bf16_f32 v255, v246, v247
    v_cvt_pk_bf16_f32 v254, v244, v245
    v_cvt_pk_bf16_f32 v253, v242, v243
    v_cvt_pk_bf16_f32 v252, v240, v241
    v_cvt_pk_bf16_f32 v251, v238, v239
    v_cvt_pk_bf16_f32 v250, v236, v237
    v_cvt_pk_bf16_f32 v249, v234, v235
    v_cvt_pk_bf16_f32 v248, v232, v233
    v_cvt_pk_bf16_f32 v247, v230, v231
    v_cvt_pk_bf16_f32 v246, v228, v229
    v_mov_b32 v245, v23
    s_lshl_b32 s23, s4, 2
    s_add_u32 s23, s23, s3
    s_lshl_b32 s32, s23, 8
    s_add_u32 s32, s32, 22347776
    s_mul_i32 s25, s23, 40960
    s_add_u32 s25, s25, 12189696
    s_waitcnt vmcnt(6)
    s_mov_b64 exec, 1
    buffer_atomic_add v14, v13, s[8:11], s31 offen sc1
    s_mov_b64 exec, -1
    s_add_u32 m0, s21, 40960
    s_add_u32 s41, s20, 1331200
    buffer_load_dwordx4 v4, s[8:11], s41 offen offset:0 sc1 lds
    buffer_load_dwordx4 v4, s[8:11], s41 offen offset:1024 sc1 lds
    buffer_load_dwordx4 v4, s[8:11], s41 offen offset:2048 sc1 lds
    buffer_load_dwordx4 v4, s[8:11], s41 offen offset:3072 sc1 lds
    s_add_u32 m0, s21, 45056
    s_add_u32 s41, s20, 1335296
    buffer_load_dwordx4 v4, s[8:11], s41 offen offset:0 sc1 lds
    s_add_u32 m0, s21, 61440
    s_add_u32 s41, s20, 1966080
    buffer_load_dwordx4 v4, s[8:11], s41 offen offset:0 sc1 lds
    buffer_load_dwordx4 v4, s[8:11], s41 offen offset:1024 sc1 lds
    buffer_load_dwordx4 v4, s[8:11], s41 offen offset:2048 sc1 lds
    buffer_load_dwordx4 v4, s[8:11], s41 offen offset:3072 sc1 lds
    s_add_u32 m0, s21, 65536
    s_add_u32 s41, s20, 1970176
    buffer_load_dwordx4 v4, s[8:11], s41 offen offset:0 sc1 lds
    s_mul_i32 s24, s23, 108
    s_add_u32 s24, s24, s7
    s_lshl_b32 s24, s24, 10
    s_add_u32 s24, s24, 14811136
    s_lshr_b32 s52, s23, 1
    s_lshl_b32 s52, s52, 2
    s_lshr_b32 s53, s7, 2
    s_add_u32 s52, s52, s53
    s_lshl_b32 s33, s52, 9
    s_add_u32 s33, s33, 22364160
    s_lshl_b32 s34, s5, 11
    s_add_u32 s34, s34, 22364160
    s_min_u32 s53, s3, 2
    s_lshl_b32 s53, s53, 9
    s_lshl_b32 s52, s3, 9
    v_mov_b32 v5, s52
    v_writelane_b32 v5, s53, 1
    s_mul_i32 s27, s5, 221184
    s_lshl_b32 s52, s3, 12
    s_add_u32 s27, s27, s52
    s_add_u32 s27, s27, 14811136
    s_sub_u32 s29, s27, s29
    v_lshlrev_b32 v6, 9, v3
    v_lshl_add_u32 v6, v2, 4, v6
    s_add_u32 s52, s3, 0
    s_bfe_u32 s53, s52, 0x10001
    s_mul_i32 s53, s53, 110592
    s_and_b32 s52, s52, 1
    s_lshl_b32 s52, s52, 8
    s_add_u32 s52, s52, s53
    v_add_u32 v240, s52, v6
    s_add_u32 s52, s3, 1
    s_bfe_u32 s53, s52, 0x10001
    s_mul_i32 s53, s53, 110592
    s_and_b32 s52, s52, 1
    s_lshl_b32 s52, s52, 8
    s_add_u32 s52, s52, s53
    v_add_u32 v241, s52, v6
    s_add_u32 s52, s3, 2
    s_bfe_u32 s53, s52, 0x10001
    s_mul_i32 s53, s53, 110592
    s_and_b32 s52, s52, 1
    s_lshl_b32 s52, s52, 8
    s_add_u32 s52, s52, s53
    v_add_u32 v242, s52, v6
    s_add_u32 s52, s3, 3
    s_bfe_u32 s53, s52, 0x10001
    s_mul_i32 s53, s53, 110592
    s_and_b32 s52, s52, 1
    s_lshl_b32 s52, s52, 8
    s_add_u32 s52, s52, s53
    v_add_u32 v243, s52, v6
    v_lshrrev_b32 v7, 5, v1
    v_and_b32 v8, 31, v1
    v_lshlrev_b32 v6, 3, v8
    v_lshl_add_u32 v6, v7, 10, v6
    v_lshlrev_b32 v7, 4, v8
    v_add_u32 v7, 160128, v7
    v_add_u32 v11, 61440, v4
    v_add_u32 v12, 122880, v4
    s_waitcnt vmcnt(16)
    s_mov_b64 exec, 1
    buffer_atomic_add v14, v13, s[8:11], s31 offen offset:128 sc1
    s_mov_b64 exec, -1
    v_accvgpr_read_b32 v64, a144
    v_accvgpr_read_b32 v65, a145
    v_accvgpr_read_b32 v66, a146
    v_accvgpr_read_b32 v67, a147
    v_accvgpr_read_b32 v68, a148
    v_accvgpr_read_b32 v69, a149
    v_accvgpr_read_b32 v70, a150
    v_accvgpr_read_b32 v71, a151
    v_accvgpr_read_b32 v72, a152
    v_accvgpr_read_b32 v73, a153
    v_accvgpr_read_b32 v74, a154
    v_accvgpr_read_b32 v75, a155
    v_accvgpr_read_b32 v76, a156
    v_accvgpr_read_b32 v77, a157
    v_accvgpr_read_b32 v78, a158
    v_accvgpr_read_b32 v79, a159
    v_pk_add_f32 v[64:65], v[64:65], v[68:69]
    v_pk_add_f32 v[72:73], v[72:73], v[76:77]
    v_pk_add_f32 v[66:67], v[66:67], v[70:71]
    v_pk_add_f32 v[74:75], v[74:75], v[78:79]
    v_pk_add_f32 v[64:65], v[64:65], v[72:73]
    v_pk_add_f32 v[66:67], v[66:67], v[74:75]
    v_mov_b32 v68, v64
    v_mov_b32 v69, v65
    v_mov_b32 v70, v66
    v_mov_b32 v71, v67
    v_permlane32_swap_b32 v64, v68
    v_permlane32_swap_b32 v65, v69
    v_permlane32_swap_b32 v66, v70
    v_permlane32_swap_b32 v67, v71
    v_pk_add_f32 v[64:65], v[64:65], v[68:69]
    v_pk_add_f32 v[66:67], v[66:67], v[70:71]
    s_mov_b32 s52, 0x05040100
    v_cvt_pk_bf16_f32 v73, v64, v65
    v_lshlrev_b32 v68, 16, v73
    v_and_b32 v69, 0xffff0000, v73
    v_pk_add_f32 v[68:69], v[64:65], v[68:69] neg_lo:[0,1] neg_hi:[0,1]
    v_cvt_pk_bf16_f32 v68, v68, v69
    v_perm_b32 v72, v68, v73, s52
    v_perm_b32 v74, v73, v68, s59
    v_mov_b32 v75, 0
    v_cvt_pk_bf16_f32 v77, v66, v67
    v_lshlrev_b32 v68, 16, v77
    v_and_b32 v69, 0xffff0000, v77
    v_pk_add_f32 v[68:69], v[66:67], v[68:69] neg_lo:[0,1] neg_hi:[0,1]
    v_cvt_pk_bf16_f32 v68, v68, v69
    v_perm_b32 v76, v68, v77, s52
    v_perm_b32 v78, v77, v68, s59
    v_mov_b32 v79, 0
    v_lshlrev_b32 v10, 9, v17
    v_lshl_add_u32 v10, v2, 5, v10
    v_add_u32 v10, 160128, v10
    s_cmp_eq_u32 s3, 3
    s_cselect_b32 exec_lo, 0xffff, -1
    s_mov_b32 exec_hi, 0
    ds_write_b128 v10, v[72:75]
    ds_write_b128 v10, v[76:79] offset:16
    s_mov_b64 exec, -1
    ds_read_b128 v[16:19], v11 offset:20480
    ds_read_b128 v[20:23], v11 offset:40960
    ds_read_b128 v[24:27], v12 offset:0
    s_branch L_pg4c
.p2align 12
L_pg4:
    s_setpc_b64 s[60:61]
L_pg4c:
    ds_read_b128 v[28:31], v11 offset:21504
    ds_read_b128 v[32:35], v11 offset:41984
    ds_read_b128 v[36:39], v12 offset:1024
    s_mov_b32 s52, 20000
    s_mov_b64 exec, 1
    s_branch L_l3_paf
L_l3_pa:
    s_sleep 1
L_l3_paf:
    v_mov_b32 v15, 0
    buffer_atomic_add v15, v13, s[8:11], s32 offen sc0 sc1
    s_waitcnt vmcnt(0)
    v_readfirstlane_b32 s53, v15
    s_sub_u32 s52, s52, 1
    s_cselect_b32 s53, 16, s53
    s_cmp_lt_u32 s53, 16
    s_cbranch_scc1 L_l3_pa
    s_mov_b64 exec, -1
    buffer_load_dwordx4 a[0:3], v4, s[8:11], s25 offen offset:0 sc1
    buffer_load_dwordx4 a[4:7], v4, s[8:11], s25 offen offset:1024 sc1
    buffer_load_dwordx4 a[8:11], v4, s[8:11], s25 offen offset:2048 sc1
    buffer_load_dwordx4 a[12:15], v4, s[8:11], s25 offen offset:3072 sc1
    s_add_u32 s25, s25, 4096
    buffer_load_dwordx4 a[16:19], v4, s[8:11], s25 offen offset:0 sc1
    buffer_load_dwordx4 a[20:23], v4, s[8:11], s25 offen offset:1024 sc1
    buffer_load_dwordx4 a[24:27], v4, s[8:11], s25 offen offset:2048 sc1
    buffer_load_dwordx4 a[28:31], v4, s[8:11], s25 offen offset:3072 sc1
    s_add_u32 s25, s25, 4096
    buffer_load_dwordx4 a[32:35], v4, s[8:11], s25 offen offset:0 sc1
    buffer_load_dwordx4 a[36:39], v4, s[8:11], s25 offen offset:1024 sc1
    buffer_load_dwordx4 a[40:43], v4, s[8:11], s25 offen offset:2048 sc1
    buffer_load_dwordx4 a[44:47], v4, s[8:11], s25 offen offset:3072 sc1
    s_add_u32 s25, s25, 4096
    buffer_load_dwordx4 a[48:51], v4, s[8:11], s25 offen offset:0 sc1
    buffer_load_dwordx4 a[52:55], v4, s[8:11], s25 offen offset:1024 sc1
    ds_read_b128 v[40:43], v11 offset:22528
    ds_read_b128 v[44:47], v11 offset:43008
    s_waitcnt vmcnt(13)
    s_waitcnt lgkmcnt(6)
    v_mfma_f32_32x32x16_bf16 v[48:63], v[16:19], a[0:3], 0
    buffer_load_dwordx4 a[56:59], v4, s[8:11], s25 offen offset:2048 sc1
    v_mfma_f32_32x32x16_bf16 v[64:79], v[20:23], a[0:3], 0
    ds_read_b128 v[16:19], v12 offset:2048
    ds_read_b128 v[20:23], v11 offset:23552
    s_waitcnt lgkmcnt(6)
    v_mfma_f32_32x32x16_bf16 v[80:95], v[24:27], a[0:3], 0
    s_waitcnt vmcnt(13)
    v_mfma_f32_32x32x16_bf16 v[48:63], v[28:31], a[4:7], v[48:63]
    buffer_load_dwordx4 a[60:63], v4, s[8:11], s25 offen offset:3072 sc1
    ds_read_b128 v[24:27], v11 offset:44032
    ds_read_b128 v[28:31], v12 offset:3072
    s_waitcnt lgkmcnt(6)
    v_mfma_f32_32x32x16_bf16 v[64:79], v[32:35], a[4:7], v[64:79]
    v_mfma_f32_32x32x16_bf16 v[80:95], v[36:39], a[4:7], v[80:95]
    ds_read_b128 v[32:35], v11 offset:24576
    ds_read_b128 v[36:39], v11 offset:45056
    s_waitcnt vmcnt(13)
    s_waitcnt lgkmcnt(6)
    v_mfma_f32_32x32x16_bf16 v[48:63], v[40:43], a[8:11], v[48:63]
    s_add_u32 s25, s25, 4096
    buffer_load_dwordx4 a[64:67], v4, s[8:11], s25 offen offset:0 sc1
    v_mfma_f32_32x32x16_bf16 v[64:79], v[44:47], a[8:11], v[64:79]
    ds_read_b128 v[40:43], v12 offset:4096
    ds_read_b128 v[44:47], v11 offset:25600
    s_waitcnt lgkmcnt(6)
    v_mfma_f32_32x32x16_bf16 v[80:95], v[16:19], a[8:11], v[80:95]
    s_waitcnt vmcnt(13)
    v_mfma_f32_32x32x16_bf16 v[48:63], v[20:23], a[12:15], v[48:63]
    buffer_load_dwordx4 a[68:71], v4, s[8:11], s25 offen offset:1024 sc1
    ds_read_b128 v[16:19], v11 offset:46080
    ds_read_b128 v[20:23], v12 offset:5120
    s_waitcnt lgkmcnt(6)
    v_mfma_f32_32x32x16_bf16 v[64:79], v[24:27], a[12:15], v[64:79]
    v_mfma_f32_32x32x16_bf16 v[80:95], v[28:31], a[12:15], v[80:95]
    ds_read_b128 v[24:27], v11 offset:26624
    ds_read_b128 v[28:31], v11 offset:47104
    s_waitcnt vmcnt(13)
    s_waitcnt lgkmcnt(6)
    v_mfma_f32_32x32x16_bf16 v[48:63], v[32:35], a[16:19], v[48:63]
    buffer_load_dwordx4 a[72:75], v4, s[8:11], s25 offen offset:2048 sc1
    v_mfma_f32_32x32x16_bf16 v[64:79], v[36:39], a[16:19], v[64:79]
    ds_read_b128 v[32:35], v12 offset:6144
    ds_read_b128 v[36:39], v11 offset:27648
    s_waitcnt lgkmcnt(6)
    v_mfma_f32_32x32x16_bf16 v[80:95], v[40:43], a[16:19], v[80:95]
    s_waitcnt vmcnt(13)
    v_mfma_f32_32x32x16_bf16 v[48:63], v[44:47], a[20:23], v[48:63]
    buffer_load_dwordx4 a[76:79], v4, s[8:11], s25 offen offset:3072 sc1
    ds_read_b128 v[40:43], v11 offset:48128
    ds_read_b128 v[44:47], v12 offset:7168
    s_waitcnt lgkmcnt(6)
    v_mfma_f32_32x32x16_bf16 v[64:79], v[16:19], a[20:23], v[64:79]
    v_mfma_f32_32x32x16_bf16 v[80:95], v[20:23], a[20:23], v[80:95]
    ds_read_b128 v[16:19], v11 offset:28672
    ds_read_b128 v[20:23], v11 offset:49152
    s_waitcnt vmcnt(13)
    s_waitcnt lgkmcnt(6)
    v_mfma_f32_32x32x16_bf16 v[48:63], v[24:27], a[24:27], v[48:63]
    s_add_u32 s25, s25, 4096
    buffer_load_dwordx4 a[80:83], v4, s[8:11], s25 offen offset:0 sc1
    v_mfma_f32_32x32x16_bf16 v[64:79], v[28:31], a[24:27], v[64:79]
    ds_read_b128 v[24:27], v12 offset:8192
    ds_read_b128 v[28:31], v11 offset:29696
    s_waitcnt lgkmcnt(6)
    v_mfma_f32_32x32x16_bf16 v[80:95], v[32:35], a[24:27], v[80:95]
    s_waitcnt vmcnt(13)
    v_mfma_f32_32x32x16_bf16 v[48:63], v[36:39], a[28:31], v[48:63]
    buffer_load_dwordx4 a[84:87], v4, s[8:11], s25 offen offset:1024 sc1
    ds_read_b128 v[32:35], v11 offset:50176
    ds_read_b128 v[36:39], v12 offset:9216
    s_waitcnt lgkmcnt(6)
    v_mfma_f32_32x32x16_bf16 v[64:79], v[40:43], a[28:31], v[64:79]
    v_mfma_f32_32x32x16_bf16 v[80:95], v[44:47], a[28:31], v[80:95]
    ds_read_b128 v[40:43], v11 offset:30720
    ds_read_b128 v[44:47], v11 offset:51200
    s_waitcnt vmcnt(13)
    s_waitcnt lgkmcnt(6)
    v_mfma_f32_32x32x16_bf16 v[48:63], v[16:19], a[32:35], v[48:63]
    buffer_load_dwordx4 a[88:91], v4, s[8:11], s25 offen offset:2048 sc1
    v_mfma_f32_32x32x16_bf16 v[64:79], v[20:23], a[32:35], v[64:79]
    ds_read_b128 v[16:19], v12 offset:10240
    ds_read_b128 v[20:23], v11 offset:31744
    s_waitcnt lgkmcnt(6)
    v_mfma_f32_32x32x16_bf16 v[80:95], v[24:27], a[32:35], v[80:95]
    s_waitcnt vmcnt(13)
    v_mfma_f32_32x32x16_bf16 v[48:63], v[28:31], a[36:39], v[48:63]
    buffer_load_dwordx4 a[92:95], v4, s[8:11], s25 offen offset:3072 sc1
    ds_read_b128 v[24:27], v11 offset:52224
    ds_read_b128 v[28:31], v12 offset:11264
    s_waitcnt lgkmcnt(6)
    v_mfma_f32_32x32x16_bf16 v[64:79], v[32:35], a[36:39], v[64:79]
    v_mfma_f32_32x32x16_bf16 v[80:95], v[36:39], a[36:39], v[80:95]
    ds_read_b128 v[32:35], v11 offset:32768
    ds_read_b128 v[36:39], v11 offset:53248
    s_waitcnt vmcnt(13)
    s_waitcnt lgkmcnt(6)
    v_mfma_f32_32x32x16_bf16 v[48:63], v[40:43], a[40:43], v[48:63]
    s_add_u32 s25, s25, 4096
    buffer_load_dwordx4 a[96:99], v4, s[8:11], s25 offen offset:0 sc1
    v_mfma_f32_32x32x16_bf16 v[64:79], v[44:47], a[40:43], v[64:79]
    ds_read_b128 v[40:43], v12 offset:12288
    ds_read_b128 v[44:47], v11 offset:33792
    s_waitcnt lgkmcnt(6)
    v_mfma_f32_32x32x16_bf16 v[80:95], v[16:19], a[40:43], v[80:95]
    s_waitcnt vmcnt(13)
    v_mfma_f32_32x32x16_bf16 v[48:63], v[20:23], a[44:47], v[48:63]
    buffer_load_dwordx4 a[100:103], v4, s[8:11], s25 offen offset:1024 sc1
    ds_read_b128 v[16:19], v11 offset:54272
    ds_read_b128 v[20:23], v12 offset:13312
    s_waitcnt lgkmcnt(6)
    v_mfma_f32_32x32x16_bf16 v[64:79], v[24:27], a[44:47], v[64:79]
    v_mfma_f32_32x32x16_bf16 v[80:95], v[28:31], a[44:47], v[80:95]
    ds_read_b128 v[24:27], v11 offset:34816
    ds_read_b128 v[28:31], v11 offset:55296
    s_waitcnt vmcnt(13)
    s_waitcnt lgkmcnt(6)
    v_mfma_f32_32x32x16_bf16 v[48:63], v[32:35], a[48:51], v[48:63]
    buffer_load_dwordx4 a[104:107], v4, s[8:11], s25 offen offset:2048 sc1
    v_mfma_f32_32x32x16_bf16 v[64:79], v[36:39], a[48:51], v[64:79]
    ds_read_b128 v[32:35], v12 offset:14336
    ds_read_b128 v[36:39], v11 offset:35840
    s_waitcnt lgkmcnt(6)
    v_mfma_f32_32x32x16_bf16 v[80:95], v[40:43], a[48:51], v[80:95]
    s_waitcnt vmcnt(13)
    v_mfma_f32_32x32x16_bf16 v[48:63], v[44:47], a[52:55], v[48:63]
    buffer_load_dwordx4 a[108:111], v4, s[8:11], s25 offen offset:3072 sc1
    s_barrier
    ds_read_b128 v[40:43], v11 offset:56320
    ds_read_b128 v[44:47], v12 offset:15360
    s_waitcnt lgkmcnt(6)
    v_mfma_f32_32x32x16_bf16 v[64:79], v[16:19], a[52:55], v[64:79]
    v_mfma_f32_32x32x16_bf16 v[80:95], v[20:23], a[52:55], v[80:95]
    ds_read_b128 v[16:19], v11 offset:36864
    ds_read_b128 v[20:23], v11 offset:57344
    s_waitcnt vmcnt(13)
    s_waitcnt lgkmcnt(6)
    v_mfma_f32_32x32x16_bf16 v[48:63], v[24:27], a[56:59], v[48:63]
    s_add_u32 s25, s25, 4096
    buffer_load_dwordx4 a[112:115], v4, s[8:11], s25 offen offset:0 sc1
    v_mfma_f32_32x32x16_bf16 v[64:79], v[28:31], a[56:59], v[64:79]
    ds_read_b128 v[24:27], v12 offset:16384
    ds_read_b128 v[28:31], v11 offset:37888
    s_waitcnt lgkmcnt(6)
    v_mfma_f32_32x32x16_bf16 v[80:95], v[32:35], a[56:59], v[80:95]
    s_waitcnt vmcnt(13)
    v_mfma_f32_32x32x16_bf16 v[48:63], v[36:39], a[60:63], v[48:63]
    buffer_load_dwordx4 a[116:119], v4, s[8:11], s25 offen offset:1024 sc1
    ds_read_b128 v[32:35], v11 offset:58368
    ds_read_b128 v[36:39], v12 offset:17408
    s_waitcnt lgkmcnt(6)
    v_mfma_f32_32x32x16_bf16 v[64:79], v[40:43], a[60:63], v[64:79]
    v_mfma_f32_32x32x16_bf16 v[80:95], v[44:47], a[60:63], v[80:95]
    ds_read_b128 v[40:43], v11 offset:38912
    ds_read_b128 v[44:47], v11 offset:59392
    s_waitcnt vmcnt(13)
    s_waitcnt lgkmcnt(6)
    v_mfma_f32_32x32x16_bf16 v[48:63], v[16:19], a[64:67], v[48:63]
    buffer_load_dwordx4 a[120:123], v4, s[8:11], s25 offen offset:2048 sc1
    v_mfma_f32_32x32x16_bf16 v[64:79], v[20:23], a[64:67], v[64:79]
    ds_read_b128 v[16:19], v12 offset:18432
    ds_read_b128 v[20:23], v11 offset:39936
    s_waitcnt lgkmcnt(6)
    v_mfma_f32_32x32x16_bf16 v[80:95], v[24:27], a[64:67], v[80:95]
    s_waitcnt vmcnt(13)
    v_mfma_f32_32x32x16_bf16 v[48:63], v[28:31], a[68:71], v[48:63]
    buffer_load_dwordx4 a[124:127], v4, s[8:11], s25 offen offset:3072 sc1
    ds_read_b128 v[24:27], v11 offset:60416
    ds_read_b128 v[28:31], v12 offset:19456
    s_waitcnt lgkmcnt(6)
    v_mfma_f32_32x32x16_bf16 v[64:79], v[32:35], a[68:71], v[64:79]
    v_mfma_f32_32x32x16_bf16 v[80:95], v[36:39], a[68:71], v[80:95]
    ds_read_b128 v[32:35], v4 offset:0
    ds_read_b128 v[36:39], v4 offset:20480
    s_waitcnt vmcnt(13)
    s_waitcnt lgkmcnt(6)
    v_mfma_f32_32x32x16_bf16 v[48:63], v[40:43], a[72:75], v[48:63]
    s_add_u32 s25, s25, 4096
    buffer_load_dwordx4 a[128:131], v4, s[8:11], s25 offen offset:0 sc1
    v_mfma_f32_32x32x16_bf16 v[64:79], v[44:47], a[72:75], v[64:79]
    ds_read_b128 v[40:43], v4 offset:40960
    ds_read_b128 v[44:47], v4 offset:1024
    s_waitcnt lgkmcnt(6)
    v_mfma_f32_32x32x16_bf16 v[80:95], v[16:19], a[72:75], v[80:95]
    s_waitcnt vmcnt(13)
    v_mfma_f32_32x32x16_bf16 v[48:63], v[20:23], a[76:79], v[48:63]
    buffer_load_dwordx4 a[132:135], v4, s[8:11], s25 offen offset:1024 sc1
    ds_read_b128 v[16:19], v4 offset:21504
    ds_read_b128 v[20:23], v4 offset:41984
    s_waitcnt lgkmcnt(6)
    v_mfma_f32_32x32x16_bf16 v[64:79], v[24:27], a[76:79], v[64:79]
    v_mfma_f32_32x32x16_bf16 v[80:95], v[28:31], a[76:79], v[80:95]
    s_barrier
    ds_read_b128 v[24:27], v4 offset:2048
    ds_read_b128 v[28:31], v4 offset:22528
    s_waitcnt vmcnt(13)
    s_waitcnt lgkmcnt(6)
    v_mfma_f32_32x32x16_bf16 v[48:63], v[32:35], a[80:83], v[48:63]
    buffer_load_dwordx4 a[136:139], v4, s[8:11], s25 offen offset:2048 sc1
    v_mfma_f32_32x32x16_bf16 v[64:79], v[36:39], a[80:83], v[64:79]
    v_mov_b32 v15, 0
    s_mov_b64 exec, 1
    buffer_atomic_add v15, v13, s[8:11], s32 offen offset:128 sc0 sc1
    s_mov_b64 exec, -1
    ds_read_b128 v[32:35], v4 offset:43008
    ds_read_b128 v[36:39], v4 offset:3072
    s_waitcnt lgkmcnt(6)
    v_mfma_f32_32x32x16_bf16 v[80:95], v[40:43], a[80:83], v[80:95]
    s_waitcnt vmcnt(14)
    v_mfma_f32_32x32x16_bf16 v[48:63], v[44:47], a[84:87], v[48:63]
    buffer_load_dwordx4 a[140:143], v4, s[8:11], s25 offen offset:3072 sc1
    ds_read_b128 v[40:43], v4 offset:23552
    ds_read_b128 v[44:47], v4 offset:44032
    s_waitcnt lgkmcnt(6)
    v_mfma_f32_32x32x16_bf16 v[64:79], v[16:19], a[84:87], v[64:79]
    v_mfma_f32_32x32x16_bf16 v[80:95], v[20:23], a[84:87], v[80:95]
    ds_read_b128 v[16:19], v4 offset:4096
    ds_read_b128 v[20:23], v4 offset:24576
    s_waitcnt vmcnt(14)
    s_waitcnt lgkmcnt(6)
    v_mfma_f32_32x32x16_bf16 v[48:63], v[24:27], a[88:91], v[48:63]
    s_add_u32 s25, s25, 4096
    buffer_load_dwordx4 a[144:147], v4, s[8:11], s25 offen offset:0 sc1
    v_mfma_f32_32x32x16_bf16 v[64:79], v[28:31], a[88:91], v[64:79]
    ds_read_b128 v[24:27], v4 offset:45056
    ds_read_b128 v[28:31], v4 offset:5120
    s_waitcnt lgkmcnt(6)
    v_mfma_f32_32x32x16_bf16 v[80:95], v[32:35], a[88:91], v[80:95]
    s_waitcnt vmcnt(14)
    v_mfma_f32_32x32x16_bf16 v[48:63], v[36:39], a[92:95], v[48:63]
    buffer_load_dwordx4 a[148:151], v4, s[8:11], s25 offen offset:1024 sc1
    ds_read_b128 v[32:35], v4 offset:25600
    ds_read_b128 v[36:39], v4 offset:46080
    s_waitcnt lgkmcnt(6)
    v_mfma_f32_32x32x16_bf16 v[64:79], v[40:43], a[92:95], v[64:79]
    v_mfma_f32_32x32x16_bf16 v[80:95], v[44:47], a[92:95], v[80:95]
    ds_read_b128 v[40:43], v4 offset:6144
    ds_read_b128 v[44:47], v4 offset:26624
    s_waitcnt vmcnt(14)
    s_waitcnt lgkmcnt(6)
    v_mfma_f32_32x32x16_bf16 v[48:63], v[16:19], a[96:99], v[48:63]
    buffer_load_dwordx4 a[152:155], v4, s[8:11], s25 offen offset:2048 sc1
    v_mfma_f32_32x32x16_bf16 v[64:79], v[20:23], a[96:99], v[64:79]
    ds_read_b128 v[16:19], v4 offset:47104
    ds_read_b128 v[20:23], v4 offset:7168
    s_waitcnt lgkmcnt(6)
    v_mfma_f32_32x32x16_bf16 v[80:95], v[24:27], a[96:99], v[80:95]
    s_waitcnt vmcnt(14)
    v_mfma_f32_32x32x16_bf16 v[48:63], v[28:31], a[100:103], v[48:63]
    buffer_load_dwordx4 a[156:159], v4, s[8:11], s25 offen offset:3072 sc1
    s_waitcnt vmcnt(5)
    s_mov_b32 s52, 20000
L_l3_pc0:
    v_cmp_gt_u32 vcc, 16, v15
    s_sub_u32 s52, s52, 1
    s_cselect_b32 s53, 0, vcc_lo
    s_and_b32 s53, s53, 1
    s_cbranch_scc0 L_l3_ok0
    s_sleep 1
    v_mov_b32 v15, 0
    s_mov_b64 exec, 1
    buffer_atomic_add v15, v13, s[8:11], s32 offen offset:128 sc0 sc1
    s_mov_b64 exec, -1
    s_waitcnt vmcnt(0)
    s_branch L_l3_pc0
L_l3_ok0:
    ds_read_b128 v[24:27], v4 offset:27648
    ds_read_b128 v[28:31], v4 offset:48128
    s_waitcnt lgkmcnt(6)
    v_mfma_f32_32x32x16_bf16 v[64:79], v[32:35], a[100:103], v[64:79]
    v_mfma_f32_32x32x16_bf16 v[80:95], v[36:39], a[100:103], v[80:95]
    ds_read_b128 v[32:35], v4 offset:8192
    ds_read_b128 v[36:39], v4 offset:28672
    s_waitcnt lgkmcnt(6)
    v_mfma_f32_32x32x16_bf16 v[48:63], v[40:43], a[104:107], v[48:63]
    s_lshl_b32 s52, s23, 11
    s_add_u32 s52, s52, 22216704
    buffer_load_dwordx2 v[96:97], v6, s[8:11], s52 offen offset:0 sc1
    buffer_load_dwordx2 v[98:99], v6, s[8:11], s52 offen offset:256 sc1
    buffer_load_dwordx2 v[100:101], v6, s[8:11], s52 offen offset:512 sc1
    buffer_load_dwordx2 v[102:103], v6, s[8:11], s52 offen offset:768 sc1
    v_mfma_f32_32x32x16_bf16 v[64:79], v[44:47], a[104:107], v[64:79]
    ds_read_b128 v[40:43], v4 offset:49152
    ds_read_b128 v[44:47], v4 offset:9216
    s_waitcnt lgkmcnt(6)
    v_mfma_f32_32x32x16_bf16 v[80:95], v[16:19], a[104:107], v[80:95]
    s_add_u32 m0, s21, 81920
    s_add_u32 s41, s20, 1986560
    buffer_load_dwordx4 v4, s[8:11], s41 offen offset:0 sc1 lds
    v_mfma_f32_32x32x16_bf16 v[48:63], v[20:23], a[108:111], v[48:63]
    ds_read_b128 v[16:19], v4 offset:29696
    ds_read_b128 v[20:23], v4 offset:50176
    s_waitcnt lgkmcnt(6)
    v_mfma_f32_32x32x16_bf16 v[64:79], v[24:27], a[108:111], v[64:79]
    v_mfma_f32_32x32x16_bf16 v[80:95], v[28:31], a[108:111], v[80:95]
    buffer_load_dwordx4 v4, s[8:11], s41 offen offset:1024 sc1 lds
    ds_read_b128 v[24:27], v4 offset:10240
    ds_read_b128 v[28:31], v4 offset:30720
    s_waitcnt lgkmcnt(6)
    v_mfma_f32_32x32x16_bf16 v[48:63], v[32:35], a[112:115], v[48:63]
    v_mfma_f32_32x32x16_bf16 v[64:79], v[36:39], a[112:115], v[64:79]
    buffer_load_dwordx4 v4, s[8:11], s41 offen offset:2048 sc1 lds
    ds_read_b128 v[32:35], v4 offset:51200
    ds_read_b128 v[36:39], v4 offset:11264
    s_waitcnt lgkmcnt(6)
    v_mfma_f32_32x32x16_bf16 v[80:95], v[40:43], a[112:115], v[80:95]
    v_mfma_f32_32x32x16_bf16 v[48:63], v[44:47], a[116:119], v[48:63]
    ds_read_b128 v[40:43], v4 offset:31744
    ds_read_b128 v[44:47], v4 offset:52224
    s_waitcnt lgkmcnt(6)
    v_mfma_f32_32x32x16_bf16 v[64:79], v[16:19], a[116:119], v[64:79]
    buffer_load_dwordx4 v4, s[8:11], s41 offen offset:3072 sc1 lds
    v_mfma_f32_32x32x16_bf16 v[80:95], v[20:23], a[116:119], v[80:95]
    ds_read_b128 v[16:19], v4 offset:12288
    ds_read_b128 v[20:23], v4 offset:32768
    s_waitcnt lgkmcnt(6)
    v_mfma_f32_32x32x16_bf16 v[48:63], v[24:27], a[120:123], v[48:63]
    s_add_u32 m0, s21, 86016
    s_add_u32 s41, s20, 1990656
    buffer_load_dwordx4 v4, s[8:11], s41 offen offset:0 sc1 lds
    v_mfma_f32_32x32x16_bf16 v[64:79], v[28:31], a[120:123], v[64:79]
    ds_read_b128 v[24:27], v4 offset:53248
    ds_read_b128 v[28:31], v4 offset:13312
    s_waitcnt lgkmcnt(6)
    v_mfma_f32_32x32x16_bf16 v[80:95], v[32:35], a[120:123], v[80:95]
    v_mfma_f32_32x32x16_bf16 v[48:63], v[36:39], a[124:127], v[48:63]
    s_add_u32 m0, s21, 102400
    s_add_u32 s41, s20, 2621440
    buffer_load_dwordx4 v4, s[8:11], s41 offen offset:0 sc1 lds
    ds_read_b128 v[32:35], v4 offset:33792
    ds_read_b128 v[36:39], v4 offset:54272
    s_waitcnt lgkmcnt(6)
    v_mfma_f32_32x32x16_bf16 v[64:79], v[40:43], a[124:127], v[64:79]
    v_mfma_f32_32x32x16_bf16 v[80:95], v[44:47], a[124:127], v[80:95]
    buffer_load_dwordx4 v4, s[8:11], s41 offen offset:1024 sc1 lds
    ds_read_b128 v[40:43], v4 offset:14336
    ds_read_b128 v[44:47], v4 offset:34816
    s_waitcnt lgkmcnt(6)
    v_mfma_f32_32x32x16_bf16 v[48:63], v[16:19], a[128:131], v[48:63]
    v_mfma_f32_32x32x16_bf16 v[64:79], v[20:23], a[128:131], v[64:79]
    ds_read_b128 v[16:19], v4 offset:55296
    ds_read_b128 v[20:23], v4 offset:15360
    s_waitcnt lgkmcnt(6)
    v_mfma_f32_32x32x16_bf16 v[80:95], v[24:27], a[128:131], v[80:95]
    buffer_load_dwordx4 v4, s[8:11], s41 offen offset:2048 sc1 lds
    v_mfma_f32_32x32x16_bf16 v[48:63], v[28:31], a[132:135], v[48:63]
    ds_read_b128 v[24:27], v4 offset:35840
    ds_read_b128 v[28:31], v4 offset:56320
    s_waitcnt lgkmcnt(6)
    v_mfma_f32_32x32x16_bf16 v[64:79], v[32:35], a[132:135], v[64:79]
    buffer_load_dwordx4 v4, s[8:11], s41 offen offset:3072 sc1 lds
    s_waitcnt vmcnt(9)
    v_add_f32 v96, v96, v98
    v_mfma_f32_32x32x16_bf16 v[80:95], v[36:39], a[132:135], v[80:95]
    v_add_f32 v97, v97, v99
    ds_read_b128 v[32:35], v4 offset:16384
    ds_read_b128 v[36:39], v4 offset:36864
    s_waitcnt lgkmcnt(6)
    v_mfma_f32_32x32x16_bf16 v[48:63], v[40:43], a[136:139], v[48:63]
    v_add_f32 v100, v100, v102
    v_add_f32 v101, v101, v103
    v_add_f32 v8, v96, v100
    v_add_f32 v9, v97, v101
    v_mfma_f32_32x32x16_bf16 v[64:79], v[44:47], a[136:139], v[64:79]
    s_add_u32 m0, s21, 106496
    s_add_u32 s41, s20, 2625536
    buffer_load_dwordx4 v4, s[8:11], s41 offen offset:0 sc1 lds
    ds_read_b128 v[40:43], v4 offset:57344
    ds_read_b128 v[44:47], v4 offset:17408
    s_waitcnt lgkmcnt(6)
    v_mfma_f32_32x32x16_bf16 v[80:95], v[16:19], a[136:139], v[80:95]
    v_mov_b32 v96, v8
    v_mov_b32 v97, v9
    s_mov_b32 s52, 0x01000100
    s_mov_b32 s53, 0x07060100
    v_mfma_f32_32x32x16_bf16 v[48:63], v[20:23], a[140:143], v[48:63]
    s_add_u32 m0, s21, 122880
    s_add_u32 s41, s20, 2641920
    buffer_load_dwordx4 v4, s[8:11], s41 offen offset:0 sc1 lds
    ds_read_b128 v[16:19], v4 offset:37888
    ds_read_b128 v[20:23], v4 offset:58368
    s_waitcnt lgkmcnt(6)
    v_mfma_f32_32x32x16_bf16 v[64:79], v[24:27], a[140:143], v[64:79]
    v_permlane32_swap_b32 v8, v96
    v_permlane32_swap_b32 v9, v97
    v_add_f32 v8, v8, v96
    v_add_f32 v9, v9, v97
    v_mfma_f32_32x32x16_bf16 v[80:95], v[28:31], a[140:143], v[80:95]
    v_mul_f32 v8, 0xbacccccd, v8
    ds_read_b128 v[24:27], v4 offset:18432
    ds_read_b128 v[28:31], v4 offset:38912
    s_waitcnt lgkmcnt(6)
    v_mfma_f32_32x32x16_bf16 v[48:63], v[32:35], a[144:147], v[48:63]
    buffer_load_dwordx4 v4, s[8:11], s41 offen offset:1024 sc1 lds
    v_mul_f32 v9, 0x3acccccd, v9
    v_fma_f32 v9, -v8, v8, v9
    v_mfma_f32_32x32x16_bf16 v[64:79], v[36:39], a[144:147], v[64:79]
    v_max_f32 v9, 0, v9
    ds_read_b128 v[32:35], v4 offset:59392
    ds_read_b128 v[36:39], v4 offset:19456
    s_waitcnt lgkmcnt(6)
    v_mfma_f32_32x32x16_bf16 v[80:95], v[40:43], a[144:147], v[80:95]
    buffer_load_dwordx4 v4, s[8:11], s41 offen offset:2048 sc1 lds
    v_add_f32 v9, 0x3727c5ac, v9
    v_sqrt_f32 v96, v9
    v_mfma_f32_32x32x16_bf16 v[48:63], v[44:47], a[148:151], v[48:63]
    v_rcp_f32 v9, v9
    ds_read_b128 v[40:43], v4 offset:39936
    ds_read_b128 v[44:47], v4 offset:60416
    s_waitcnt lgkmcnt(6)
    v_mfma_f32_32x32x16_bf16 v[64:79], v[16:19], a[148:151], v[64:79]
    v_cvt_pk_bf16_f32 v97, v8, v96
    v_lshlrev_b32 v98, 16, v97
    v_and_b32 v99, 0xffff0000, v97
    v_sub_f32 v98, v8, v98
    v_mfma_f32_32x32x16_bf16 v[80:95], v[20:23], a[148:151], v[80:95]
    buffer_load_dwordx4 v4, s[8:11], s41 offen offset:3072 sc1 lds
    ds_read_b128 v[16:19], v7 offset:0
    ds_read_b128 v[20:23], v7 offset:512
    s_waitcnt lgkmcnt(6)
    v_mfma_f32_32x32x16_bf16 v[48:63], v[24:27], a[152:155], v[48:63]
    v_sub_f32 v99, v96, v99
    v_cvt_pk_bf16_f32 v98, v98, v99
    v_perm_b32 v112, v97, v97, s52
    v_perm_b32 v113, v97, v98, s53
    v_mfma_f32_32x32x16_bf16 v[64:79], v[28:31], a[152:155], v[64:79]
    s_add_u32 m0, s21, 126976
    s_add_u32 s41, s20, 2646016
    buffer_load_dwordx4 v4, s[8:11], s41 offen offset:0 sc1 lds
    ds_read_b128 v[24:27], v7 offset:1024
    ds_read_b128 v[28:31], v11 offset:0
    s_waitcnt lgkmcnt(6)
    v_mfma_f32_32x32x16_bf16 v[80:95], v[32:35], a[152:155], v[80:95]
    v_perm_b32 v114, v98, v97, s59
    v_mov_b32 v115, 0
    s_mov_b32 exec_lo, 0
    v_mov_b32 v112, 0
    v_mov_b32 v113, 0
    v_mov_b32 v114, 0
    s_mov_b64 exec, -1
    v_mfma_f32_32x32x16_bf16 v[48:63], v[36:39], a[156:159], v[48:63]
    ds_read_b128 v[32:35], v11 offset:1024
    ds_read_b128 v[36:39], v11 offset:2048
    s_waitcnt lgkmcnt(6)
    v_mfma_f32_32x32x16_bf16 v[64:79], v[40:43], a[156:159], v[64:79]
    s_add_u32 s42, s26, 81920
    buffer_load_dwordx4 a[240:243], v4, s[8:11], s42 offen offset:0 sc1
    v_mfma_f32_32x32x16_bf16 v[80:95], v[44:47], a[156:159], v[80:95]
    ds_read_b128 v[40:43], v11 offset:3072
    ds_read_b128 v[44:47], v11 offset:4096
    s_waitcnt lgkmcnt(6)
    v_mfma_f32_32x32x16_bf16 v[48:63], v[16:19], v[112:115], v[48:63]
    buffer_load_dwordx4 a[244:247], v4, s[8:11], s42 offen offset:1024 sc1
    v_mfma_f32_32x32x16_bf16 v[64:79], v[20:23], v[112:115], v[64:79]
    ds_read_b128 v[16:19], v11 offset:5120
    ds_read_b128 v[20:23], v11 offset:6144
    s_waitcnt lgkmcnt(6)
    v_mfma_f32_32x32x16_bf16 v[80:95], v[24:27], v[112:115], v[80:95]
    v_mfma_f32_32x32x16_bf16 v[96:111], v[28:31], a[0:3], 0
    buffer_load_dwordx4 a[248:251], v4, s[8:11], s42 offen offset:2048 sc1
    s_waitcnt vmcnt(13)
    s_barrier
    ds_read_b128 v[24:27], v11 offset:7168
    ds_read_b128 v[28:31], v11 offset:8192
    s_waitcnt lgkmcnt(6)
    v_mfma_f32_32x32x16_bf16 v[96:111], v[32:35], a[4:7], v[96:111]
    v_mfma_f32_32x32x16_bf16 v[96:111], v[36:39], a[8:11], v[96:111]
    s_add_u32 m0, s21, 0
    s_add_u32 s41, s20, 3276800
    buffer_load_dwordx4 v4, s[8:11], s41 offen offset:0 sc1 lds
    ds_read_b128 v[32:35], v11 offset:9216
    ds_read_b128 v[36:39], v11 offset:10240
    s_waitcnt lgkmcnt(6)
    v_mfma_f32_32x32x16_bf16 v[96:111], v[40:43], a[12:15], v[96:111]
    v_mul_f32 v48, v48, v56
    v_mul_f32 v49, v49, v57
    v_mul_f32 v50, v50, v58
    v_mul_f32 v51, v51, v59
    v_mfma_f32_32x32x16_bf16 v[96:111], v[44:47], a[16:19], v[96:111]
    v_mul_f32 v52, v52, v60
    ds_read_b128 v[40:43], v11 offset:11264
    ds_read_b128 v[44:47], v11 offset:12288
    s_waitcnt lgkmcnt(6)
    v_mfma_f32_32x32x16_bf16 v[96:111], v[16:19], a[20:23], v[96:111]
    buffer_load_dwordx4 v4, s[8:11], s41 offen offset:1024 sc1 lds
    v_mul_f32 v53, v53, v61
    v_mul_f32 v54, v54, v62
    v_mfma_f32_32x32x16_bf16 v[96:111], v[20:23], a[24:27], v[96:111]
    v_mul_f32 v55, v55, v63
    ds_read_b128 v[16:19], v11 offset:13312
    ds_read_b128 v[20:23], v11 offset:14336
    s_waitcnt lgkmcnt(6)
    v_mfma_f32_32x32x16_bf16 v[96:111], v[24:27], a[28:31], v[96:111]
    buffer_load_dwordx4 v4, s[8:11], s41 offen offset:2048 sc1 lds
    v_mul_f32 v48, v9, v48
    v_mul_f32 v49, v9, v49
    v_mfma_f32_32x32x16_bf16 v[96:111], v[28:31], a[32:35], v[96:111]
    v_mul_f32 v50, v9, v50
    ds_read_b128 v[24:27], v11 offset:15360
    ds_read_b128 v[28:31], v11 offset:16384
    s_waitcnt lgkmcnt(6)
    v_mfma_f32_32x32x16_bf16 v[96:111], v[32:35], a[36:39], v[96:111]
    v_mul_f32 v51, v9, v51
    v_mul_f32 v52, v9, v52
    v_mul_f32 v53, v9, v53
    v_mul_f32 v54, v9, v54
    v_mfma_f32_32x32x16_bf16 v[96:111], v[36:39], a[40:43], v[96:111]
    buffer_load_dwordx4 v4, s[8:11], s41 offen offset:3072 sc1 lds
    ds_read_b128 v[32:35], v11 offset:17408
    ds_read_b128 v[36:39], v11 offset:18432
    s_waitcnt lgkmcnt(6)
    v_mfma_f32_32x32x16_bf16 v[96:111], v[40:43], a[44:47], v[96:111]
    v_mul_f32 v55, v9, v55
    v_cvt_pk_bf16_f32 v56, v48, v49
    v_cvt_pk_bf16_f32 v57, v50, v51
    v_cvt_pk_bf16_f32 v58, v52, v53
    v_mfma_f32_32x32x16_bf16 v[96:111], v[44:47], a[48:51], v[96:111]
    s_add_u32 m0, s21, 4096
    s_add_u32 s41, s20, 3280896
    buffer_load_dwordx4 v4, s[8:11], s41 offen offset:0 sc1 lds
    ds_read_b128 v[40:43], v11 offset:19456
    ds_read_b128 v[44:47], v11 offset:20480
    s_waitcnt lgkmcnt(6)
    v_mfma_f32_32x32x16_bf16 v[96:111], v[16:19], a[52:55], v[96:111]
    v_cvt_pk_bf16_f32 v59, v54, v55
    buffer_store_dwordx4 v[56:59], v4, s[8:11], s24 offen sc1
    s_add_u32 s24, s24, 16384
    v_mul_f32 v64, v64, v72
    v_mul_f32 v65, v65, v73
    v_mfma_f32_32x32x16_bf16 v[96:111], v[20:23], a[56:59], v[96:111]
    v_mul_f32 v66, v66, v74
    ds_read_b128 v[16:19], v11 offset:21504
    ds_read_b128 v[20:23], v11 offset:22528
    s_waitcnt lgkmcnt(6)
    v_mfma_f32_32x32x16_bf16 v[96:111], v[24:27], a[60:63], v[96:111]
    s_add_u32 m0, s21, 20480
    s_add_u32 s41, s39, 3932160
    buffer_load_dwordx4 v4, s[8:11], s41 offen offset:0 sc1 lds
    v_mul_f32 v67, v67, v75
    v_mul_f32 v68, v68, v76
    v_mfma_f32_32x32x16_bf16 v[96:111], v[28:31], a[64:67], v[96:111]
    v_mul_f32 v69, v69, v77
    ds_read_b128 v[24:27], v11 offset:23552
    ds_read_b128 v[28:31], v11 offset:24576
    s_waitcnt lgkmcnt(6)
    v_mfma_f32_32x32x16_bf16 v[96:111], v[32:35], a[68:71], v[96:111]
    buffer_load_dwordx4 v4, s[8:11], s41 offen offset:1024 sc1 lds
    v_mul_f32 v70, v70, v78
    v_mul_f32 v71, v71, v79
    v_mfma_f32_32x32x16_bf16 v[96:111], v[36:39], a[72:75], v[96:111]
    v_mul_f32 v64, v9, v64
    ds_read_b128 v[32:35], v11 offset:25600
    ds_read_b128 v[36:39], v11 offset:26624
    s_waitcnt lgkmcnt(6)
    v_mfma_f32_32x32x16_bf16 v[96:111], v[40:43], a[76:79], v[96:111]
    v_mul_f32 v65, v9, v65
    v_mul_f32 v66, v9, v66
    v_mul_f32 v67, v9, v67
    v_mul_f32 v68, v9, v68
    v_mfma_f32_32x32x16_bf16 v[96:111], v[44:47], a[80:83], v[96:111]
    buffer_load_dwordx4 v4, s[8:11], s41 offen offset:2048 sc1 lds
    ds_read_b128 v[40:43], v11 offset:27648
    ds_read_b128 v[44:47], v11 offset:28672
    s_waitcnt lgkmcnt(6)
    v_mfma_f32_32x32x16_bf16 v[96:111], v[16:19], a[84:87], v[96:111]
    v_mul_f32 v69, v9, v69
    v_mul_f32 v70, v9, v70
    v_mul_f32 v71, v9, v71
    v_cvt_pk_bf16_f32 v72, v64, v65
    v_mfma_f32_32x32x16_bf16 v[96:111], v[20:23], a[88:91], v[96:111]
    s_branch L_pg5c
.p2align 12
L_pg5:
    s_setpc_b64 s[60:61]
L_pg5c:
    buffer_load_dwordx4 v4, s[8:11], s41 offen offset:3072 sc1 lds
    ds_read_b128 v[16:19], v11 offset:29696
    ds_read_b128 v[20:23], v11 offset:30720
    s_waitcnt lgkmcnt(6)
    v_mfma_f32_32x32x16_bf16 v[96:111], v[24:27], a[92:95], v[96:111]
    v_cvt_pk_bf16_f32 v73, v66, v67
    v_cvt_pk_bf16_f32 v74, v68, v69
    v_cvt_pk_bf16_f32 v75, v70, v71
    buffer_store_dwordx4 v[72:75], v4, s[8:11], s24 offen sc1
    s_add_u32 s24, s24, 16384
    v_mfma_f32_32x32x16_bf16 v[96:111], v[28:31], a[96:99], v[96:111]
    v_mul_f32 v80, v80, v88
    ds_read_b128 v[24:27], v11 offset:31744
    ds_read_b128 v[28:31], v11 offset:32768
    s_waitcnt lgkmcnt(6)
    v_mfma_f32_32x32x16_bf16 v[96:111], v[32:35], a[100:103], v[96:111]
    s_add_u32 m0, s21, 24576
    s_add_u32 s41, s39, 3936256
    buffer_load_dwordx4 v4, s[8:11], s41 offen offset:0 sc1 lds
    v_mul_f32 v81, v81, v89
    v_mul_f32 v82, v82, v90
    v_mfma_f32_32x32x16_bf16 v[96:111], v[36:39], a[104:107], v[96:111]
    v_mul_f32 v83, v83, v91
    ds_read_b128 v[32:35], v11 offset:33792
    ds_read_b128 v[36:39], v11 offset:34816
    s_waitcnt lgkmcnt(6)
    v_mfma_f32_32x32x16_bf16 v[96:111], v[40:43], a[108:111], v[96:111]
    s_add_u32 m0, s21, 40960
    s_add_u32 s41, s20, 3297280
    buffer_load_dwordx4 v4, s[8:11], s41 offen offset:0 sc1 lds
    v_mul_f32 v84, v84, v92
    v_mul_f32 v85, v85, v93
    v_mfma_f32_32x32x16_bf16 v[96:111], v[44:47], a[112:115], v[96:111]
    v_mul_f32 v86, v86, v94
    ds_read_b128 v[40:43], v11 offset:35840
    ds_read_b128 v[44:47], v11 offset:36864
    s_waitcnt lgkmcnt(6)
    v_mfma_f32_32x32x16_bf16 v[96:111], v[16:19], a[116:119], v[96:111]
    v_mul_f32 v87, v87, v95
    v_mul_f32 v80, v9, v80
    v_mul_f32 v81, v9, v81
    v_mul_f32 v82, v9, v82
    v_mfma_f32_32x32x16_bf16 v[96:111], v[20:23], a[120:123], v[96:111]
    buffer_load_dwordx4 v4, s[8:11], s41 offen offset:1024 sc1 lds
    s_waitcnt vmcnt(17)
    s_barrier
    ds_read_b128 v[16:19], v11 offset:37888
    ds_read_b128 v[20:23], v11 offset:38912
    s_waitcnt lgkmcnt(6)
    v_mfma_f32_32x32x16_bf16 v[96:111], v[24:27], a[124:127], v[96:111]
    v_mul_f32 v83, v9, v83
    v_mul_f32 v84, v9, v84
    v_mul_f32 v85, v9, v85
    v_mul_f32 v86, v9, v86
    v_mfma_f32_32x32x16_bf16 v[96:111], v[28:31], a[128:131], v[96:111]
    buffer_load_dwordx4 v4, s[8:11], s41 offen offset:2048 sc1 lds
    ds_read_b128 v[24:27], v11 offset:39936
    ds_read_b128 v[28:31], v7 offset:1536
    s_waitcnt lgkmcnt(6)
    v_mfma_f32_32x32x16_bf16 v[96:111], v[32:35], a[132:135], v[96:111]
    v_mul_f32 v87, v9, v87
    v_cvt_pk_bf16_f32 v88, v80, v81
    v_cvt_pk_bf16_f32 v89, v82, v83
    v_cvt_pk_bf16_f32 v90, v84, v85
    v_mfma_f32_32x32x16_bf16 v[96:111], v[36:39], a[136:139], v[96:111]
    v_cvt_pk_bf16_f32 v91, v86, v87
    ds_read_b128 v[32:35], v11 offset:40960
    ds_read_b128 v[36:39], v11 offset:41984
    s_waitcnt lgkmcnt(6)
    v_mfma_f32_32x32x16_bf16 v[96:111], v[40:43], a[140:143], v[96:111]
    buffer_load_dwordx4 v4, s[8:11], s41 offen offset:3072 sc1 lds
    buffer_store_dwordx4 v[88:91], v4, s[8:11], s24 offen sc1
    s_add_u32 s24, s24, 16384
    v_mfma_f32_32x32x16_bf16 v[96:111], v[44:47], a[144:147], v[96:111]
    ds_read_b128 v[40:43], v11 offset:43008
    ds_read_b128 v[44:47], v11 offset:44032
    s_waitcnt lgkmcnt(6)
    v_mfma_f32_32x32x16_bf16 v[96:111], v[16:19], a[148:151], v[96:111]
    s_add_u32 m0, s21, 45056
    s_add_u32 s41, s20, 3301376
    buffer_load_dwordx4 v4, s[8:11], s41 offen offset:0 sc1 lds
    v_mfma_f32_32x32x16_bf16 v[96:111], v[20:23], a[152:155], v[96:111]
    ds_read_b128 v[16:19], v11 offset:45056
    ds_read_b128 v[20:23], v11 offset:46080
    s_waitcnt lgkmcnt(6)
    v_mfma_f32_32x32x16_bf16 v[96:111], v[24:27], a[156:159], v[96:111]
    v_mfma_f32_32x32x16_bf16 v[96:111], v[28:31], v[112:115], v[96:111]
    s_add_u32 m0, s21, 61440
    s_add_u32 s41, s39, 3952640
    buffer_load_dwordx4 v4, s[8:11], s41 offen offset:0 sc1 lds
    ds_read_b128 v[24:27], v11 offset:47104
    ds_read_b128 v[28:31], v11 offset:48128
    s_waitcnt lgkmcnt(6)
    v_mfma_f32_32x32x16_bf16 v[48:63], v[32:35], a[0:3], 0
    v_mfma_f32_32x32x16_bf16 v[48:63], v[36:39], a[4:7], v[48:63]
    buffer_load_dwordx4 v4, s[8:11], s41 offen offset:1024 sc1 lds
    ds_read_b128 v[32:35], v11 offset:49152
    ds_read_b128 v[36:39], v11 offset:50176
    s_waitcnt lgkmcnt(6)
    v_mfma_f32_32x32x16_bf16 v[48:63], v[40:43], a[8:11], v[48:63]
    v_mfma_f32_32x32x16_bf16 v[48:63], v[44:47], a[12:15], v[48:63]
    v_mul_f32 v96, v96, v104
    ds_read_b128 v[40:43], v11 offset:51200
    ds_read_b128 v[44:47], v11 offset:52224
    s_waitcnt lgkmcnt(6)
    v_mfma_f32_32x32x16_bf16 v[48:63], v[16:19], a[16:19], v[48:63]
    buffer_load_dwordx4 v4, s[8:11], s41 offen offset:2048 sc1 lds
    v_mul_f32 v97, v97, v105
    v_mul_f32 v98, v98, v106
    v_mfma_f32_32x32x16_bf16 v[48:63], v[20:23], a[20:23], v[48:63]
    v_mul_f32 v99, v99, v107
    ds_read_b128 v[16:19], v11 offset:53248
    ds_read_b128 v[20:23], v11 offset:54272
    s_waitcnt lgkmcnt(6)
    v_mfma_f32_32x32x16_bf16 v[48:63], v[24:27], a[24:27], v[48:63]
    buffer_load_dwordx4 v4, s[8:11], s41 offen offset:3072 sc1 lds
    v_mul_f32 v100, v100, v108
    v_mul_f32 v101, v101, v109
    v_mfma_f32_32x32x16_bf16 v[48:63], v[28:31], a[28:31], v[48:63]
    v_mul_f32 v102, v102, v110
    ds_read_b128 v[24:27], v11 offset:55296
    ds_read_b128 v[28:31], v11 offset:56320
    s_waitcnt lgkmcnt(6)
    v_mfma_f32_32x32x16_bf16 v[48:63], v[32:35], a[32:35], v[48:63]
    v_mul_f32 v103, v103, v111
    v_mul_f32 v96, v9, v96
    v_mul_f32 v97, v9, v97
    v_mul_f32 v98, v9, v98
    v_mfma_f32_32x32x16_bf16 v[48:63], v[36:39], a[36:39], v[48:63]
    s_add_u32 m0, s21, 65536
    s_add_u32 s41, s39, 3956736
    buffer_load_dwordx4 v4, s[8:11], s41 offen offset:0 sc1 lds
    ds_read_b128 v[32:35], v11 offset:57344
    ds_read_b128 v[36:39], v11 offset:58368
    s_waitcnt lgkmcnt(6)
    v_mfma_f32_32x32x16_bf16 v[48:63], v[40:43], a[40:43], v[48:63]
    v_mul_f32 v99, v9, v99
    v_mul_f32 v100, v9, v100
    v_mul_f32 v101, v9, v101
    v_mul_f32 v102, v9, v102
    v_mfma_f32_32x32x16_bf16 v[48:63], v[44:47], a[44:47], v[48:63]
    buffer_load_dwordx4 a[252:255], v4, s[8:11], s42 offen offset:3072 sc1
    ds_read_b128 v[40:43], v11 offset:59392
    ds_read_b128 v[44:47], v11 offset:60416
    s_waitcnt lgkmcnt(6)
    v_mfma_f32_32x32x16_bf16 v[48:63], v[16:19], a[48:51], v[48:63]
    v_mul_f32 v103, v9, v103
    v_cvt_pk_bf16_f32 v104, v96, v97
    v_cvt_pk_bf16_f32 v105, v98, v99
    v_cvt_pk_bf16_f32 v106, v100, v101
    v_mfma_f32_32x32x16_bf16 v[48:63], v[20:23], a[52:55], v[48:63]
    v_cvt_pk_bf16_f32 v107, v102, v103
    ds_read_b128 v[16:19], v12 offset:0
    ds_read_b128 v[20:23], v12 offset:1024
    s_waitcnt lgkmcnt(6)
    v_mfma_f32_32x32x16_bf16 v[48:63], v[24:27], a[56:59], v[48:63]
    s_add_u32 s42, s26, 86016
    buffer_load_dwordx4 v[168:171], v4, s[8:11], s42 offen offset:0 sc1
    buffer_store_dwordx4 v[104:107], v4, s[8:11], s24 offen sc1
    s_add_u32 s24, s24, 16384
    v_mfma_f32_32x32x16_bf16 v[48:63], v[28:31], a[60:63], v[48:63]
    ds_read_b128 v[24:27], v12 offset:2048
    ds_read_b128 v[28:31], v12 offset:3072
    s_waitcnt lgkmcnt(6)
    v_mfma_f32_32x32x16_bf16 v[48:63], v[32:35], a[64:67], v[48:63]
    s_add_u32 s42, s26, 87040
    buffer_load_dwordx4 v[172:175], v4, s[8:11], s42 offen offset:0 sc1
    v_mfma_f32_32x32x16_bf16 v[48:63], v[36:39], a[68:71], v[48:63]
    ds_read_b128 v[32:35], v12 offset:4096
    ds_read_b128 v[36:39], v12 offset:5120
    s_waitcnt lgkmcnt(6)
    v_mfma_f32_32x32x16_bf16 v[48:63], v[40:43], a[72:75], v[48:63]
    v_mfma_f32_32x32x16_bf16 v[48:63], v[44:47], a[76:79], v[48:63]
    buffer_load_dwordx4 v[176:179], v4, s[8:11], s42 offen offset:1024 sc1
    ds_read_b128 v[40:43], v12 offset:6144
    ds_read_b128 v[44:47], v12 offset:7168
    s_waitcnt lgkmcnt(6)
    v_mfma_f32_32x32x16_bf16 v[48:63], v[16:19], a[80:83], v[48:63]
    s_waitcnt vmcnt(11)
    s_mov_b64 exec, 1
    buffer_atomic_add v14, v13, s[8:11], s33 offen offset:0 sc1
    s_mov_b64 exec, -1
    v_mfma_f32_32x32x16_bf16 v[48:63], v[20:23], a[84:87], v[48:63]
    buffer_load_dwordx4 v[180:183], v4, s[8:11], s42 offen offset:2048 sc1
    ds_read_b128 v[16:19], v12 offset:8192
    ds_read_b128 v[20:23], v12 offset:9216
    s_waitcnt lgkmcnt(6)
    v_mfma_f32_32x32x16_bf16 v[48:63], v[24:27], a[88:91], v[48:63]
    v_mfma_f32_32x32x16_bf16 v[48:63], v[28:31], a[92:95], v[48:63]
    ds_read_b128 v[24:27], v12 offset:10240
    ds_read_b128 v[28:31], v12 offset:11264
    s_waitcnt lgkmcnt(6)
    v_mfma_f32_32x32x16_bf16 v[48:63], v[32:35], a[96:99], v[48:63]
    buffer_load_dwordx4 v[184:187], v4, s[8:11], s42 offen offset:3072 sc1
    v_mfma_f32_32x32x16_bf16 v[48:63], v[36:39], a[100:103], v[48:63]
    ds_read_b128 v[32:35], v12 offset:12288
    ds_read_b128 v[36:39], v12 offset:13312
    s_waitcnt lgkmcnt(6)
    v_mfma_f32_32x32x16_bf16 v[48:63], v[40:43], a[104:107], v[48:63]
    s_add_u32 s42, s26, 91136
    buffer_load_dwordx4 v[188:191], v4, s[8:11], s42 offen offset:0 sc1
    v_mfma_f32_32x32x16_bf16 v[48:63], v[44:47], a[108:111], v[48:63]
    ds_read_b128 v[40:43], v12 offset:14336
    ds_read_b128 v[44:47], v12 offset:15360
    s_waitcnt lgkmcnt(6)
    v_mfma_f32_32x32x16_bf16 v[48:63], v[16:19], a[112:115], v[48:63]
    v_mfma_f32_32x32x16_bf16 v[48:63], v[20:23], a[116:119], v[48:63]
    s_add_u32 s42, s26, 122880
    buffer_load_dwordx4 v[192:195], v4, s[8:11], s42 offen offset:0 sc1
    ds_read_b128 v[16:19], v12 offset:16384
    ds_read_b128 v[20:23], v12 offset:17408
    s_waitcnt lgkmcnt(6)
    v_mfma_f32_32x32x16_bf16 v[48:63], v[24:27], a[120:123], v[48:63]
    v_mfma_f32_32x32x16_bf16 v[48:63], v[28:31], a[124:127], v[48:63]
    buffer_load_dwordx4 v[196:199], v4, s[8:11], s42 offen offset:1024 sc1
    s_barrier
    ds_read_b128 v[24:27], v12 offset:18432
    ds_read_b128 v[28:31], v12 offset:19456
    s_waitcnt lgkmcnt(6)
    v_mfma_f32_32x32x16_bf16 v[48:63], v[32:35], a[128:131], v[48:63]
    v_mfma_f32_32x32x16_bf16 v[48:63], v[36:39], a[132:135], v[48:63]
    ds_read_b128 v[32:35], v7 offset:2048
    ds_read_b128 v[36:39], v4 offset:0
    s_waitcnt lgkmcnt(6)
    v_mfma_f32_32x32x16_bf16 v[48:63], v[40:43], a[136:139], v[48:63]
    buffer_load_dwordx4 v[200:203], v4, s[8:11], s42 offen offset:2048 sc1
    v_mfma_f32_32x32x16_bf16 v[48:63], v[44:47], a[140:143], v[48:63]
    ds_read_b128 v[40:43], v4 offset:20480
    ds_read_b128 v[44:47], v4 offset:1024
    s_waitcnt lgkmcnt(6)
    v_mfma_f32_32x32x16_bf16 v[48:63], v[16:19], a[144:147], v[48:63]
    buffer_load_dwordx4 v[204:207], v4, s[8:11], s42 offen offset:3072 sc1
    v_mfma_f32_32x32x16_bf16 v[48:63], v[20:23], a[148:151], v[48:63]
    v_mov_b32 v15, 0
    s_mov_b64 exec, 1
    buffer_atomic_add v15, v5, s[8:11], s34 offen offset:0 sc0 sc1
    s_mov_b64 exec, -1
    ds_read_b128 v[16:19], v4 offset:21504
    ds_read_b128 v[20:23], v4 offset:2048
    s_waitcnt lgkmcnt(6)
    v_mfma_f32_32x32x16_bf16 v[48:63], v[24:27], a[152:155], v[48:63]
    v_mfma_f32_32x32x16_bf16 v[48:63], v[28:31], a[156:159], v[48:63]
    s_add_u32 s42, s26, 126976
    buffer_load_dwordx4 v[208:211], v4, s[8:11], s42 offen offset:0 sc1
    ds_read_b128 v[24:27], v4 offset:22528
    ds_read_b128 v[28:31], v4 offset:3072
    s_waitcnt lgkmcnt(6)
    v_mfma_f32_32x32x16_bf16 v[48:63], v[32:35], v[112:115], v[48:63]
    v_mfma_f32_32x32x16_bf16 v[64:79], v[36:39], a[0:3], 0
    s_add_u32 s42, s26, 128000
    buffer_load_dwordx4 v[212:215], v4, s[8:11], s42 offen offset:0 sc1
    s_cmp_lt_u32 s7, 12
    s_cbranch_scc1 L_l3_u6
    ds_read_b128 v[32:35], v4 offset:23552
    ds_read_b128 v[36:39], v4 offset:4096
    s_waitcnt lgkmcnt(6)
    v_mfma_f32_32x32x16_bf16 v[64:79], v[44:47], a[4:7], v[64:79]
    ds_read_b128 v[40:43], v4 offset:24576
    ds_read_b128 v[44:47], v4 offset:5120
    s_waitcnt lgkmcnt(6)
    buffer_load_dwordx4 v[216:219], v4, s[8:11], s42 offen offset:1024 sc1
    v_mul_f32 v48, v48, v56
    v_mul_f32 v49, v49, v57
    v_mfma_f32_32x32x16_bf16 v[64:79], v[20:23], a[8:11], v[64:79]
    v_mul_f32 v50, v50, v58
    ds_read_b128 v[16:19], v4 offset:25600
    ds_read_b128 v[20:23], v4 offset:6144
    s_waitcnt lgkmcnt(6)
    buffer_load_dwordx4 v[220:223], v4, s[8:11], s42 offen offset:2048 sc1
    v_mul_f32 v51, v51, v59
    v_mul_f32 v52, v52, v60
    v_mfma_f32_32x32x16_bf16 v[64:79], v[28:31], a[12:15], v[64:79]
    v_mul_f32 v53, v53, v61
    ds_read_b128 v[24:27], v4 offset:26624
    ds_read_b128 v[28:31], v4 offset:7168
    s_waitcnt lgkmcnt(6)
    v_mul_f32 v54, v54, v62
    v_mul_f32 v55, v55, v63
    v_mul_f32 v48, v9, v48
    v_mul_f32 v49, v9, v49
    v_mfma_f32_32x32x16_bf16 v[64:79], v[36:39], a[16:19], v[64:79]
    buffer_load_dwordx4 v[224:227], v4, s[8:11], s42 offen offset:3072 sc1
    ds_read_b128 v[32:35], v4 offset:27648
    ds_read_b128 v[36:39], v4 offset:8192
    s_waitcnt lgkmcnt(6)
    v_mul_f32 v50, v9, v50
    v_mul_f32 v51, v9, v51
    v_mul_f32 v52, v9, v52
    v_mul_f32 v53, v9, v53
    v_mfma_f32_32x32x16_bf16 v[64:79], v[44:47], a[20:23], v[64:79]
    s_add_u32 s42, s26, 132096
    buffer_load_dwordx4 v[120:123], v4, s[8:11], s42 offen offset:0 sc1
    s_waitcnt vmcnt(6)
    s_mov_b32 s52, 20000
L_l3_pc1b:
    v_cmp_gt_u32 vcc, 8, v15
    s_sub_u32 s52, s52, 1
    s_cselect_b32 s53, 0, vcc_lo
    s_and_b32 s53, s53, 1
    s_cbranch_scc0 L_l3_ok1b
    s_sleep 1
    v_mov_b32 v15, 0
    s_mov_b64 exec, 1
    buffer_atomic_add v15, v5, s[8:11], s34 offen offset:0 sc0 sc1
    s_mov_b64 exec, -1
    s_waitcnt vmcnt(0)
    s_branch L_l3_pc1b
L_l3_ok1b:
    ds_read_b128 v[40:43], v4 offset:28672
    ds_read_b128 v[44:47], v4 offset:9216
    s_waitcnt lgkmcnt(6)
    v_mul_f32 v54, v9, v54
    v_mul_f32 v55, v9, v55
    v_cvt_pk_bf16_f32 v56, v48, v49
    v_cvt_pk_bf16_f32 v57, v50, v51
    v_mfma_f32_32x32x16_bf16 v[64:79], v[20:23], a[24:27], v[64:79]
    v_cvt_pk_bf16_f32 v58, v52, v53
    ds_read_b128 v[16:19], v4 offset:29696
    ds_read_b128 v[20:23], v4 offset:10240
    s_waitcnt lgkmcnt(6)
    s_add_u32 s43, s27, 0
    buffer_load_dwordx4 v[124:127], v240, s[8:11], s43 offen sc1
    v_cvt_pk_bf16_f32 v59, v54, v55
    buffer_store_dwordx4 v[56:59], v4, s[8:11], s24 offen sc1
    s_add_u32 s24, s24, 16384
    v_mfma_f32_32x32x16_bf16 v[64:79], v[28:31], a[28:31], v[64:79]
    ds_read_b128 v[24:27], v4 offset:30720
    ds_read_b128 v[28:31], v4 offset:11264
    s_waitcnt lgkmcnt(6)
    buffer_load_dwordx4 v[128:131], v241, s[8:11], s43 offen sc1
    v_mfma_f32_32x32x16_bf16 v[64:79], v[36:39], a[32:35], v[64:79]
    ds_read_b128 v[32:35], v4 offset:31744
    ds_read_b128 v[36:39], v4 offset:12288
    s_waitcnt lgkmcnt(6)
    v_mfma_f32_32x32x16_bf16 v[64:79], v[44:47], a[36:39], v[64:79]
    buffer_load_dwordx4 v[132:135], v242, s[8:11], s43 offen sc1
    ds_read_b128 v[40:43], v4 offset:32768
    ds_read_b128 v[44:47], v4 offset:13312
    s_waitcnt lgkmcnt(6)
    v_mfma_f32_32x32x16_bf16 v[64:79], v[20:23], a[40:43], v[64:79]
    buffer_load_dwordx4 v[136:139], v243, s[8:11], s43 offen sc1
    ds_read_b128 v[16:19], v4 offset:33792
    ds_read_b128 v[20:23], v4 offset:14336
    s_waitcnt lgkmcnt(6)
    v_mfma_f32_32x32x16_bf16 v[64:79], v[28:31], a[44:47], v[64:79]
    ds_read_b128 v[24:27], v4 offset:34816
    ds_read_b128 v[28:31], v4 offset:15360
    s_waitcnt lgkmcnt(6)
    s_add_u32 s43, s27, 2048
    buffer_load_dwordx4 v[140:143], v240, s[8:11], s43 offen sc1
    v_mfma_f32_32x32x16_bf16 v[64:79], v[36:39], a[48:51], v[64:79]
    ds_read_b128 v[32:35], v4 offset:35840
    ds_read_b128 v[36:39], v4 offset:16384
    s_waitcnt lgkmcnt(6)
    buffer_load_dwordx4 v[144:147], v241, s[8:11], s43 offen sc1
    v_mfma_f32_32x32x16_bf16 v[64:79], v[44:47], a[52:55], v[64:79]
    ds_read_b128 v[40:43], v4 offset:36864
    ds_read_b128 v[44:47], v4 offset:17408
    s_waitcnt lgkmcnt(6)
    v_mfma_f32_32x32x16_bf16 v[64:79], v[20:23], a[56:59], v[64:79]
    buffer_load_dwordx4 v[148:151], v242, s[8:11], s43 offen sc1
    ds_read_b128 v[16:19], v4 offset:37888
    ds_read_b128 v[20:23], v4 offset:18432
    s_waitcnt lgkmcnt(6)
    v_mfma_f32_32x32x16_bf16 v[64:79], v[28:31], a[60:63], v[64:79]
    buffer_load_dwordx4 v[152:155], v243, s[8:11], s43 offen sc1
    s_barrier
    ds_read_b128 v[24:27], v4 offset:38912
    ds_read_b128 v[28:31], v4 offset:19456
    s_waitcnt lgkmcnt(6)
    v_mfma_f32_32x32x16_bf16 v[64:79], v[36:39], a[64:67], v[64:79]
    ds_read_b128 v[32:35], v4 offset:39936
    ds_read_b128 v[36:39], v4 offset:40960
    s_waitcnt lgkmcnt(6)
    s_add_u32 s43, s27, 16384
    buffer_load_dwordx4 v[156:159], v240, s[8:11], s43 offen sc1
    v_mfma_f32_32x32x16_bf16 v[64:79], v[44:47], a[68:71], v[64:79]
    ds_read_b128 v[40:43], v11 offset:0
    ds_read_b128 v[44:47], v4 offset:41984
    s_waitcnt lgkmcnt(6)
    buffer_load_dwordx4 v[160:163], v241, s[8:11], s43 offen sc1
    v_mfma_f32_32x32x16_bf16 v[64:79], v[20:23], a[72:75], v[64:79]
    ds_read_b128 v[16:19], v11 offset:1024
    ds_read_b128 v[20:23], v4 offset:43008
    s_waitcnt lgkmcnt(6)
    v_mfma_f32_32x32x16_bf16 v[64:79], v[28:31], a[76:79], v[64:79]
    buffer_load_dwordx4 v[164:167], v242, s[8:11], s43 offen sc1
    ds_read_b128 v[24:27], v11 offset:2048
    ds_read_b128 v[28:31], v4 offset:44032
    s_waitcnt lgkmcnt(6)
    s_waitcnt vmcnt(10)
    s_mov_b64 exec, 1
    buffer_atomic_add v14, v13, s[8:11], s33 offen offset:128 sc1
    s_mov_b64 exec, -1
    v_mfma_f32_32x32x16_bf16 v[64:79], v[36:39], a[80:83], v[64:79]
    buffer_load_dwordx4 v[228:231], v243, s[8:11], s43 offen sc1
    ds_read_b128 v[32:35], v11 offset:3072
    ds_read_b128 v[36:39], v4 offset:45056
    s_waitcnt lgkmcnt(6)
    v_mfma_f32_32x32x16_bf16 v[64:79], v[44:47], a[84:87], v[64:79]
    ds_read_b128 v[40:43], v11 offset:4096
    ds_read_b128 v[44:47], v4 offset:46080
    s_waitcnt lgkmcnt(6)
    s_add_u32 s43, s27, 18432
    buffer_load_dwordx4 v[232:235], v240, s[8:11], s43 offen sc1
    v_mfma_f32_32x32x16_bf16 v[64:79], v[20:23], a[88:91], v[64:79]
    ds_read_b128 v[16:19], v11 offset:5120
    ds_read_b128 v[20:23], v4 offset:47104
    s_waitcnt lgkmcnt(6)
    buffer_load_dwordx4 v[236:239], v241, s[8:11], s43 offen sc1
    v_mfma_f32_32x32x16_bf16 v[64:79], v[28:31], a[92:95], v[64:79]
    ds_read_b128 v[24:27], v11 offset:6144
    ds_read_b128 v[28:31], v4 offset:48128
    s_waitcnt lgkmcnt(6)
    v_mfma_f32_32x32x16_bf16 v[64:79], v[36:39], a[96:99], v[64:79]
    buffer_load_dwordx4 a[0:3], v242, s[8:11], s43 offen sc1
    ds_read_b128 v[32:35], v11 offset:7168
    ds_read_b128 v[36:39], v4 offset:49152
    s_waitcnt lgkmcnt(6)
    v_mfma_f32_32x32x16_bf16 v[64:79], v[44:47], a[100:103], v[64:79]
    buffer_load_dwordx4 a[4:7], v243, s[8:11], s43 offen sc1
    ds_read_b128 v[40:43], v11 offset:8192
    ds_read_b128 v[44:47], v4 offset:50176
    s_waitcnt lgkmcnt(6)
    v_mfma_f32_32x32x16_bf16 v[64:79], v[20:23], a[104:107], v[64:79]
    ds_read_b128 v[16:19], v11 offset:9216
    ds_read_b128 v[20:23], v4 offset:51200
    s_waitcnt lgkmcnt(6)
    s_add_u32 s43, s27, 32768
    buffer_load_dwordx4 a[8:11], v240, s[8:11], s43 offen sc1
    v_mfma_f32_32x32x16_bf16 v[64:79], v[28:31], a[108:111], v[64:79]
    ds_read_b128 v[24:27], v11 offset:10240
    ds_read_b128 v[28:31], v4 offset:52224
    s_waitcnt lgkmcnt(6)
    buffer_load_dwordx4 a[12:15], v241, s[8:11], s43 offen sc1
    v_mfma_f32_32x32x16_bf16 v[64:79], v[36:39], a[112:115], v[64:79]
    ds_read_b128 v[32:35], v11 offset:11264
    ds_read_b128 v[36:39], v4 offset:53248
    s_waitcnt lgkmcnt(6)
    v_mfma_f32_32x32x16_bf16 v[64:79], v[44:47], a[116:119], v[64:79]
    buffer_load_dwordx4 a[16:19], v242, s[8:11], s43 offen sc1
    ds_read_b128 v[40:43], v11 offset:12288
    ds_read_b128 v[44:47], v4 offset:54272
    s_waitcnt lgkmcnt(6)
    v_mfma_f32_32x32x16_bf16 v[64:79], v[20:23], a[120:123], v[64:79]
    buffer_load_dwordx4 a[20:23], v243, s[8:11], s43 offen sc1
    ds_read_b128 v[16:19], v11 offset:13312
    ds_read_b128 v[20:23], v4 offset:55296
    s_waitcnt lgkmcnt(6)
    v_mfma_f32_32x32x16_bf16 v[64:79], v[28:31], a[124:127], v[64:79]
    ds_read_b128 v[24:27], v11 offset:14336
    ds_read_b128 v[28:31], v4 offset:56320
    s_waitcnt lgkmcnt(6)
    s_add_u32 s43, s27, 34816
    buffer_load_dwordx4 a[24:27], v240, s[8:11], s43 offen sc1
    v_mfma_f32_32x32x16_bf16 v[64:79], v[36:39], a[128:131], v[64:79]
    ds_read_b128 v[32:35], v11 offset:15360
    ds_read_b128 v[36:39], v4 offset:57344
    s_waitcnt lgkmcnt(6)
    buffer_load_dwordx4 a[28:31], v241, s[8:11], s43 offen sc1
    v_mfma_f32_32x32x16_bf16 v[64:79], v[44:47], a[132:135], v[64:79]
    ds_read_b128 v[40:43], v11 offset:16384
    ds_read_b128 v[44:47], v4 offset:58368
    s_waitcnt lgkmcnt(6)
    v_mfma_f32_32x32x16_bf16 v[64:79], v[20:23], a[136:139], v[64:79]
    buffer_load_dwordx4 a[32:35], v242, s[8:11], s43 offen sc1
    ds_read_b128 v[16:19], v11 offset:17408
    ds_read_b128 v[20:23], v4 offset:59392
    s_waitcnt lgkmcnt(6)
    v_mfma_f32_32x32x16_bf16 v[64:79], v[28:31], a[140:143], v[64:79]
    buffer_load_dwordx4 a[36:39], v243, s[8:11], s43 offen sc1
    ds_read_b128 v[24:27], v11 offset:18432
    ds_read_b128 v[28:31], v4 offset:60416
    s_waitcnt lgkmcnt(6)
    v_mfma_f32_32x32x16_bf16 v[64:79], v[36:39], a[144:147], v[64:79]
    ds_read_b128 v[32:35], v11 offset:19456
    ds_read_b128 v[36:39], v7 offset:2560
    s_waitcnt lgkmcnt(6)
    s_add_u32 s42, s26, 163840
    buffer_load_dwordx4 a[40:43], v4, s[8:11], s42 offen offset:0 sc1
    v_mfma_f32_32x32x16_bf16 v[64:79], v[44:47], a[148:151], v[64:79]
    ds_read_b128 v[40:43], v7 offset:3072
    s_waitcnt lgkmcnt(5)
    buffer_load_dwordx4 a[44:47], v4, s[8:11], s42 offen offset:1024 sc1
    v_mfma_f32_32x32x16_bf16 v[64:79], v[20:23], a[152:155], v[64:79]
    s_waitcnt lgkmcnt(3)
    v_mfma_f32_32x32x16_bf16 v[64:79], v[28:31], a[156:159], v[64:79]
    buffer_load_dwordx4 a[48:51], v4, s[8:11], s42 offen offset:2048 sc1
    s_waitcnt lgkmcnt(1)
    v_mfma_f32_32x32x16_bf16 v[64:79], v[36:39], v[112:115], v[64:79]
    buffer_load_dwordx4 a[52:55], v4, s[8:11], s42 offen offset:3072 sc1
    s_waitcnt lgkmcnt(0)
    s_nop 9
    s_branch L_l3_g2b
L_l3_u6:
    ds_read_b128 v[32:35], v4 offset:23552
    ds_read_b128 v[36:39], v4 offset:4096
    s_waitcnt lgkmcnt(6)
    v_mfma_f32_32x32x16_bf16 v[80:95], v[40:43], a[0:3], 0
    v_mfma_f32_32x32x16_bf16 v[64:79], v[44:47], a[4:7], v[64:79]
    ds_read_b128 v[40:43], v4 offset:24576
    ds_read_b128 v[44:47], v4 offset:5120
    s_waitcnt lgkmcnt(6)
    v_mfma_f32_32x32x16_bf16 v[80:95], v[16:19], a[4:7], v[80:95]
    buffer_load_dwordx4 v[216:219], v4, s[8:11], s42 offen offset:1024 sc1
    v_mul_f32 v48, v48, v56
    v_mul_f32 v49, v49, v57
    v_mfma_f32_32x32x16_bf16 v[64:79], v[20:23], a[8:11], v[64:79]
    v_mul_f32 v50, v50, v58
    ds_read_b128 v[16:19], v4 offset:25600
    ds_read_b128 v[20:23], v4 offset:6144
    s_waitcnt lgkmcnt(6)
    v_mfma_f32_32x32x16_bf16 v[80:95], v[24:27], a[8:11], v[80:95]
    buffer_load_dwordx4 v[220:223], v4, s[8:11], s42 offen offset:2048 sc1
    v_mul_f32 v51, v51, v59
    v_mul_f32 v52, v52, v60
    v_mfma_f32_32x32x16_bf16 v[64:79], v[28:31], a[12:15], v[64:79]
    v_mul_f32 v53, v53, v61
    ds_read_b128 v[24:27], v4 offset:26624
    ds_read_b128 v[28:31], v4 offset:7168
    s_waitcnt lgkmcnt(6)
    v_mfma_f32_32x32x16_bf16 v[80:95], v[32:35], a[12:15], v[80:95]
    v_mul_f32 v54, v54, v62
    v_mul_f32 v55, v55, v63
    v_mul_f32 v48, v9, v48
    v_mul_f32 v49, v9, v49
    v_mfma_f32_32x32x16_bf16 v[64:79], v[36:39], a[16:19], v[64:79]
    buffer_load_dwordx4 v[224:227], v4, s[8:11], s42 offen offset:3072 sc1
    ds_read_b128 v[32:35], v4 offset:27648
    ds_read_b128 v[36:39], v4 offset:8192
    s_waitcnt lgkmcnt(6)
    v_mfma_f32_32x32x16_bf16 v[80:95], v[40:43], a[16:19], v[80:95]
    v_mul_f32 v50, v9, v50
    v_mul_f32 v51, v9, v51
    v_mul_f32 v52, v9, v52
    v_mul_f32 v53, v9, v53
    v_mfma_f32_32x32x16_bf16 v[64:79], v[44:47], a[20:23], v[64:79]
    s_add_u32 s42, s26, 132096
    buffer_load_dwordx4 v[120:123], v4, s[8:11], s42 offen offset:0 sc1
    s_waitcnt vmcnt(6)
    s_mov_b32 s52, 20000
L_l3_pc1:
    v_cmp_gt_u32 vcc, 8, v15
    s_sub_u32 s52, s52, 1
    s_cselect_b32 s53, 0, vcc_lo
    s_and_b32 s53, s53, 1
    s_cbranch_scc0 L_l3_ok1
    s_sleep 1
    v_mov_b32 v15, 0
    s_mov_b64 exec, 1
    buffer_atomic_add v15, v5, s[8:11], s34 offen offset:0 sc0 sc1
    s_mov_b64 exec, -1
    s_waitcnt vmcnt(0)
    s_branch L_l3_pc1
L_l3_ok1:
    ds_read_b128 v[40:43], v4 offset:28672
    ds_read_b128 v[44:47], v4 offset:9216
    s_waitcnt lgkmcnt(6)
    v_mfma_f32_32x32x16_bf16 v[80:95], v[16:19], a[20:23], v[80:95]
    v_mul_f32 v54, v9, v54
    v_mul_f32 v55, v9, v55
    v_cvt_pk_bf16_f32 v56, v48, v49
    v_cvt_pk_bf16_f32 v57, v50, v51
    v_mfma_f32_32x32x16_bf16 v[64:79], v[20:23], a[24:27], v[64:79]
    v_cvt_pk_bf16_f32 v58, v52, v53
    ds_read_b128 v[16:19], v4 offset:29696
    ds_read_b128 v[20:23], v4 offset:10240
    s_waitcnt lgkmcnt(6)
    v_mfma_f32_32x32x16_bf16 v[80:95], v[24:27], a[24:27], v[80:95]
    s_add_u32 s43, s27, 0
    buffer_load_dwordx4 v[124:127], v240, s[8:11], s43 offen sc1
    v_cvt_pk_bf16_f32 v59, v54, v55
    buffer_store_dwordx4 v[56:59], v4, s[8:11], s24 offen sc1
    s_add_u32 s24, s24, 16384
    v_mfma_f32_32x32x16_bf16 v[64:79], v[28:31], a[28:31], v[64:79]
    ds_read_b128 v[24:27], v4 offset:30720
    ds_read_b128 v[28:31], v4 offset:11264
    s_waitcnt lgkmcnt(6)
    v_mfma_f32_32x32x16_bf16 v[80:95], v[32:35], a[28:31], v[80:95]
    buffer_load_dwordx4 v[128:131], v241, s[8:11], s43 offen sc1
    v_mfma_f32_32x32x16_bf16 v[64:79], v[36:39], a[32:35], v[64:79]
    ds_read_b128 v[32:35], v4 offset:31744
    ds_read_b128 v[36:39], v4 offset:12288
    s_waitcnt lgkmcnt(6)
    v_mfma_f32_32x32x16_bf16 v[80:95], v[40:43], a[32:35], v[80:95]
    v_mfma_f32_32x32x16_bf16 v[64:79], v[44:47], a[36:39], v[64:79]
    buffer_load_dwordx4 v[132:135], v242, s[8:11], s43 offen sc1
    ds_read_b128 v[40:43], v4 offset:32768
    ds_read_b128 v[44:47], v4 offset:13312
    s_waitcnt lgkmcnt(6)
    v_mfma_f32_32x32x16_bf16 v[80:95], v[16:19], a[36:39], v[80:95]
    v_mfma_f32_32x32x16_bf16 v[64:79], v[20:23], a[40:43], v[64:79]
    buffer_load_dwordx4 v[136:139], v243, s[8:11], s43 offen sc1
    ds_read_b128 v[16:19], v4 offset:33792
    ds_read_b128 v[20:23], v4 offset:14336
    s_waitcnt lgkmcnt(6)
    v_mfma_f32_32x32x16_bf16 v[80:95], v[24:27], a[40:43], v[80:95]
    v_mfma_f32_32x32x16_bf16 v[64:79], v[28:31], a[44:47], v[64:79]
    ds_read_b128 v[24:27], v4 offset:34816
    ds_read_b128 v[28:31], v4 offset:15360
    s_waitcnt lgkmcnt(6)
    v_mfma_f32_32x32x16_bf16 v[80:95], v[32:35], a[44:47], v[80:95]
    s_add_u32 s43, s27, 2048
    buffer_load_dwordx4 v[140:143], v240, s[8:11], s43 offen sc1
    v_mfma_f32_32x32x16_bf16 v[64:79], v[36:39], a[48:51], v[64:79]
    ds_read_b128 v[32:35], v4 offset:35840
    ds_read_b128 v[36:39], v4 offset:16384
    s_waitcnt lgkmcnt(6)
    v_mfma_f32_32x32x16_bf16 v[80:95], v[40:43], a[48:51], v[80:95]
    buffer_load_dwordx4 v[144:147], v241, s[8:11], s43 offen sc1
    v_mfma_f32_32x32x16_bf16 v[64:79], v[44:47], a[52:55], v[64:79]
    s_branch L_pg6c
.p2align 12
L_pg6:
    s_setpc_b64 s[60:61]
L_pg6c:
    ds_read_b128 v[40:43], v4 offset:36864
    ds_read_b128 v[44:47], v4 offset:17408
    s_waitcnt lgkmcnt(6)
    v_mfma_f32_32x32x16_bf16 v[80:95], v[16:19], a[52:55], v[80:95]
    v_mfma_f32_32x32x16_bf16 v[64:79], v[20:23], a[56:59], v[64:79]
    buffer_load_dwordx4 v[148:151], v242, s[8:11], s43 offen sc1
    ds_read_b128 v[16:19], v4 offset:37888
    ds_read_b128 v[20:23], v4 offset:18432
    s_waitcnt lgkmcnt(6)
    v_mfma_f32_32x32x16_bf16 v[80:95], v[24:27], a[56:59], v[80:95]
    v_mfma_f32_32x32x16_bf16 v[64:79], v[28:31], a[60:63], v[64:79]
    buffer_load_dwordx4 v[152:155], v243, s[8:11], s43 offen sc1
    s_barrier
    ds_read_b128 v[24:27], v4 offset:38912
    ds_read_b128 v[28:31], v4 offset:19456
    s_waitcnt lgkmcnt(6)
    v_mfma_f32_32x32x16_bf16 v[80:95], v[32:35], a[60:63], v[80:95]
    v_mfma_f32_32x32x16_bf16 v[64:79], v[36:39], a[64:67], v[64:79]
    ds_read_b128 v[32:35], v4 offset:39936
    ds_read_b128 v[36:39], v4 offset:40960
    s_waitcnt lgkmcnt(6)
    v_mfma_f32_32x32x16_bf16 v[80:95], v[40:43], a[64:67], v[80:95]
    s_add_u32 s43, s27, 16384
    buffer_load_dwordx4 v[156:159], v240, s[8:11], s43 offen sc1
    v_mfma_f32_32x32x16_bf16 v[64:79], v[44:47], a[68:71], v[64:79]
    ds_read_b128 v[40:43], v11 offset:0
    ds_read_b128 v[44:47], v4 offset:41984
    s_waitcnt lgkmcnt(6)
    v_mfma_f32_32x32x16_bf16 v[80:95], v[16:19], a[68:71], v[80:95]
    buffer_load_dwordx4 v[160:163], v241, s[8:11], s43 offen sc1
    v_mfma_f32_32x32x16_bf16 v[64:79], v[20:23], a[72:75], v[64:79]
    ds_read_b128 v[16:19], v11 offset:1024
    ds_read_b128 v[20:23], v4 offset:43008
    s_waitcnt lgkmcnt(6)
    v_mfma_f32_32x32x16_bf16 v[80:95], v[24:27], a[72:75], v[80:95]
    v_mfma_f32_32x32x16_bf16 v[64:79], v[28:31], a[76:79], v[64:79]
    buffer_load_dwordx4 v[164:167], v242, s[8:11], s43 offen sc1
    ds_read_b128 v[24:27], v11 offset:2048
    ds_read_b128 v[28:31], v4 offset:44032
    s_waitcnt lgkmcnt(6)
    v_mfma_f32_32x32x16_bf16 v[80:95], v[32:35], a[76:79], v[80:95]
    s_waitcnt vmcnt(10)
    s_mov_b64 exec, 1
    buffer_atomic_add v14, v13, s[8:11], s33 offen offset:128 sc1
    s_mov_b64 exec, -1
    v_mfma_f32_32x32x16_bf16 v[64:79], v[36:39], a[80:83], v[64:79]
    buffer_load_dwordx4 v[228:231], v243, s[8:11], s43 offen sc1
    ds_read_b128 v[32:35], v11 offset:3072
    ds_read_b128 v[36:39], v4 offset:45056
    s_waitcnt lgkmcnt(6)
    v_mfma_f32_32x32x16_bf16 v[80:95], v[40:43], a[80:83], v[80:95]
    v_mfma_f32_32x32x16_bf16 v[64:79], v[44:47], a[84:87], v[64:79]
    ds_read_b128 v[40:43], v11 offset:4096
    ds_read_b128 v[44:47], v4 offset:46080
    s_waitcnt lgkmcnt(6)
    v_mfma_f32_32x32x16_bf16 v[80:95], v[16:19], a[84:87], v[80:95]
    s_add_u32 s43, s27, 18432
    buffer_load_dwordx4 v[232:235], v240, s[8:11], s43 offen sc1
    v_mfma_f32_32x32x16_bf16 v[64:79], v[20:23], a[88:91], v[64:79]
    ds_read_b128 v[16:19], v11 offset:5120
    ds_read_b128 v[20:23], v4 offset:47104
    s_waitcnt lgkmcnt(6)
    v_mfma_f32_32x32x16_bf16 v[80:95], v[24:27], a[88:91], v[80:95]
    buffer_load_dwordx4 v[236:239], v241, s[8:11], s43 offen sc1
    v_mfma_f32_32x32x16_bf16 v[64:79], v[28:31], a[92:95], v[64:79]
    ds_read_b128 v[24:27], v11 offset:6144
    ds_read_b128 v[28:31], v4 offset:48128
    s_waitcnt lgkmcnt(6)
    v_mfma_f32_32x32x16_bf16 v[80:95], v[32:35], a[92:95], v[80:95]
    v_mfma_f32_32x32x16_bf16 v[64:79], v[36:39], a[96:99], v[64:79]
    buffer_load_dwordx4 a[0:3], v242, s[8:11], s43 offen sc1
    ds_read_b128 v[32:35], v11 offset:7168
    ds_read_b128 v[36:39], v4 offset:49152
    s_waitcnt lgkmcnt(6)
    v_mfma_f32_32x32x16_bf16 v[80:95], v[40:43], a[96:99], v[80:95]
    v_mfma_f32_32x32x16_bf16 v[64:79], v[44:47], a[100:103], v[64:79]
    buffer_load_dwordx4 a[4:7], v243, s[8:11], s43 offen sc1
    ds_read_b128 v[40:43], v11 offset:8192
    ds_read_b128 v[44:47], v4 offset:50176
    s_waitcnt lgkmcnt(6)
    v_mfma_f32_32x32x16_bf16 v[80:95], v[16:19], a[100:103], v[80:95]
    v_mfma_f32_32x32x16_bf16 v[64:79], v[20:23], a[104:107], v[64:79]
    ds_read_b128 v[16:19], v11 offset:9216
    ds_read_b128 v[20:23], v4 offset:51200
    s_waitcnt lgkmcnt(6)
    v_mfma_f32_32x32x16_bf16 v[80:95], v[24:27], a[104:107], v[80:95]
    s_add_u32 s43, s27, 32768
    buffer_load_dwordx4 a[8:11], v240, s[8:11], s43 offen sc1
    v_mfma_f32_32x32x16_bf16 v[64:79], v[28:31], a[108:111], v[64:79]
    ds_read_b128 v[24:27], v11 offset:10240
    ds_read_b128 v[28:31], v4 offset:52224
    s_waitcnt lgkmcnt(6)
    v_mfma_f32_32x32x16_bf16 v[80:95], v[32:35], a[108:111], v[80:95]
    buffer_load_dwordx4 a[12:15], v241, s[8:11], s43 offen sc1
    v_mfma_f32_32x32x16_bf16 v[64:79], v[36:39], a[112:115], v[64:79]
    ds_read_b128 v[32:35], v11 offset:11264
    ds_read_b128 v[36:39], v4 offset:53248
    s_waitcnt lgkmcnt(6)
    v_mfma_f32_32x32x16_bf16 v[80:95], v[40:43], a[112:115], v[80:95]
    v_mfma_f32_32x32x16_bf16 v[64:79], v[44:47], a[116:119], v[64:79]
    buffer_load_dwordx4 a[16:19], v242, s[8:11], s43 offen sc1
    ds_read_b128 v[40:43], v11 offset:12288
    ds_read_b128 v[44:47], v4 offset:54272
    s_waitcnt lgkmcnt(6)
    v_mfma_f32_32x32x16_bf16 v[80:95], v[16:19], a[116:119], v[80:95]
    v_mfma_f32_32x32x16_bf16 v[64:79], v[20:23], a[120:123], v[64:79]
    buffer_load_dwordx4 a[20:23], v243, s[8:11], s43 offen sc1
    ds_read_b128 v[16:19], v11 offset:13312
    ds_read_b128 v[20:23], v4 offset:55296
    s_waitcnt lgkmcnt(6)
    v_mfma_f32_32x32x16_bf16 v[80:95], v[24:27], a[120:123], v[80:95]
    v_mfma_f32_32x32x16_bf16 v[64:79], v[28:31], a[124:127], v[64:79]
    ds_read_b128 v[24:27], v11 offset:14336
    ds_read_b128 v[28:31], v4 offset:56320
    s_waitcnt lgkmcnt(6)
    v_mfma_f32_32x32x16_bf16 v[80:95], v[32:35], a[124:127], v[80:95]
    s_add_u32 s43, s27, 34816
    buffer_load_dwordx4 a[24:27], v240, s[8:11], s43 offen sc1
    v_mfma_f32_32x32x16_bf16 v[64:79], v[36:39], a[128:131], v[64:79]
    ds_read_b128 v[32:35], v11 offset:15360
    ds_read_b128 v[36:39], v4 offset:57344
    s_waitcnt lgkmcnt(6)
    v_mfma_f32_32x32x16_bf16 v[80:95], v[40:43], a[128:131], v[80:95]
    buffer_load_dwordx4 a[28:31], v241, s[8:11], s43 offen sc1
    v_mfma_f32_32x32x16_bf16 v[64:79], v[44:47], a[132:135], v[64:79]
    ds_read_b128 v[40:43], v11 offset:16384
    ds_read_b128 v[44:47], v4 offset:58368
    s_waitcnt lgkmcnt(6)
    v_mfma_f32_32x32x16_bf16 v[80:95], v[16:19], a[132:135], v[80:95]
    v_mfma_f32_32x32x16_bf16 v[64:79], v[20:23], a[136:139], v[64:79]
    buffer_load_dwordx4 a[32:35], v242, s[8:11], s43 offen sc1
    ds_read_b128 v[16:19], v11 offset:17408
    ds_read_b128 v[20:23], v4 offset:59392
    s_waitcnt lgkmcnt(6)
    v_mfma_f32_32x32x16_bf16 v[80:95], v[24:27], a[136:139], v[80:95]
    v_mfma_f32_32x32x16_bf16 v[64:79], v[28:31], a[140:143], v[64:79]
    buffer_load_dwordx4 a[36:39], v243, s[8:11], s43 offen sc1
    ds_read_b128 v[24:27], v11 offset:18432
    ds_read_b128 v[28:31], v4 offset:60416
    s_waitcnt lgkmcnt(6)
    v_mfma_f32_32x32x16_bf16 v[80:95], v[32:35], a[140:143], v[80:95]
    v_mfma_f32_32x32x16_bf16 v[64:79], v[36:39], a[144:147], v[64:79]
    ds_read_b128 v[32:35], v11 offset:19456
    ds_read_b128 v[36:39], v7 offset:2560
    s_waitcnt lgkmcnt(6)
    v_mfma_f32_32x32x16_bf16 v[80:95], v[40:43], a[144:147], v[80:95]
    s_add_u32 s42, s26, 163840
    buffer_load_dwordx4 a[40:43], v4, s[8:11], s42 offen offset:0 sc1
    v_mfma_f32_32x32x16_bf16 v[64:79], v[44:47], a[148:151], v[64:79]
    ds_read_b128 v[40:43], v7 offset:3072
    s_waitcnt lgkmcnt(5)
    v_mfma_f32_32x32x16_bf16 v[80:95], v[16:19], a[148:151], v[80:95]
    buffer_load_dwordx4 a[44:47], v4, s[8:11], s42 offen offset:1024 sc1
    v_mfma_f32_32x32x16_bf16 v[64:79], v[20:23], a[152:155], v[64:79]
    s_waitcnt lgkmcnt(3)
    v_mfma_f32_32x32x16_bf16 v[80:95], v[24:27], a[152:155], v[80:95]
    v_mfma_f32_32x32x16_bf16 v[64:79], v[28:31], a[156:159], v[64:79]
    buffer_load_dwordx4 a[48:51], v4, s[8:11], s42 offen offset:2048 sc1
    s_waitcnt lgkmcnt(1)
    v_mfma_f32_32x32x16_bf16 v[80:95], v[32:35], a[156:159], v[80:95]
    v_mfma_f32_32x32x16_bf16 v[64:79], v[36:39], v[112:115], v[64:79]
    buffer_load_dwordx4 a[52:55], v4, s[8:11], s42 offen offset:3072 sc1
    s_waitcnt lgkmcnt(0)
    v_mfma_f32_32x32x16_bf16 v[80:95], v[40:43], v[112:115], v[80:95]
L_l3_g2b:
    v_mov_b32 v15, 0
    s_mov_b64 exec, 1
    buffer_atomic_add v15, v5, s[8:11], s34 offen offset:128 sc0 sc1
    s_mov_b64 exec, -1
    s_waitcnt vmcnt(26)
    v_mfma_f32_16x16x32_bf16 v[16:19], a[160:163], v[124:127], 0
    v_mfma_f32_16x16x32_bf16 v[20:23], a[164:167], v[124:127], 0
    v_mfma_f32_16x16x32_bf16 v[24:27], a[168:171], v[124:127], 0
    v_mfma_f32_16x16x32_bf16 v[28:31], a[172:175], v[124:127], 0
    s_add_u32 s42, s26, 167936
    buffer_load_dwordx4 a[56:59], v4, s[8:11], s42 offen offset:0 sc1
    v_mfma_f32_16x16x32_bf16 v[32:35], a[176:179], v[124:127], 0
    v_mul_f32 v64, v64, v72
    v_mul_f32 v65, v65, v73
    v_mfma_f32_16x16x32_bf16 v[36:39], a[160:163], v[128:131], 0
    v_mul_f32 v66, v66, v74
    v_mul_f32 v67, v67, v75
    v_mfma_f32_16x16x32_bf16 v[40:43], a[164:167], v[128:131], 0
    v_mul_f32 v68, v68, v76
    v_mul_f32 v69, v69, v77
    v_mfma_f32_16x16x32_bf16 v[44:47], a[168:171], v[128:131], 0
    v_mul_f32 v70, v70, v78
    v_mul_f32 v71, v71, v79
    v_mfma_f32_16x16x32_bf16 v[48:51], a[172:175], v[128:131], 0
    v_mul_f32 v64, v9, v64
    v_mul_f32 v65, v9, v65
    v_mfma_f32_16x16x32_bf16 v[52:55], a[176:179], v[128:131], 0
    v_mul_f32 v66, v9, v66
    v_mul_f32 v67, v9, v67
    v_mfma_f32_16x16x32_bf16 v[56:59], a[160:163], v[132:135], 0
    v_mul_f32 v68, v9, v68
    v_mul_f32 v69, v9, v69
    v_mfma_f32_16x16x32_bf16 v[60:63], a[164:167], v[132:135], 0
    v_mul_f32 v70, v9, v70
    v_mul_f32 v71, v9, v71
    v_mfma_f32_16x16x32_bf16 v[96:99], a[168:171], v[132:135], 0
    v_cvt_pk_bf16_f32 v72, v64, v65
    v_cvt_pk_bf16_f32 v73, v66, v67
    v_mfma_f32_16x16x32_bf16 v[100:103], a[172:175], v[132:135], 0
    v_cvt_pk_bf16_f32 v74, v68, v69
    v_cvt_pk_bf16_f32 v75, v70, v71
    v_mfma_f32_16x16x32_bf16 v[104:107], a[176:179], v[132:135], 0
    buffer_store_dwordx4 v[72:75], v4, s[8:11], s24 offen sc1
    s_add_u32 s24, s24, 16384
    v_mul_f32 v80, v80, v88
    v_mfma_f32_16x16x32_bf16 v[108:111], a[160:163], v[136:139], 0
    v_mul_f32 v81, v81, v89
    v_mul_f32 v82, v82, v90
    v_mfma_f32_16x16x32_bf16 v[112:115], a[164:167], v[136:139], 0
    v_mul_f32 v83, v83, v91
    v_mul_f32 v84, v84, v92
    v_mfma_f32_16x16x32_bf16 v[116:119], a[168:171], v[136:139], 0
    v_mul_f32 v85, v85, v93
    v_mul_f32 v86, v86, v94
    v_mfma_f32_16x16x32_bf16 v[64:67], a[172:175], v[136:139], 0
    v_mul_f32 v87, v87, v95
    v_mul_f32 v80, v9, v80
    v_mfma_f32_16x16x32_bf16 v[68:71], a[176:179], v[136:139], 0
    v_mul_f32 v81, v9, v81
    v_mul_f32 v82, v9, v82
    s_waitcnt vmcnt(24)
    v_mfma_f32_16x16x32_bf16 v[16:19], a[180:183], v[140:143], v[16:19]
    v_mul_f32 v83, v9, v83
    v_mul_f32 v84, v9, v84
    v_mfma_f32_16x16x32_bf16 v[20:23], a[184:187], v[140:143], v[20:23]
    v_mul_f32 v85, v9, v85
    v_mul_f32 v86, v9, v86
    v_mfma_f32_16x16x32_bf16 v[24:27], a[188:191], v[140:143], v[24:27]
    v_mul_f32 v87, v9, v87
    v_cvt_pk_bf16_f32 v88, v80, v81
    v_mfma_f32_16x16x32_bf16 v[28:31], a[192:195], v[140:143], v[28:31]
    v_cvt_pk_bf16_f32 v89, v82, v83
    v_cvt_pk_bf16_f32 v90, v84, v85
    v_mfma_f32_16x16x32_bf16 v[32:35], a[196:199], v[140:143], v[32:35]
    v_cvt_pk_bf16_f32 v91, v86, v87
    s_add_u32 s24, s24, s35
    buffer_store_dwordx4 v[88:91], v4, s[8:11], s24 offen sc1
    v_mfma_f32_16x16x32_bf16 v[36:39], a[180:183], v[144:147], v[36:39]
    v_mfma_f32_16x16x32_bf16 v[40:43], a[184:187], v[144:147], v[40:43]
    v_mfma_f32_16x16x32_bf16 v[44:47], a[188:191], v[144:147], v[44:47]
    s_add_u32 s42, s26, 168960
    buffer_load_dwordx4 a[60:63], v4, s[8:11], s42 offen offset:0 sc1
    v_mfma_f32_16x16x32_bf16 v[48:51], a[192:195], v[144:147], v[48:51]
    v_mfma_f32_16x16x32_bf16 v[52:55], a[196:199], v[144:147], v[52:55]
    v_mfma_f32_16x16x32_bf16 v[56:59], a[180:183], v[148:151], v[56:59]
    v_mfma_f32_16x16x32_bf16 v[60:63], a[184:187], v[148:151], v[60:63]
    buffer_load_dwordx4 a[64:67], v4, s[8:11], s42 offen offset:1024 sc1
    v_mfma_f32_16x16x32_bf16 v[96:99], a[188:191], v[148:151], v[96:99]
    v_mfma_f32_16x16x32_bf16 v[100:103], a[192:195], v[148:151], v[100:103]
    v_mfma_f32_16x16x32_bf16 v[104:107], a[196:199], v[148:151], v[104:107]
    v_mfma_f32_16x16x32_bf16 v[108:111], a[180:183], v[152:155], v[108:111]
    buffer_load_dwordx4 a[68:71], v4, s[8:11], s42 offen offset:2048 sc1
    v_mfma_f32_16x16x32_bf16 v[112:115], a[184:187], v[152:155], v[112:115]
    v_mfma_f32_16x16x32_bf16 v[116:119], a[188:191], v[152:155], v[116:119]
    v_mfma_f32_16x16x32_bf16 v[64:67], a[192:195], v[152:155], v[64:67]
    v_mfma_f32_16x16x32_bf16 v[68:71], a[196:199], v[152:155], v[68:71]
    buffer_load_dwordx4 a[72:75], v4, s[8:11], s42 offen offset:3072 sc1
    s_waitcnt vmcnt(7)
    s_mov_b32 s52, 20000
L_l3_pc2:
    v_cmp_gt_u32 vcc, 8, v15
    s_sub_u32 s52, s52, 1
    s_cselect_b32 s53, 0, vcc_lo
    s_and_b32 s53, s53, 1
    s_cbranch_scc0 L_l3_ok2
    s_sleep 1
    v_mov_b32 v15, 0
    s_mov_b64 exec, 1
    buffer_atomic_add v15, v5, s[8:11], s34 offen offset:128 sc0 sc1
    s_mov_b64 exec, -1
    s_waitcnt vmcnt(0)
    s_branch L_l3_pc2
L_l3_ok2:
    v_mfma_f32_16x16x32_bf16 v[16:19], a[200:203], v[156:159], v[16:19]
    v_mfma_f32_16x16x32_bf16 v[20:23], a[204:207], v[156:159], v[20:23]
    v_mfma_f32_16x16x32_bf16 v[24:27], a[208:211], v[156:159], v[24:27]
    v_mfma_f32_16x16x32_bf16 v[28:31], a[212:215], v[156:159], v[28:31]
    s_add_u32 s43, s27, 49152
    buffer_load_dwordx4 a[76:79], v240, s[8:11], s43 offen sc1
    v_mfma_f32_16x16x32_bf16 v[32:35], a[216:219], v[156:159], v[32:35]
    v_mfma_f32_16x16x32_bf16 v[36:39], a[200:203], v[160:163], v[36:39]
    v_mfma_f32_16x16x32_bf16 v[40:43], a[204:207], v[160:163], v[40:43]
    v_mfma_f32_16x16x32_bf16 v[44:47], a[208:211], v[160:163], v[44:47]
    buffer_load_dwordx4 a[80:83], v241, s[8:11], s43 offen sc1
    v_mfma_f32_16x16x32_bf16 v[48:51], a[212:215], v[160:163], v[48:51]
    v_mfma_f32_16x16x32_bf16 v[52:55], a[216:219], v[160:163], v[52:55]
    v_mfma_f32_16x16x32_bf16 v[56:59], a[200:203], v[164:167], v[56:59]
    v_mfma_f32_16x16x32_bf16 v[60:63], a[204:207], v[164:167], v[60:63]
    buffer_load_dwordx4 a[84:87], v242, s[8:11], s43 offen sc1
    v_mfma_f32_16x16x32_bf16 v[96:99], a[208:211], v[164:167], v[96:99]
    v_mfma_f32_16x16x32_bf16 v[100:103], a[212:215], v[164:167], v[100:103]
    v_mfma_f32_16x16x32_bf16 v[104:107], a[216:219], v[164:167], v[104:107]
    v_mfma_f32_16x16x32_bf16 v[108:111], a[200:203], v[228:231], v[108:111]
    buffer_load_dwordx4 a[88:91], v243, s[8:11], s43 offen sc1
    v_mfma_f32_16x16x32_bf16 v[112:115], a[204:207], v[228:231], v[112:115]
    v_mfma_f32_16x16x32_bf16 v[116:119], a[208:211], v[228:231], v[116:119]
    v_mfma_f32_16x16x32_bf16 v[64:67], a[212:215], v[228:231], v[64:67]
    v_mfma_f32_16x16x32_bf16 v[68:71], a[216:219], v[228:231], v[68:71]
    s_add_u32 s43, s27, 51200
    buffer_load_dwordx4 a[92:95], v240, s[8:11], s43 offen sc1
    s_waitcnt vmcnt(9)
    s_mov_b64 exec, 1
    buffer_atomic_add v14, v13, s[8:11], s33 offen offset:256 sc1
    s_mov_b64 exec, -1
    v_mfma_f32_16x16x32_bf16 v[16:19], a[220:223], v[232:235], v[16:19]
    v_mfma_f32_16x16x32_bf16 v[20:23], a[224:227], v[232:235], v[20:23]
    v_mfma_f32_16x16x32_bf16 v[24:27], a[228:231], v[232:235], v[24:27]
    v_mfma_f32_16x16x32_bf16 v[28:31], a[232:235], v[232:235], v[28:31]
    buffer_load_dwordx4 a[96:99], v241, s[8:11], s43 offen sc1
    v_mfma_f32_16x16x32_bf16 v[32:35], a[236:239], v[232:235], v[32:35]
    v_mfma_f32_16x16x32_bf16 v[36:39], a[220:223], v[236:239], v[36:39]
    v_mfma_f32_16x16x32_bf16 v[40:43], a[224:227], v[236:239], v[40:43]
    v_mfma_f32_16x16x32_bf16 v[44:47], a[228:231], v[236:239], v[44:47]
    buffer_load_dwordx4 a[100:103], v242, s[8:11], s43 offen sc1
    v_mfma_f32_16x16x32_bf16 v[48:51], a[232:235], v[236:239], v[48:51]
    v_mfma_f32_16x16x32_bf16 v[52:55], a[236:239], v[236:239], v[52:55]
    v_mfma_f32_16x16x32_bf16 v[56:59], a[220:223], a[0:3], v[56:59]
    v_mfma_f32_16x16x32_bf16 v[60:63], a[224:227], a[0:3], v[60:63]
    buffer_load_dwordx4 a[104:107], v243, s[8:11], s43 offen sc1
    v_mfma_f32_16x16x32_bf16 v[96:99], a[228:231], a[0:3], v[96:99]
    v_mfma_f32_16x16x32_bf16 v[100:103], a[232:235], a[0:3], v[100:103]
    v_mfma_f32_16x16x32_bf16 v[104:107], a[236:239], a[0:3], v[104:107]
    v_mfma_f32_16x16x32_bf16 v[108:111], a[220:223], a[4:7], v[108:111]
    s_add_u32 s43, s27, 65536
    buffer_load_dwordx4 a[108:111], v240, s[8:11], s43 offen sc1
    v_mfma_f32_16x16x32_bf16 v[112:115], a[224:227], a[4:7], v[112:115]
    v_mfma_f32_16x16x32_bf16 v[116:119], a[228:231], a[4:7], v[116:119]
    v_mfma_f32_16x16x32_bf16 v[64:67], a[232:235], a[4:7], v[64:67]
    v_mfma_f32_16x16x32_bf16 v[68:71], a[236:239], a[4:7], v[68:71]
    buffer_load_dwordx4 a[112:115], v241, s[8:11], s43 offen sc1
    v_mfma_f32_16x16x32_bf16 v[16:19], a[240:243], a[8:11], v[16:19]
    v_mfma_f32_16x16x32_bf16 v[20:23], a[244:247], a[8:11], v[20:23]
    v_mfma_f32_16x16x32_bf16 v[24:27], a[248:251], a[8:11], v[24:27]
    v_mfma_f32_16x16x32_bf16 v[28:31], a[252:255], a[8:11], v[28:31]
    buffer_load_dwordx4 a[116:119], v242, s[8:11], s43 offen sc1
    v_mfma_f32_16x16x32_bf16 v[32:35], v[168:171], a[8:11], v[32:35]
    v_mfma_f32_16x16x32_bf16 v[36:39], a[240:243], a[12:15], v[36:39]
    v_mfma_f32_16x16x32_bf16 v[40:43], a[244:247], a[12:15], v[40:43]
    v_mfma_f32_16x16x32_bf16 v[44:47], a[248:251], a[12:15], v[44:47]
    buffer_load_dwordx4 a[120:123], v243, s[8:11], s43 offen sc1
    v_mfma_f32_16x16x32_bf16 v[48:51], a[252:255], a[12:15], v[48:51]
    v_mfma_f32_16x16x32_bf16 v[52:55], v[168:171], a[12:15], v[52:55]
    v_mfma_f32_16x16x32_bf16 v[56:59], a[240:243], a[16:19], v[56:59]
    v_mfma_f32_16x16x32_bf16 v[60:63], a[244:247], a[16:19], v[60:63]
    s_add_u32 s43, s27, 67584
    buffer_load_dwordx4 a[124:127], v240, s[8:11], s43 offen sc1
    v_mfma_f32_16x16x32_bf16 v[96:99], a[248:251], a[16:19], v[96:99]
    v_mfma_f32_16x16x32_bf16 v[100:103], a[252:255], a[16:19], v[100:103]
    v_mfma_f32_16x16x32_bf16 v[104:107], v[168:171], a[16:19], v[104:107]
    v_mfma_f32_16x16x32_bf16 v[108:111], a[240:243], a[20:23], v[108:111]
    buffer_load_dwordx4 a[128:131], v241, s[8:11], s43 offen sc1
    v_mfma_f32_16x16x32_bf16 v[112:115], a[244:247], a[20:23], v[112:115]
    v_mfma_f32_16x16x32_bf16 v[116:119], a[248:251], a[20:23], v[116:119]
    v_mfma_f32_16x16x32_bf16 v[64:67], a[252:255], a[20:23], v[64:67]
    v_mfma_f32_16x16x32_bf16 v[68:71], v[168:171], a[20:23], v[68:71]
    buffer_load_dwordx4 a[132:135], v242, s[8:11], s43 offen sc1
    v_mov_b32 v15, 0
    s_mov_b64 exec, 3
    buffer_atomic_add v15, v5, s[8:11], s34 offen offset:256 sc0 sc1
    s_mov_b64 exec, -1
    v_mfma_f32_16x16x32_bf16 v[16:19], v[172:175], a[24:27], v[16:19]
    v_mfma_f32_16x16x32_bf16 v[20:23], v[176:179], a[24:27], v[20:23]
    v_mfma_f32_16x16x32_bf16 v[24:27], v[180:183], a[24:27], v[24:27]
    v_mfma_f32_16x16x32_bf16 v[28:31], v[184:187], a[24:27], v[28:31]
    buffer_load_dwordx4 a[136:139], v243, s[8:11], s43 offen sc1
    v_mfma_f32_16x16x32_bf16 v[32:35], v[188:191], a[24:27], v[32:35]
    v_mfma_f32_16x16x32_bf16 v[36:39], v[172:175], a[28:31], v[36:39]
    v_mfma_f32_16x16x32_bf16 v[40:43], v[176:179], a[28:31], v[40:43]
    v_mfma_f32_16x16x32_bf16 v[44:47], v[180:183], a[28:31], v[44:47]
    s_add_u32 s42, s26, 173056
    buffer_load_dwordx4 a[140:143], v4, s[8:11], s42 offen offset:0 sc1
    v_mfma_f32_16x16x32_bf16 v[48:51], v[184:187], a[28:31], v[48:51]
    v_mfma_f32_16x16x32_bf16 v[52:55], v[188:191], a[28:31], v[52:55]
    v_mfma_f32_16x16x32_bf16 v[56:59], v[172:175], a[32:35], v[56:59]
    v_mfma_f32_16x16x32_bf16 v[60:63], v[176:179], a[32:35], v[60:63]
    s_add_u32 s42, s26, 204800
    buffer_load_dwordx4 a[144:147], v4, s[8:11], s42 offen offset:0 sc1
    v_mfma_f32_16x16x32_bf16 v[96:99], v[180:183], a[32:35], v[96:99]
    v_mfma_f32_16x16x32_bf16 v[100:103], v[184:187], a[32:35], v[100:103]
    v_mfma_f32_16x16x32_bf16 v[104:107], v[188:191], a[32:35], v[104:107]
    v_mfma_f32_16x16x32_bf16 v[108:111], v[172:175], a[36:39], v[108:111]
    buffer_load_dwordx4 a[148:151], v4, s[8:11], s42 offen offset:1024 sc1
    v_mfma_f32_16x16x32_bf16 v[112:115], v[176:179], a[36:39], v[112:115]
    v_mfma_f32_16x16x32_bf16 v[116:119], v[180:183], a[36:39], v[116:119]
    v_mfma_f32_16x16x32_bf16 v[64:67], v[184:187], a[36:39], v[64:67]
    v_mfma_f32_16x16x32_bf16 v[68:71], v[188:191], a[36:39], v[68:71]
    buffer_load_dwordx4 a[152:155], v4, s[8:11], s42 offen offset:2048 sc1
    s_waitcnt vmcnt(18)
    v_mfma_f32_16x16x32_bf16 v[16:19], v[192:195], a[76:79], v[16:19]
    v_mfma_f32_16x16x32_bf16 v[20:23], v[196:199], a[76:79], v[20:23]
    v_mfma_f32_16x16x32_bf16 v[24:27], v[200:203], a[76:79], v[24:27]
    v_mfma_f32_16x16x32_bf16 v[28:31], v[204:207], a[76:79], v[28:31]
    buffer_load_dwordx4 a[156:159], v4, s[8:11], s42 offen offset:3072 sc1
    v_mfma_f32_16x16x32_bf16 v[32:35], v[208:211], a[76:79], v[32:35]
    v_mfma_f32_16x16x32_bf16 v[36:39], v[192:195], a[80:83], v[36:39]
    v_mfma_f32_16x16x32_bf16 v[40:43], v[196:199], a[80:83], v[40:43]
    v_mfma_f32_16x16x32_bf16 v[44:47], v[200:203], a[80:83], v[44:47]
    s_add_u32 s42, s26, 208896
    buffer_load_dwordx4 v[124:127], v4, s[8:11], s42 offen offset:0 sc1
    v_mfma_f32_16x16x32_bf16 v[48:51], v[204:207], a[80:83], v[48:51]
    v_mfma_f32_16x16x32_bf16 v[52:55], v[208:211], a[80:83], v[52:55]
    v_mfma_f32_16x16x32_bf16 v[56:59], v[192:195], a[84:87], v[56:59]
    v_mfma_f32_16x16x32_bf16 v[60:63], v[196:199], a[84:87], v[60:63]
    s_add_u32 s42, s26, 209920
    buffer_load_dwordx4 v[128:131], v4, s[8:11], s42 offen offset:0 sc1
    v_mfma_f32_16x16x32_bf16 v[96:99], v[200:203], a[84:87], v[96:99]
    v_mfma_f32_16x16x32_bf16 v[100:103], v[204:207], a[84:87], v[100:103]
    v_mfma_f32_16x16x32_bf16 v[104:107], v[208:211], a[84:87], v[104:107]
    v_mfma_f32_16x16x32_bf16 v[108:111], v[192:195], a[88:91], v[108:111]
    buffer_load_dwordx4 v[132:135], v4, s[8:11], s42 offen offset:1024 sc1
    v_mfma_f32_16x16x32_bf16 v[112:115], v[196:199], a[88:91], v[112:115]
    v_mfma_f32_16x16x32_bf16 v[116:119], v[200:203], a[88:91], v[116:119]
    v_mfma_f32_16x16x32_bf16 v[64:67], v[204:207], a[88:91], v[64:67]
    v_mfma_f32_16x16x32_bf16 v[68:71], v[208:211], a[88:91], v[68:71]
    buffer_load_dwordx4 v[136:139], v4, s[8:11], s42 offen offset:2048 sc1
    s_waitcnt vmcnt(10)
    s_mov_b32 s52, 20000
L_l3_pc3:
    v_cmp_gt_u32 vcc, 8, v15
    s_sub_u32 s52, s52, 1
    s_cselect_b32 s53, 0, vcc_lo
    s_and_b32 s53, s53, 3
    s_cbranch_scc0 L_l3_ok3
    s_sleep 1
    v_mov_b32 v15, 0
    s_mov_b64 exec, 3
    buffer_atomic_add v15, v5, s[8:11], s34 offen offset:256 sc0 sc1
    s_mov_b64 exec, -1
    s_waitcnt vmcnt(0)
    s_branch L_l3_pc3
L_l3_ok3:
    v_mfma_f32_16x16x32_bf16 v[16:19], v[212:215], a[92:95], v[16:19]
    v_mfma_f32_16x16x32_bf16 v[20:23], v[216:219], a[92:95], v[20:23]
    s_add_u32 s43, s27, 81920
    buffer_load_dwordx4 a[160:163], v240, s[8:11], s43 offen sc1
    v_mfma_f32_16x16x32_bf16 v[24:27], v[220:223], a[92:95], v[24:27]
    v_mfma_f32_16x16x32_bf16 v[28:31], v[224:227], a[92:95], v[28:31]
    buffer_load_dwordx4 a[164:167], v241, s[8:11], s43 offen sc1
    v_mfma_f32_16x16x32_bf16 v[32:35], v[120:123], a[92:95], v[32:35]
    v_mfma_f32_16x16x32_bf16 v[36:39], v[212:215], a[96:99], v[36:39]
    buffer_load_dwordx4 a[168:171], v242, s[8:11], s43 offen sc1
    v_mfma_f32_16x16x32_bf16 v[40:43], v[216:219], a[96:99], v[40:43]
    v_mfma_f32_16x16x32_bf16 v[44:47], v[220:223], a[96:99], v[44:47]
    buffer_load_dwordx4 a[172:175], v243, s[8:11], s43 offen sc1
    v_mfma_f32_16x16x32_bf16 v[48:51], v[224:227], a[96:99], v[48:51]
    v_mfma_f32_16x16x32_bf16 v[52:55], v[120:123], a[96:99], v[52:55]
    s_add_u32 s43, s27, 83968
    buffer_load_dwordx4 a[176:179], v240, s[8:11], s43 offen sc1
    v_mfma_f32_16x16x32_bf16 v[56:59], v[212:215], a[100:103], v[56:59]
    v_mfma_f32_16x16x32_bf16 v[60:63], v[216:219], a[100:103], v[60:63]
    buffer_load_dwordx4 v[140:143], v241, s[8:11], s43 offen sc1
    v_mfma_f32_16x16x32_bf16 v[96:99], v[220:223], a[100:103], v[96:99]
    v_mfma_f32_16x16x32_bf16 v[100:103], v[224:227], a[100:103], v[100:103]
    buffer_load_dwordx4 v[144:147], v242, s[8:11], s43 offen sc1
    v_mfma_f32_16x16x32_bf16 v[104:107], v[120:123], a[100:103], v[104:107]
    v_mfma_f32_16x16x32_bf16 v[108:111], v[212:215], a[104:107], v[108:111]
    buffer_load_dwordx4 v[148:151], v243, s[8:11], s43 offen sc1
    v_mfma_f32_16x16x32_bf16 v[112:115], v[216:219], a[104:107], v[112:115]
    v_mfma_f32_16x16x32_bf16 v[116:119], v[220:223], a[104:107], v[116:119]
    s_add_u32 s43, s29, 98304
    buffer_load_dwordx4 v[152:155], v240, s[8:11], s43 offen sc1
    v_mfma_f32_16x16x32_bf16 v[64:67], v[224:227], a[104:107], v[64:67]
    v_mfma_f32_16x16x32_bf16 v[68:71], v[120:123], a[104:107], v[68:71]
    buffer_load_dwordx4 a[180:183], v241, s[8:11], s43 offen sc1
    v_mfma_f32_16x16x32_bf16 v[16:19], a[40:43], a[108:111], v[16:19]
    v_mfma_f32_16x16x32_bf16 v[20:23], a[44:47], a[108:111], v[20:23]
    buffer_load_dwordx4 a[184:187], v242, s[8:11], s43 offen sc1
    v_mfma_f32_16x16x32_bf16 v[24:27], a[48:51], a[108:111], v[24:27]
    v_mfma_f32_16x16x32_bf16 v[28:31], a[52:55], a[108:111], v[28:31]
    buffer_load_dwordx4 a[188:191], v243, s[8:11], s43 offen sc1
    v_mfma_f32_16x16x32_bf16 v[32:35], a[56:59], a[108:111], v[32:35]
    v_mfma_f32_16x16x32_bf16 v[36:39], a[40:43], a[112:115], v[36:39]
    s_add_u32 s43, s29, 100352
    buffer_load_dwordx4 a[192:195], v240, s[8:11], s43 offen sc1
    v_mfma_f32_16x16x32_bf16 v[40:43], a[44:47], a[112:115], v[40:43]
    v_mfma_f32_16x16x32_bf16 v[44:47], a[48:51], a[112:115], v[44:47]
    buffer_load_dwordx4 a[196:199], v241, s[8:11], s43 offen sc1
    v_mfma_f32_16x16x32_bf16 v[48:51], a[52:55], a[112:115], v[48:51]
    v_mfma_f32_16x16x32_bf16 v[52:55], a[56:59], a[112:115], v[52:55]
    buffer_load_dwordx4 v[156:159], v242, s[8:11], s43 offen sc1
    v_mfma_f32_16x16x32_bf16 v[56:59], a[40:43], a[116:119], v[56:59]
    v_mfma_f32_16x16x32_bf16 v[60:63], a[44:47], a[116:119], v[60:63]
    buffer_load_dwordx4 v[160:163], v243, s[8:11], s43 offen sc1
    v_mfma_f32_16x16x32_bf16 v[96:99], a[48:51], a[116:119], v[96:99]
    v_mfma_f32_16x16x32_bf16 v[100:103], a[52:55], a[116:119], v[100:103]
    buffer_load_dwordx4 v[164:167], v4, s[8:11], s42 offen offset:3072 sc1
    v_mfma_f32_16x16x32_bf16 v[104:107], a[56:59], a[116:119], v[104:107]
    v_mfma_f32_16x16x32_bf16 v[108:111], a[40:43], a[120:123], v[108:111]
    s_add_u32 s42, s26, 214016
    buffer_load_dwordx4 v[228:231], v4, s[8:11], s42 offen offset:0 sc1
    v_mfma_f32_16x16x32_bf16 v[112:115], a[44:47], a[120:123], v[112:115]
    v_mfma_f32_16x16x32_bf16 v[116:119], a[48:51], a[120:123], v[116:119]
    s_add_u32 s42, s28, 245760
    buffer_load_dwordx4 a[200:203], v4, s[8:11], s42 offen offset:0 sc1
    v_mfma_f32_16x16x32_bf16 v[64:67], a[52:55], a[120:123], v[64:67]
    v_mfma_f32_16x16x32_bf16 v[68:71], a[56:59], a[120:123], v[68:71]
    buffer_load_dwordx4 a[204:207], v4, s[8:11], s42 offen offset:1024 sc1
    s_waitcnt vmcnt(28)
    v_mfma_f32_16x16x32_bf16 v[16:19], a[60:63], a[124:127], v[16:19]
    v_mfma_f32_16x16x32_bf16 v[20:23], a[64:67], a[124:127], v[20:23]
    buffer_load_dwordx4 a[208:211], v4, s[8:11], s42 offen offset:2048 sc1
    v_mfma_f32_16x16x32_bf16 v[24:27], a[68:71], a[124:127], v[24:27]
    v_mfma_f32_16x16x32_bf16 v[28:31], a[72:75], a[124:127], v[28:31]
    buffer_load_dwordx4 a[212:215], v4, s[8:11], s42 offen offset:3072 sc1
    v_mfma_f32_16x16x32_bf16 v[32:35], a[140:143], a[124:127], v[32:35]
    v_mfma_f32_16x16x32_bf16 v[36:39], a[60:63], a[128:131], v[36:39]
    s_add_u32 s42, s28, 249856
    buffer_load_dwordx4 a[216:219], v4, s[8:11], s42 offen offset:0 sc1
    v_mfma_f32_16x16x32_bf16 v[40:43], a[64:67], a[128:131], v[40:43]
    v_mfma_f32_16x16x32_bf16 v[44:47], a[68:71], a[128:131], v[44:47]
    s_add_u32 s42, s28, 250880
    buffer_load_dwordx4 v[232:235], v4, s[8:11], s42 offen offset:0 sc1
    v_mfma_f32_16x16x32_bf16 v[48:51], a[72:75], a[128:131], v[48:51]
    v_mfma_f32_16x16x32_bf16 v[52:55], a[140:143], a[128:131], v[52:55]
    buffer_load_dwordx4 v[236:239], v4, s[8:11], s42 offen offset:1024 sc1
    v_mfma_f32_16x16x32_bf16 v[56:59], a[60:63], a[132:135], v[56:59]
    v_mfma_f32_16x16x32_bf16 v[60:63], a[64:67], a[132:135], v[60:63]
    buffer_load_dwordx4 a[0:3], v4, s[8:11], s42 offen offset:2048 sc1
    v_mfma_f32_16x16x32_bf16 v[96:99], a[68:71], a[132:135], v[96:99]
    v_mfma_f32_16x16x32_bf16 v[100:103], a[72:75], a[132:135], v[100:103]
    buffer_load_dwordx4 a[4:7], v4, s[8:11], s42 offen offset:3072 sc1
    v_mfma_f32_16x16x32_bf16 v[104:107], a[140:143], a[132:135], v[104:107]
    v_mfma_f32_16x16x32_bf16 v[108:111], a[60:63], a[136:139], v[108:111]
    s_add_u32 s42, s28, 254976
    buffer_load_dwordx4 a[220:223], v4, s[8:11], s42 offen offset:0 sc1
    v_mfma_f32_16x16x32_bf16 v[112:115], a[64:67], a[136:139], v[112:115]
    v_mfma_f32_16x16x32_bf16 v[116:119], a[68:71], a[136:139], v[116:119]
    v_mfma_f32_16x16x32_bf16 v[64:67], a[72:75], a[136:139], v[64:67]
    v_mfma_f32_16x16x32_bf16 v[68:71], a[140:143], a[136:139], v[68:71]
    s_waitcnt vmcnt(24)
    v_mfma_f32_16x16x32_bf16 v[16:19], a[144:147], a[160:163], v[16:19]
    v_mfma_f32_16x16x32_bf16 v[20:23], a[148:151], a[160:163], v[20:23]
    v_mfma_f32_16x16x32_bf16 v[24:27], a[152:155], a[160:163], v[24:27]
    v_mfma_f32_16x16x32_bf16 v[28:31], a[156:159], a[160:163], v[28:31]
    v_mfma_f32_16x16x32_bf16 v[32:35], v[124:127], a[160:163], v[32:35]
    v_mfma_f32_16x16x32_bf16 v[36:39], a[144:147], a[164:167], v[36:39]
    v_mfma_f32_16x16x32_bf16 v[40:43], a[148:151], a[164:167], v[40:43]
    v_mfma_f32_16x16x32_bf16 v[44:47], a[152:155], a[164:167], v[44:47]
    v_mfma_f32_16x16x32_bf16 v[48:51], a[156:159], a[164:167], v[48:51]
    v_mfma_f32_16x16x32_bf16 v[52:55], v[124:127], a[164:167], v[52:55]
    v_mfma_f32_16x16x32_bf16 v[56:59], a[144:147], a[168:171], v[56:59]
    v_mfma_f32_16x16x32_bf16 v[60:63], a[148:151], a[168:171], v[60:63]
    v_mfma_f32_16x16x32_bf16 v[96:99], a[152:155], a[168:171], v[96:99]
    v_mfma_f32_16x16x32_bf16 v[100:103], a[156:159], a[168:171], v[100:103]
    v_mfma_f32_16x16x32_bf16 v[104:107], v[124:127], a[168:171], v[104:107]
    v_mfma_f32_16x16x32_bf16 v[108:111], a[144:147], a[172:175], v[108:111]
    v_mfma_f32_16x16x32_bf16 v[112:115], a[148:151], a[172:175], v[112:115]
    v_mfma_f32_16x16x32_bf16 v[116:119], a[152:155], a[172:175], v[116:119]
    v_mfma_f32_16x16x32_bf16 v[64:67], a[156:159], a[172:175], v[64:67]
    v_mfma_f32_16x16x32_bf16 v[68:71], v[124:127], a[172:175], v[68:71]
    s_waitcnt vmcnt(10)
    v_mfma_f32_16x16x32_bf16 v[16:19], v[128:131], a[176:179], v[16:19]
    v_mfma_f32_16x16x32_bf16 v[20:23], v[132:135], a[176:179], v[20:23]
    v_mfma_f32_16x16x32_bf16 v[24:27], v[136:139], a[176:179], v[24:27]
    v_mfma_f32_16x16x32_bf16 v[28:31], v[164:167], a[176:179], v[28:31]
    v_mfma_f32_16x16x32_bf16 v[32:35], v[228:231], a[176:179], v[32:35]
    v_mfma_f32_16x16x32_bf16 v[36:39], v[128:131], v[140:143], v[36:39]
    v_mfma_f32_16x16x32_bf16 v[40:43], v[132:135], v[140:143], v[40:43]
    v_mfma_f32_16x16x32_bf16 v[44:47], v[136:139], v[140:143], v[44:47]
    v_mfma_f32_16x16x32_bf16 v[48:51], v[164:167], v[140:143], v[48:51]
    v_mfma_f32_16x16x32_bf16 v[52:55], v[228:231], v[140:143], v[52:55]
    v_mfma_f32_16x16x32_bf16 v[56:59], v[128:131], v[144:147], v[56:59]
    v_mfma_f32_16x16x32_bf16 v[60:63], v[132:135], v[144:147], v[60:63]
    s_branch L_pg7c
.p2align 12
L_pg7:
    s_setpc_b64 s[60:61]
L_pg7c:
    v_mfma_f32_16x16x32_bf16 v[96:99], v[136:139], v[144:147], v[96:99]
    v_mfma_f32_16x16x32_bf16 v[100:103], v[164:167], v[144:147], v[100:103]
    v_mfma_f32_16x16x32_bf16 v[104:107], v[228:231], v[144:147], v[104:107]
    v_mfma_f32_16x16x32_bf16 v[108:111], v[128:131], v[148:151], v[108:111]
    v_mfma_f32_16x16x32_bf16 v[112:115], v[132:135], v[148:151], v[112:115]
    v_mfma_f32_16x16x32_bf16 v[116:119], v[136:139], v[148:151], v[116:119]
    v_mfma_f32_16x16x32_bf16 v[64:67], v[164:167], v[148:151], v[64:67]
    v_mfma_f32_16x16x32_bf16 v[68:71], v[228:231], v[148:151], v[68:71]
    s_waitcnt vmcnt(5)
    v_mfma_f32_16x16x32_bf16 v[16:19], a[200:203], v[152:155], v[16:19]
    v_mfma_f32_16x16x32_bf16 v[20:23], a[204:207], v[152:155], v[20:23]
    v_mfma_f32_16x16x32_bf16 v[24:27], a[208:211], v[152:155], v[24:27]
    v_mfma_f32_16x16x32_bf16 v[28:31], a[212:215], v[152:155], v[28:31]
    v_mfma_f32_16x16x32_bf16 v[32:35], a[216:219], v[152:155], v[32:35]
    v_mfma_f32_16x16x32_bf16 v[36:39], a[200:203], a[180:183], v[36:39]
    v_mfma_f32_16x16x32_bf16 v[40:43], a[204:207], a[180:183], v[40:43]
    v_mfma_f32_16x16x32_bf16 v[44:47], a[208:211], a[180:183], v[44:47]
    v_mfma_f32_16x16x32_bf16 v[48:51], a[212:215], a[180:183], v[48:51]
    v_mfma_f32_16x16x32_bf16 v[52:55], a[216:219], a[180:183], v[52:55]
    v_mfma_f32_16x16x32_bf16 v[56:59], a[200:203], a[184:187], v[56:59]
    v_mfma_f32_16x16x32_bf16 v[60:63], a[204:207], a[184:187], v[60:63]
    v_mfma_f32_16x16x32_bf16 v[96:99], a[208:211], a[184:187], v[96:99]
    v_mfma_f32_16x16x32_bf16 v[100:103], a[212:215], a[184:187], v[100:103]
    v_mfma_f32_16x16x32_bf16 v[104:107], a[216:219], a[184:187], v[104:107]
    v_mfma_f32_16x16x32_bf16 v[108:111], a[200:203], a[188:191], v[108:111]
    v_mfma_f32_16x16x32_bf16 v[112:115], a[204:207], a[188:191], v[112:115]
    v_mfma_f32_16x16x32_bf16 v[116:119], a[208:211], a[188:191], v[116:119]
    v_mfma_f32_16x16x32_bf16 v[64:67], a[212:215], a[188:191], v[64:67]
    v_mfma_f32_16x16x32_bf16 v[68:71], a[216:219], a[188:191], v[68:71]
    s_cmp_ge_u32 s3, 2
    s_cbranch_scc1 L_l3_skip
    s_waitcnt vmcnt(0)
    v_mfma_f32_16x16x32_bf16 v[16:19], v[232:235], a[192:195], v[16:19]
    v_mfma_f32_16x16x32_bf16 v[20:23], v[236:239], a[192:195], v[20:23]
    v_mfma_f32_16x16x32_bf16 v[24:27], a[0:3], a[192:195], v[24:27]
    v_mfma_f32_16x16x32_bf16 v[28:31], a[4:7], a[192:195], v[28:31]
    v_mfma_f32_16x16x32_bf16 v[32:35], a[220:223], a[192:195], v[32:35]
    v_mfma_f32_16x16x32_bf16 v[36:39], v[232:235], a[196:199], v[36:39]
    v_mfma_f32_16x16x32_bf16 v[40:43], v[236:239], a[196:199], v[40:43]
    v_mfma_f32_16x16x32_bf16 v[44:47], a[0:3], a[196:199], v[44:47]
    v_mfma_f32_16x16x32_bf16 v[48:51], a[4:7], a[196:199], v[48:51]
    v_mfma_f32_16x16x32_bf16 v[52:55], a[220:223], a[196:199], v[52:55]
    v_mfma_f32_16x16x32_bf16 v[56:59], v[232:235], v[156:159], v[56:59]
    v_mfma_f32_16x16x32_bf16 v[60:63], v[236:239], v[156:159], v[60:63]
    v_mfma_f32_16x16x32_bf16 v[96:99], a[0:3], v[156:159], v[96:99]
    v_mfma_f32_16x16x32_bf16 v[100:103], a[4:7], v[156:159], v[100:103]
    v_mfma_f32_16x16x32_bf16 v[104:107], a[220:223], v[156:159], v[104:107]
    v_mfma_f32_16x16x32_bf16 v[108:111], v[232:235], v[160:163], v[108:111]
    v_mfma_f32_16x16x32_bf16 v[112:115], v[236:239], v[160:163], v[112:115]
    v_mfma_f32_16x16x32_bf16 v[116:119], a[0:3], v[160:163], v[116:119]
    v_mfma_f32_16x16x32_bf16 v[64:67], a[4:7], v[160:163], v[64:67]
    v_mfma_f32_16x16x32_bf16 v[68:71], a[220:223], v[160:163], v[68:71]
    s_nop 7
L_l3_skip:
    s_waitcnt vmcnt(0)
    s_nop 7
    s_add_u32 s52, s3, 1
    s_and_b32 s52, s52, 3
    s_mul_i32 s52, s52, 15360
    s_add_u32 s52, s52, 81920
    v_add_u32 v8, s52, v4
    ds_write_b128 v8, v[36:39] offset:0
    ds_write_b128 v8, v[40:43] offset:1024
    ds_write_b128 v8, v[44:47] offset:2048
    ds_write_b128 v8, v[48:51] offset:3072
    ds_write_b128 v8, v[52:55] offset:4096
    s_add_u32 s52, s3, 2
    s_and_b32 s52, s52, 3
    s_mul_i32 s52, s52, 15360
    s_add_u32 s52, s52, 81920
    v_add_u32 v8, s52, v4
    ds_write_b128 v8, v[56:59] offset:5120
    ds_write_b128 v8, v[60:63] offset:6144
    ds_write_b128 v8, v[96:99] offset:7168
    ds_write_b128 v8, v[100:103] offset:8192
    ds_write_b128 v8, v[104:107] offset:9216
    s_add_u32 s52, s3, 3
    s_and_b32 s52, s52, 3
    s_mul_i32 s52, s52, 15360
    s_add_u32 s52, s52, 81920
    v_add_u32 v8, s52, v4
    ds_write_b128 v8, v[108:111] offset:10240
    ds_write_b128 v8, v[112:115] offset:11264
    ds_write_b128 v8, v[116:119] offset:12288
    ds_write_b128 v8, v[64:67] offset:13312
    ds_write_b128 v8, v[68:71] offset:14336
    v_mul_u32_u24 v9, 80, v3
    v_add_u32 v9, 159104, v9
    ds_read_b128 v[120:123], v9 offset:640
    ds_read_b128 v[124:127], v9 offset:656
    ds_read_b128 v[128:131], v9 offset:672
    ds_read_b128 v[132:135], v9 offset:688
    ds_read_b128 v[136:139], v9 offset:704
    s_mul_i32 s52, s3, 15360
    s_add_u32 s52, s52, 81920
    v_add_u32 v8, s52, v4
    v_lshlrev_b32 v140, 16, v246
    v_and_b32 v141, 0xffff0000, v246
    v_lshlrev_b32 v142, 16, v247
    v_and_b32 v143, 0xffff0000, v247
    v_lshlrev_b32 v144, 16, v248
    v_and_b32 v145, 0xffff0000, v248
    v_lshlrev_b32 v146, 16, v249
    v_and_b32 v147, 0xffff0000, v249
    v_lshlrev_b32 v148, 16, v250
    v_and_b32 v149, 0xffff0000, v250
    v_lshlrev_b32 v150, 16, v251
    v_and_b32 v151, 0xffff0000, v251
    v_lshlrev_b32 v152, 16, v252
    v_and_b32 v153, 0xffff0000, v252
    v_lshlrev_b32 v154, 16, v253
    v_and_b32 v155, 0xffff0000, v253
    v_lshlrev_b32 v156, 16, v254
    v_and_b32 v157, 0xffff0000, v254
    v_lshlrev_b32 v158, 16, v255
    v_and_b32 v159, 0xffff0000, v255
    s_waitcnt lgkmcnt(0)
    s_barrier
    ds_read_b128 v[36:39], v8 offset:0
    ds_read_b128 v[40:43], v8 offset:1024
    ds_read_b128 v[44:47], v8 offset:2048
    ds_read_b128 v[48:51], v8 offset:3072
    ds_read_b128 v[52:55], v8 offset:4096
    ds_read_b128 v[56:59], v8 offset:5120
    ds_read_b128 v[60:63], v8 offset:6144
    ds_read_b128 v[64:67], v8 offset:7168
    ds_read_b128 v[68:71], v8 offset:8192
    ds_read_b128 v[72:75], v8 offset:9216
    ds_read_b128 v[76:79], v8 offset:10240
    ds_read_b128 v[80:83], v8 offset:11264
    ds_read_b128 v[84:87], v8 offset:12288
    ds_read_b128 v[88:91], v8 offset:13312
    ds_read_b128 v[92:95], v8 offset:14336
    s_waitcnt lgkmcnt(10)
    v_pk_add_f32 v[16:17], v[16:17], v[36:37]
    v_pk_add_f32 v[18:19], v[18:19], v[38:39]
    v_pk_add_f32 v[20:21], v[20:21], v[40:41]
    v_pk_add_f32 v[22:23], v[22:23], v[42:43]
    v_pk_add_f32 v[24:25], v[24:25], v[44:45]
    v_pk_add_f32 v[26:27], v[26:27], v[46:47]
    v_pk_add_f32 v[28:29], v[28:29], v[48:49]
    v_pk_add_f32 v[30:31], v[30:31], v[50:51]
    v_pk_add_f32 v[32:33], v[32:33], v[52:53]
    v_pk_add_f32 v[34:35], v[34:35], v[54:55]
    s_waitcnt lgkmcnt(5)
    v_pk_add_f32 v[16:17], v[16:17], v[56:57]
    v_pk_add_f32 v[18:19], v[18:19], v[58:59]
    v_pk_add_f32 v[20:21], v[20:21], v[60:61]
    v_pk_add_f32 v[22:23], v[22:23], v[62:63]
    v_pk_add_f32 v[24:25], v[24:25], v[64:65]
    v_pk_add_f32 v[26:27], v[26:27], v[66:67]
    v_pk_add_f32 v[28:29], v[28:29], v[68:69]
    v_pk_add_f32 v[30:31], v[30:31], v[70:71]
    v_pk_add_f32 v[32:33], v[32:33], v[72:73]
    v_pk_add_f32 v[34:35], v[34:35], v[74:75]
    s_waitcnt lgkmcnt(0)
    v_pk_add_f32 v[16:17], v[16:17], v[76:77]
    v_pk_add_f32 v[18:19], v[18:19], v[78:79]
    v_pk_add_f32 v[20:21], v[20:21], v[80:81]
    v_pk_add_f32 v[22:23], v[22:23], v[82:83]
    v_pk_add_f32 v[24:25], v[24:25], v[84:85]
    v_pk_add_f32 v[26:27], v[26:27], v[86:87]
    v_pk_add_f32 v[28:29], v[28:29], v[88:89]
    v_pk_add_f32 v[30:31], v[30:31], v[90:91]
    v_pk_add_f32 v[32:33], v[32:33], v[92:93]
    v_pk_add_f32 v[34:35], v[34:35], v[94:95]
    v_pk_fma_f32 v[140:141], v[16:17], v[120:121], v[140:141]
    v_pk_fma_f32 v[142:143], v[18:19], v[122:123], v[142:143]
    v_pk_fma_f32 v[144:145], v[20:21], v[124:125], v[144:145]
    v_pk_fma_f32 v[146:147], v[22:23], v[126:127], v[146:147]
    v_pk_fma_f32 v[148:149], v[24:25], v[128:129], v[148:149]
    v_pk_fma_f32 v[150:151], v[26:27], v[130:131], v[150:151]
    v_pk_fma_f32 v[152:153], v[28:29], v[132:133], v[152:153]
    v_pk_fma_f32 v[154:155], v[30:31], v[134:135], v[154:155]
    v_pk_fma_f32 v[156:157], v[32:33], v[136:137], v[156:157]
    v_pk_fma_f32 v[158:159], v[34:35], v[138:139], v[158:159]
    v_cvt_pk_bf16_f32 v96, v140, v141
    v_cvt_pk_bf16_f32 v97, v142, v143
    v_cvt_pk_bf16_f32 v98, v144, v145
    v_cvt_pk_bf16_f32 v99, v146, v147
    v_cvt_pk_bf16_f32 v100, v148, v149
    v_cvt_pk_bf16_f32 v101, v150, v151
    v_cvt_pk_bf16_f32 v102, v152, v153
    v_cvt_pk_bf16_f32 v103, v154, v155
    v_cvt_pk_bf16_f32 v104, v156, v157
    v_cvt_pk_bf16_f32 v105, v158, v159
    buffer_store_dwordx4 v[96:99], v245, s[16:19], s38 offen
    buffer_store_dwordx4 v[100:103], v245, s[16:19], s38 offen offset:16
    buffer_store_dwordx2 v[104:105], v245, s[16:19], s38 offen offset:32
    s_endpgm
L_p3e:
L_g32_s:
    s_setpc_b64 s[60:61]
L_g32:
    s_waitcnt lgkmcnt(0)
    s_mov_b32 s4, 32
    s_sub_u32 s5, s2, 160
    s_call_b64 s[62:63], L_pre2
    s_mov_b32 exec_lo, s68
    s_mov_b32 exec_hi, s68
    s_add_u32 m0, s69, 0
    s_nop 0
    buffer_load_dwordx4 v244, s[24:27], 0 offen lds
    s_add_u32 m0, s69, 1024
    s_nop 0
    buffer_load_dwordx4 v244, s[28:31], 0 offen lds
    s_add_u32 m0, s69, 2048
    s_nop 0
    buffer_load_dwordx4 v245, s[24:27], 0 offen lds
    s_add_u32 m0, s69, 3072
    s_nop 0
    buffer_load_dwordx4 v245, s[28:31], 0 offen lds
    s_add_u32 m0, s69, 4096
    s_nop 0
    buffer_load_dwordx4 v246, s[24:27], 0 offen lds
    s_add_u32 m0, s69, 5120
    s_nop 0
    buffer_load_dwordx4 v246, s[28:31], 0 offen lds
    s_add_u32 m0, s69, 6144
    s_nop 0
    buffer_load_dwordx4 v247, s[24:27], 0 offen lds
    s_add_u32 m0, s69, 7168
    s_nop 0
    buffer_load_dwordx4 v247, s[28:31], 0 offen lds
    s_mov_b64 exec, -1
    s_call_b64 s[62:63], L_pre2b
    s_cmp_lg_u32 s3, 0
    s_cbranch_scc1 L_tc5296_0
    s_call_b64 s[60:61], L_pg1
    s_call_b64 s[60:61], L_pg5
L_tc5296_0:
    s_cmp_lg_u32 s3, 1
    s_cbranch_scc1 L_tc5296_1
    s_call_b64 s[60:61], L_pg2
    s_call_b64 s[60:61], L_pg6
L_tc5296_1:
    s_cmp_lg_u32 s3, 2
    s_cbranch_scc1 L_tc5296_2
    s_call_b64 s[60:61], L_pg3
    s_call_b64 s[60:61], L_pg7
L_tc5296_2:
    s_cmp_lg_u32 s3, 3
    s_cbranch_scc1 L_tc5296_3
    s_call_b64 s[60:61], L_pg4
L_tc5296_3:
    v_mov_b32 v255, 0
    buffer_load_dword v255, v255, s[20:23], 0 offen offset:128 sc1
    s_waitcnt vmcnt(0) lgkmcnt(0)
    s_barrier
    v_add_u32 v249, 122880, v4
    ds_read_b128 a[64:67], v249 offset:0
    ds_read_b128 a[68:71], v249 offset:1024
    ds_read_b128 a[72:75], v249 offset:2048
    ds_read_b128 a[76:79], v249 offset:3072
    ds_read_b128 a[80:83], v249 offset:4096
    ds_read_b128 a[84:87], v249 offset:5120
    ds_read_b128 a[88:91], v249 offset:6144
    ds_read_b128 a[92:95], v249 offset:7168
    s_waitcnt lgkmcnt(0)
    s_barrier
    s_branch L_p2
L_a1fin_s:
    s_setpc_b64 s[60:61]
L_a1fin:
    s_load_dwordx2 s[32:33], s[0:1], 48
    s_mov_b32 s34, 2211840
    s_mov_b32 s35, 0x20000
    s_waitcnt vmcnt(20)
    v_lshlrev_b32 v112, 16, v100
    v_mul_f32 v132, 0xbfb8aa3b, v112
    v_exp_f32 v132, v132
    v_and_b32 v113, 0xffff0000, v100
    v_mul_f32 v133, 0xbfb8aa3b, v113
    v_exp_f32 v133, v133
    v_lshlrev_b32 v114, 16, v101
    v_mul_f32 v134, 0xbfb8aa3b, v114
    v_exp_f32 v134, v134
    v_and_b32 v115, 0xffff0000, v101
    v_mul_f32 v135, 0xbfb8aa3b, v115
    v_exp_f32 v135, v135
    v_lshlrev_b32 v116, 16, v102
    v_mul_f32 v136, 0xbfb8aa3b, v116
    v_exp_f32 v136, v136
    v_and_b32 v117, 0xffff0000, v102
    v_mul_f32 v137, 0xbfb8aa3b, v117
    v_exp_f32 v137, v137
    v_lshlrev_b32 v118, 16, v103
    v_mul_f32 v138, 0xbfb8aa3b, v118
    v_exp_f32 v138, v138
    v_and_b32 v119, 0xffff0000, v103
    v_mul_f32 v139, 0xbfb8aa3b, v119
    v_exp_f32 v139, v139
    v_lshlrev_b32 v120, 16, v104
    v_mul_f32 v140, 0xbfb8aa3b, v120
    v_exp_f32 v140, v140
    v_and_b32 v121, 0xffff0000, v104
    v_mul_f32 v141, 0xbfb8aa3b, v121
    v_exp_f32 v141, v141
    v_lshlrev_b32 v122, 16, v105
    v_mul_f32 v142, 0xbfb8aa3b, v122
    v_exp_f32 v142, v142
    v_and_b32 v123, 0xffff0000, v105
    v_mul_f32 v143, 0xbfb8aa3b, v123
    v_exp_f32 v143, v143
    v_lshlrev_b32 v124, 16, v106
    v_mul_f32 v144, 0xbfb8aa3b, v124
    v_exp_f32 v144, v144
    v_and_b32 v125, 0xffff0000, v106
    v_mul_f32 v145, 0xbfb8aa3b, v125
    v_exp_f32 v145, v145
    v_lshlrev_b32 v126, 16, v107
    v_mul_f32 v146, 0xbfb8aa3b, v126
    v_exp_f32 v146, v146
    v_and_b32 v127, 0xffff0000, v107
    v_mul_f32 v147, 0xbfb8aa3b, v127
    v_exp_f32 v147, v147
    v_lshlrev_b32 v128, 16, v108
    v_mul_f32 v148, 0xbfb8aa3b, v128
    v_exp_f32 v148, v148
    v_and_b32 v129, 0xffff0000, v108
    v_mul_f32 v149, 0xbfb8aa3b, v129
    v_exp_f32 v149, v149
    v_lshlrev_b32 v130, 16, v109
    v_mul_f32 v150, 0xbfb8aa3b, v130
    v_exp_f32 v150, v150
    v_and_b32 v131, 0xffff0000, v109
    v_mul_f32 v151, 0xbfb8aa3b, v131
    v_exp_f32 v151, v151
    v_add_f32 v132, 1.0, v132
    v_rcp_f32 v132, v132
    v_add_f32 v133, 1.0, v133
    v_rcp_f32 v133, v133
    v_add_f32 v134, 1.0, v134
    v_rcp_f32 v134, v134
    v_add_f32 v135, 1.0, v135
    v_rcp_f32 v135, v135
    v_add_f32 v136, 1.0, v136
    v_rcp_f32 v136, v136
    v_add_f32 v137, 1.0, v137
    v_rcp_f32 v137, v137
    v_add_f32 v138, 1.0, v138
    v_rcp_f32 v138, v138
    v_add_f32 v139, 1.0, v139
    v_rcp_f32 v139, v139
    v_add_f32 v140, 1.0, v140
    v_rcp_f32 v140, v140
    v_add_f32 v141, 1.0, v141
    v_rcp_f32 v141, v141
    v_add_f32 v142, 1.0, v142
    v_rcp_f32 v142, v142
    v_add_f32 v143, 1.0, v143
    v_rcp_f32 v143, v143
    v_add_f32 v144, 1.0, v144
    v_rcp_f32 v144, v144
    v_add_f32 v145, 1.0, v145
    v_rcp_f32 v145, v145
    v_add_f32 v146, 1.0, v146
    v_rcp_f32 v146, v146
    v_add_f32 v147, 1.0, v147
    v_rcp_f32 v147, v147
    v_add_f32 v148, 1.0, v148
    v_rcp_f32 v148, v148
    v_add_f32 v149, 1.0, v149
    v_rcp_f32 v149, v149
    v_add_f32 v150, 1.0, v150
    v_rcp_f32 v150, v150
    v_add_f32 v151, 1.0, v151
    v_rcp_f32 v151, v151
    v_mul_f32 v112, v112, v132
    v_cvt_pk_bf16_f32 v132, v112, 0
    v_lshlrev_b32 v112, 16, v132
    v_mul_f32 v113, v113, v133
    v_cvt_pk_bf16_f32 v133, v113, 0
    v_lshlrev_b32 v113, 16, v133
    v_mul_f32 v114, v114, v134
    v_cvt_pk_bf16_f32 v134, v114, 0
    v_lshlrev_b32 v114, 16, v134
    v_mul_f32 v115, v115, v135
    v_cvt_pk_bf16_f32 v135, v115, 0
    v_lshlrev_b32 v115, 16, v135
    v_mul_f32 v116, v116, v136
    v_cvt_pk_bf16_f32 v136, v116, 0
    v_lshlrev_b32 v116, 16, v136
    v_mul_f32 v117, v117, v137
    v_cvt_pk_bf16_f32 v137, v117, 0
    v_lshlrev_b32 v117, 16, v137
    v_mul_f32 v118, v118, v138
    v_cvt_pk_bf16_f32 v138, v118, 0
    v_lshlrev_b32 v118, 16, v138
    v_mul_f32 v119, v119, v139
    v_cvt_pk_bf16_f32 v139, v119, 0
    v_lshlrev_b32 v119, 16, v139
    v_mul_f32 v120, v120, v140
    v_cvt_pk_bf16_f32 v140, v120, 0
    v_lshlrev_b32 v120, 16, v140
    v_mul_f32 v121, v121, v141
    v_cvt_pk_bf16_f32 v141, v121, 0
    v_lshlrev_b32 v121, 16, v141
    v_mul_f32 v122, v122, v142
    v_cvt_pk_bf16_f32 v142, v122, 0
    v_lshlrev_b32 v122, 16, v142
    v_mul_f32 v123, v123, v143
    v_cvt_pk_bf16_f32 v143, v123, 0
    v_lshlrev_b32 v123, 16, v143
    v_mul_f32 v124, v124, v144
    v_cvt_pk_bf16_f32 v144, v124, 0
    v_lshlrev_b32 v124, 16, v144
    v_mul_f32 v125, v125, v145
    v_cvt_pk_bf16_f32 v145, v125, 0
    v_lshlrev_b32 v125, 16, v145
    v_mul_f32 v126, v126, v146
    v_cvt_pk_bf16_f32 v146, v126, 0
    v_lshlrev_b32 v126, 16, v146
    v_mul_f32 v127, v127, v147
    v_cvt_pk_bf16_f32 v147, v127, 0
    v_lshlrev_b32 v127, 16, v147
    v_mul_f32 v128, v128, v148
    v_cvt_pk_bf16_f32 v148, v128, 0
    v_lshlrev_b32 v128, 16, v148
    v_mul_f32 v129, v129, v149
    v_cvt_pk_bf16_f32 v149, v129, 0
    v_lshlrev_b32 v129, 16, v149
    v_mul_f32 v130, v130, v150
    v_cvt_pk_bf16_f32 v150, v130, 0
    v_lshlrev_b32 v130, 16, v150
    v_mul_f32 v131, v131, v151
    v_cvt_pk_bf16_f32 v151, v131, 0
    v_lshlrev_b32 v131, 16, v151
    v_mov_b32 v232, 0
    v_mov_b32 v233, 0
    v_mov_b32 v234, 0
    v_mov_b32 v235, 0
    v_mov_b32 v236, 0
    v_mov_b32 v237, 0
    v_mov_b32 v238, 0
    v_mov_b32 v239, 0
    v_lshrrev_b32 v240, 4, v0
    v_lshlrev_b32 v240, 8, v240
    v_lshl_add_u32 v240, v2, 5, v240
    v_add_u32 v240, 155648, v240
    s_lshr_b32 s65, s64, 6
    s_mul_i32 s65, s65, 26
    s_lshr_b32 s65, s65, 8
    s_cmp_eq_u32 s65, 1
    s_cselect_b32 s66, 1.0, 0
    s_cmp_eq_u32 s65, 4
    s_cselect_b32 s66, 1.0, s66
    v_lshlrev_b32 v241, 1, v1
    v_lshlrev_b32 v242, 2, v1
    v_add_u32 v243, 155648, v242
    v_and_b32 v245, 3, v1
    v_lshlrev_b32 v245, 6, v245
    v_bfe_u32 v246, v1, 2, 2
    v_lshl_add_u32 v245, v246, 4, v245
    v_lshl_add_u32 v245, v3, 2, v245
    s_lshl_b32 s51, s64, 2
    s_add_u32 s51, s51, 21921792
    s_lshl_b32 s67, s64, 2
    s_add_u32 s67, s67, 21889024
    s_lshl_b32 s68, s64, 1
    s_add_u32 s68, s68, 21905408
    s_waitcnt vmcnt(19)
    v_dot2_f32_bf16 v232, v152, v132, v232
    v_dot2_f32_bf16 v233, v152, v112, v233
    v_dot2_f32_bf16 v234, v153, v132, v234
    v_dot2_f32_bf16 v235, v153, v112, v235
    v_dot2_f32_bf16 v236, v154, v132, v236
    v_dot2_f32_bf16 v237, v154, v112, v237
    v_dot2_f32_bf16 v238, v155, v132, v238
    v_dot2_f32_bf16 v239, v155, v112, v239
    s_waitcnt vmcnt(18)
    v_dot2_f32_bf16 v232, v156, v133, v232
    v_dot2_f32_bf16 v233, v156, v113, v233
    v_dot2_f32_bf16 v234, v157, v133, v234
    v_dot2_f32_bf16 v235, v157, v113, v235
    v_dot2_f32_bf16 v236, v158, v133, v236
    v_dot2_f32_bf16 v237, v158, v113, v237
    v_dot2_f32_bf16 v238, v159, v133, v238
    v_dot2_f32_bf16 v239, v159, v113, v239
    s_waitcnt vmcnt(17)
    v_dot2_f32_bf16 v232, v160, v134, v232
    v_dot2_f32_bf16 v233, v160, v114, v233
    v_dot2_f32_bf16 v234, v161, v134, v234
    v_dot2_f32_bf16 v235, v161, v114, v235
    v_dot2_f32_bf16 v236, v162, v134, v236
    v_dot2_f32_bf16 v237, v162, v114, v237
    v_dot2_f32_bf16 v238, v163, v134, v238
    v_dot2_f32_bf16 v239, v163, v114, v239
    s_waitcnt vmcnt(16)
    v_dot2_f32_bf16 v232, v164, v135, v232
    v_dot2_f32_bf16 v233, v164, v115, v233
    v_dot2_f32_bf16 v234, v165, v135, v234
    v_dot2_f32_bf16 v235, v165, v115, v235
    v_dot2_f32_bf16 v236, v166, v135, v236
    v_dot2_f32_bf16 v237, v166, v115, v237
    v_dot2_f32_bf16 v238, v167, v135, v238
    v_dot2_f32_bf16 v239, v167, v115, v239
    s_waitcnt vmcnt(15)
    v_dot2_f32_bf16 v232, v168, v136, v232
    v_dot2_f32_bf16 v233, v168, v116, v233
    v_dot2_f32_bf16 v234, v169, v136, v234
    v_dot2_f32_bf16 v235, v169, v116, v235
    v_dot2_f32_bf16 v236, v170, v136, v236
    v_dot2_f32_bf16 v237, v170, v116, v237
    v_dot2_f32_bf16 v238, v171, v136, v238
    v_dot2_f32_bf16 v239, v171, v116, v239
    s_waitcnt vmcnt(14)
    v_dot2_f32_bf16 v232, v172, v137, v232
    v_dot2_f32_bf16 v233, v172, v117, v233
    v_dot2_f32_bf16 v234, v173, v137, v234
    v_dot2_f32_bf16 v235, v173, v117, v235
    v_dot2_f32_bf16 v236, v174, v137, v236
    v_dot2_f32_bf16 v237, v174, v117, v237
    v_dot2_f32_bf16 v238, v175, v137, v238
    v_dot2_f32_bf16 v239, v175, v117, v239
    s_waitcnt vmcnt(13)
    v_dot2_f32_bf16 v232, v176, v138, v232
    v_dot2_f32_bf16 v233, v176, v118, v233
    v_dot2_f32_bf16 v234, v177, v138, v234
    v_dot2_f32_bf16 v235, v177, v118, v235
    v_dot2_f32_bf16 v236, v178, v138, v236
    v_dot2_f32_bf16 v237, v178, v118, v237
    v_dot2_f32_bf16 v238, v179, v138, v238
    v_dot2_f32_bf16 v239, v179, v118, v239
    s_waitcnt vmcnt(12)
    v_dot2_f32_bf16 v232, v180, v139, v232
    v_dot2_f32_bf16 v233, v180, v119, v233
    v_dot2_f32_bf16 v234, v181, v139, v234
    v_dot2_f32_bf16 v235, v181, v119, v235
    v_dot2_f32_bf16 v236, v182, v139, v236
    v_dot2_f32_bf16 v237, v182, v119, v237
    v_dot2_f32_bf16 v238, v183, v139, v238
    v_dot2_f32_bf16 v239, v183, v119, v239
    s_waitcnt vmcnt(11)
    v_dot2_f32_bf16 v232, v184, v140, v232
    v_dot2_f32_bf16 v233, v184, v120, v233
    v_dot2_f32_bf16 v234, v185, v140, v234
    v_dot2_f32_bf16 v235, v185, v120, v235
    v_dot2_f32_bf16 v236, v186, v140, v236
    v_dot2_f32_bf16 v237, v186, v120, v237
    v_dot2_f32_bf16 v238, v187, v140, v238
    v_dot2_f32_bf16 v239, v187, v120, v239
    s_waitcnt vmcnt(10)
    v_dot2_f32_bf16 v232, v188, v141, v232
    v_dot2_f32_bf16 v233, v188, v121, v233
    v_dot2_f32_bf16 v234, v189, v141, v234
    v_dot2_f32_bf16 v235, v189, v121, v235
    v_dot2_f32_bf16 v236, v190, v141, v236
    v_dot2_f32_bf16 v237, v190, v121, v237
    v_dot2_f32_bf16 v238, v191, v141, v238
    v_dot2_f32_bf16 v239, v191, v121, v239
    s_waitcnt vmcnt(9)
    v_dot2_f32_bf16 v232, v192, v142, v232
    v_dot2_f32_bf16 v233, v192, v122, v233
    v_dot2_f32_bf16 v234, v193, v142, v234
    v_dot2_f32_bf16 v235, v193, v122, v235
    v_dot2_f32_bf16 v236, v194, v142, v236
    v_dot2_f32_bf16 v237, v194, v122, v237
    v_dot2_f32_bf16 v238, v195, v142, v238
    v_dot2_f32_bf16 v239, v195, v122, v239
    s_waitcnt vmcnt(8)
    v_dot2_f32_bf16 v232, v196, v143, v232
    v_dot2_f32_bf16 v233, v196, v123, v233
    v_dot2_f32_bf16 v234, v197, v143, v234
    v_dot2_f32_bf16 v235, v197, v123, v235
    v_dot2_f32_bf16 v236, v198, v143, v236
    v_dot2_f32_bf16 v237, v198, v123, v237
    v_dot2_f32_bf16 v238, v199, v143, v238
    v_dot2_f32_bf16 v239, v199, v123, v239
    s_waitcnt vmcnt(7)
    v_dot2_f32_bf16 v232, v200, v144, v232
    v_dot2_f32_bf16 v233, v200, v124, v233
    v_dot2_f32_bf16 v234, v201, v144, v234
    v_dot2_f32_bf16 v235, v201, v124, v235
    v_dot2_f32_bf16 v236, v202, v144, v236
    v_dot2_f32_bf16 v237, v202, v124, v237
    v_dot2_f32_bf16 v238, v203, v144, v238
    v_dot2_f32_bf16 v239, v203, v124, v239
    s_waitcnt vmcnt(6)
    v_dot2_f32_bf16 v232, v204, v145, v232
    v_dot2_f32_bf16 v233, v204, v125, v233
    v_dot2_f32_bf16 v234, v205, v145, v234
    v_dot2_f32_bf16 v235, v205, v125, v235
    v_dot2_f32_bf16 v236, v206, v145, v236
    v_dot2_f32_bf16 v237, v206, v125, v237
    v_dot2_f32_bf16 v238, v207, v145, v238
    v_dot2_f32_bf16 v239, v207, v125, v239
    s_waitcnt vmcnt(5)
    v_dot2_f32_bf16 v232, v208, v146, v232
    v_dot2_f32_bf16 v233, v208, v126, v233
    v_dot2_f32_bf16 v234, v209, v146, v234
    v_dot2_f32_bf16 v235, v209, v126, v235
    v_dot2_f32_bf16 v236, v210, v146, v236
    v_dot2_f32_bf16 v237, v210, v126, v237
    v_dot2_f32_bf16 v238, v211, v146, v238
    v_dot2_f32_bf16 v239, v211, v126, v239
    s_waitcnt vmcnt(4)
    v_dot2_f32_bf16 v232, v212, v147, v232
    v_dot2_f32_bf16 v233, v212, v127, v233
    v_dot2_f32_bf16 v234, v213, v147, v234
    v_dot2_f32_bf16 v235, v213, v127, v235
    v_dot2_f32_bf16 v236, v214, v147, v236
    v_dot2_f32_bf16 v237, v214, v127, v237
    v_dot2_f32_bf16 v238, v215, v147, v238
    v_dot2_f32_bf16 v239, v215, v127, v239
    s_waitcnt vmcnt(3)
    v_dot2_f32_bf16 v232, v216, v148, v232
    v_dot2_f32_bf16 v233, v216, v128, v233
    v_dot2_f32_bf16 v234, v217, v148, v234
    v_dot2_f32_bf16 v235, v217, v128, v235
    v_dot2_f32_bf16 v236, v218, v148, v236
    v_dot2_f32_bf16 v237, v218, v128, v237
    v_dot2_f32_bf16 v238, v219, v148, v238
    v_dot2_f32_bf16 v239, v219, v128, v239
    s_waitcnt vmcnt(2)
    v_dot2_f32_bf16 v232, v220, v149, v232
    v_dot2_f32_bf16 v233, v220, v129, v233
    v_dot2_f32_bf16 v234, v221, v149, v234
    v_dot2_f32_bf16 v235, v221, v129, v235
    v_dot2_f32_bf16 v236, v222, v149, v236
    v_dot2_f32_bf16 v237, v222, v129, v237
    v_dot2_f32_bf16 v238, v223, v149, v238
    v_dot2_f32_bf16 v239, v223, v129, v239
    s_waitcnt vmcnt(1)
    v_dot2_f32_bf16 v232, v224, v150, v232
    v_dot2_f32_bf16 v233, v224, v130, v233
    v_dot2_f32_bf16 v234, v225, v150, v234
    v_dot2_f32_bf16 v235, v225, v130, v235
    v_dot2_f32_bf16 v236, v226, v150, v236
    v_dot2_f32_bf16 v237, v226, v130, v237
    v_dot2_f32_bf16 v238, v227, v150, v238
    v_dot2_f32_bf16 v239, v227, v130, v239
    s_waitcnt vmcnt(0)
    v_dot2_f32_bf16 v232, v228, v151, v232
    s_branch L_pg8c
.p2align 12
L_pg8:
    s_setpc_b64 s[60:61]
L_pg8c:
    v_dot2_f32_bf16 v233, v228, v131, v233
    v_dot2_f32_bf16 v234, v229, v151, v234
    v_dot2_f32_bf16 v235, v229, v131, v235
    v_dot2_f32_bf16 v236, v230, v151, v236
    v_dot2_f32_bf16 v237, v230, v131, v237
    v_dot2_f32_bf16 v238, v231, v151, v238
    v_dot2_f32_bf16 v239, v231, v131, v239
    v_add_f32_dpp v232, v232, v232 row_ror:8 row_mask:0xf bank_mask:0xf
    v_add_f32_dpp v233, v233, v233 row_ror:8 row_mask:0xf bank_mask:0xf
    v_add_f32_dpp v234, v234, v234 row_ror:8 row_mask:0xf bank_mask:0xf
    v_add_f32_dpp v235, v235, v235 row_ror:8 row_mask:0xf bank_mask:0xf
    v_add_f32_dpp v236, v236, v236 row_ror:8 row_mask:0xf bank_mask:0xf
    v_add_f32_dpp v237, v237, v237 row_ror:8 row_mask:0xf bank_mask:0xf
    v_add_f32_dpp v238, v238, v238 row_ror:8 row_mask:0xf bank_mask:0xf
    v_add_f32_dpp v239, v239, v239 row_ror:8 row_mask:0xf bank_mask:0xf
    s_mov_b32 exec_lo, 0xff00ff
    s_mov_b32 exec_hi, 0xff00ff
    ds_write_b128 v240, v[232:235]
    ds_write_b128 v240, v[236:239] offset:16
    s_mov_b64 exec, -1
    s_waitcnt lgkmcnt(0)
    s_barrier
    s_cmp_lg_u32 s3, 0
    s_cbranch_scc1 L_gv17
    ds_read_b32 v152, v243 offset:0
    ds_read_b32 v153, v243 offset:256
    ds_read_b32 v154, v243 offset:512
    ds_read_b32 v155, v243 offset:768
    ds_read_b32 v156, v243 offset:1024
    ds_read_b32 v157, v243 offset:1280
    ds_read_b32 v158, v243 offset:1536
    ds_read_b32 v159, v243 offset:1792
    ds_read_b32 v160, v243 offset:2048
    ds_read_b32 v161, v243 offset:2304
    ds_read_b32 v162, v243 offset:2560
    ds_read_b32 v163, v243 offset:2816
    ds_read_b32 v164, v243 offset:3072
    ds_read_b32 v165, v243 offset:3328
    ds_read_b32 v166, v243 offset:3584
    ds_read_b32 v167, v243 offset:3840
    s_waitcnt lgkmcnt(0)
    v_add_f32 v152, v152, v153
    v_add_f32 v154, v154, v155
    v_add_f32 v156, v156, v157
    v_add_f32 v158, v158, v159
    v_add_f32 v160, v160, v161
    v_add_f32 v162, v162, v163
    v_add_f32 v164, v164, v165
    v_add_f32 v166, v166, v167
    v_add_f32 v152, v152, v154
    v_add_f32 v156, v156, v158
    v_add_f32 v160, v160, v162
    v_add_f32 v164, v164, v166
    v_add_f32 v152, v152, v156
    v_add_f32 v160, v160, v164
    v_add_f32 v152, v152, v160
    v_cvt_pk_bf16_f32 v247, v152, v152
    v_lshlrev_b32 v247, 16, v247
    v_add_f32 v247, s66, v247
    v_cvt_pk_bf16_f32 v247, v247, v247
    v_lshlrev_b32 v247, 16, v247
    buffer_store_dword v247, v245, s[8:11], s51 offen sc1
    v_mov_b32 v255, 0
    buffer_load_dword v255, v255, s[20:23], 0 offen offset:128 sc1
    s_waitcnt vmcnt(0)
    v_readfirstlane_b32 s53, v255
    s_nop 0
    s_cmp_lg_u32 s53, 0
    s_cbranch_scc1 L_rc18
    s_mov_b32 s52, 20000
L_rw19:
    s_sleep 4
    v_mov_b32 v255, 0
    buffer_load_dword v255, v255, s[20:23], 0 offen offset:128 sc1
    s_waitcnt vmcnt(0)
    v_readfirstlane_b32 s53, v255
    s_sub_u32 s52, s52, 1
    s_cselect_b32 s53, 1, s53
    s_cmp_eq_u32 s53, 0
    s_cbranch_scc1 L_rw19
L_rc18:
    v_lshlrev_b32 v6, 7, v1
    s_mov_b32 s52, 22446080
    s_mov_b32 exec_hi, 0
    v_mov_b32 v7, 1
    buffer_atomic_add v7, v6, s[8:11], s52 offen sc1
    s_mov_b64 exec, -1
L_gv17:
    s_barrier
    s_sub_u32 s5, s2, 134
    s_mov_b32 s42, 0
    s_call_b64 s[62:63], L_wdi
    s_cmp_lg_u32 s3, 0
    s_cbranch_scc1 L_tc5777_0
    s_call_b64 s[60:61], L_pg3
    s_call_b64 s[60:61], L_pg7
L_tc5777_0:
    s_cmp_lg_u32 s3, 1
    s_cbranch_scc1 L_tc5777_1
    s_call_b64 s[60:61], L_pg4
L_tc5777_1:
    s_cmp_lg_u32 s3, 2
    s_cbranch_scc1 L_tc5777_2
    s_call_b64 s[60:61], L_pg5
L_tc5777_2:
    s_cmp_lg_u32 s3, 3
    s_cbranch_scc1 L_tc5777_3
    s_call_b64 s[60:61], L_pg6
L_tc5777_3:
    s_waitcnt vmcnt(0)
    s_barrier
    s_branch L_wdl
L_bg_s:
    s_setpc_b64 s[60:61]
L_bg:
    s_waitcnt lgkmcnt(0)
    s_cmp_lt_u32 s2, 239
    s_cbranch_scc1 L_bgu
    s_load_dwordx2 s[32:33], s[0:1], 48
    s_mov_b32 s34, 2211840
    s_mov_b32 s35, 0x20000
    s_sub_u32 s5, s2, 239
    s_lshl_b32 s5, s5, 1
    s_mov_b32 s42, 0
    s_waitcnt lgkmcnt(0)
    s_call_b64 s[62:63], L_wdi
    s_add_u32 s5, s5, 1
    s_mov_b32 s42, 41984
    s_call_b64 s[62:63], L_wdi
    s_cmp_lg_u32 s3, 0
    s_cbranch_scc1 L_tc5797_0
    s_call_b64 s[60:61], L_pg3
    s_call_b64 s[60:61], L_pg7
L_tc5797_0:
    s_cmp_lg_u32 s3, 1
    s_cbranch_scc1 L_tc5797_1
    s_call_b64 s[60:61], L_pg4
L_tc5797_1:
    s_cmp_lg_u32 s3, 2
    s_cbranch_scc1 L_tc5797_2
    s_call_b64 s[60:61], L_pg5
L_tc5797_2:
    s_cmp_lg_u32 s3, 3
    s_cbranch_scc1 L_tc5797_3
    s_call_b64 s[60:61], L_pg6
L_tc5797_3:
    s_waitcnt vmcnt(0)
    s_barrier
    s_call_b64 s[62:63], L_wdf
    s_sub_u32 s5, s5, 1
    s_mov_b32 s42, 0
L_wdl:
    s_call_b64 s[62:63], L_wdf
    v_mov_b32 v255, 0
    buffer_load_dword v255, v255, s[20:23], 0 offen offset:128 sc1
    s_waitcnt vmcnt(0) lgkmcnt(0)
    s_barrier
    s_cmp_lg_u32 s3, 0
    s_cbranch_scc1 L_sg20
    v_readfirstlane_b32 s53, v255
    s_nop 0
    s_cmp_lg_u32 s53, 0
    s_cbranch_scc1 L_rc21
    s_mov_b32 s52, 20000
L_rw22:
    s_sleep 4
    v_mov_b32 v255, 0
    buffer_load_dword v255, v255, s[20:23], 0 offen offset:128 sc1
    s_waitcnt vmcnt(0)
    v_readfirstlane_b32 s53, v255
    s_sub_u32 s52, s52, 1
    s_cselect_b32 s53, 1, s53
    s_cmp_eq_u32 s53, 0
    s_cbranch_scc1 L_rw22
L_rc21:
    v_lshlrev_b32 v6, 7, v1
    s_mov_b32 s52, 22450176
    s_mov_b32 exec_hi, 0
    v_mov_b32 v7, 1
    buffer_atomic_add v7, v6, s[8:11], s52 offen sc1
    s_mov_b64 exec, -1
L_sg20:
    v_readfirstlane_b32 s53, v255
    s_nop 0
    s_cmp_lg_u32 s53, 0
    s_cbranch_scc1 L_rc23
    s_mov_b32 s52, 20000
L_rw24:
    s_sleep 4
    v_mov_b32 v255, 0
    buffer_load_dword v255, v255, s[20:23], 0 offen offset:128 sc1
    s_waitcnt vmcnt(0)
    v_readfirstlane_b32 s53, v255
    s_sub_u32 s52, s52, 1
    s_cselect_b32 s53, 1, s53
    s_cmp_eq_u32 s53, 0
    s_cbranch_scc1 L_rw24
L_rc23:
    s_branch L_bge
L_bgu:
    s_mov_b32 s6, 154
    s_cmp_ge_u32 s2, 188
    s_cselect_b32 s6, 174, s6
    s_cmp_ge_u32 s2, 228
    s_cselect_b32 s6, 228, s6
    s_sub_u32 s5, s2, s6
    s_load_dwordx2 s[24:25], s[0:1], 32
    s_mov_b32 s26, 2211840
    s_mov_b32 s27, 0x20000
    s_load_dwordx2 s[28:29], s[0:1], 40
    s_mov_b32 s30, 2211840
    s_mov_b32 s31, 0x20000
    s_lshl_b32 s4, s5, 2
    s_add_u32 s4, s4, s3
    s_mov_b32 s40, 12
    s_mov_b32 s41, 5462
    s_mov_b32 s44, 0
    s_mov_b32 s45, 0
    s_cmp_ge_u32 s4, 48
    s_cselect_b32 s40, 15, s40
    s_cselect_b32 s41, 4370, s41
    s_cselect_b32 s44, 12, s44
    s_cselect_b32 s46, 48, 0
    s_cmp_ge_u32 s4, 108
    s_cselect_b32 s40, 27, s40
    s_cselect_b32 s41, 2428, s41
    s_cselect_b32 s44, 0, s44
    s_cselect_b32 s45, 4, s45
    s_cselect_b32 s46, 108, s46
    s_sub_u32 s4, s4, s46
    s_mul_i32 s46, s4, s41
    s_lshr_b32 s46, s46, 16
    s_mul_i32 s47, s46, s40
    s_sub_u32 s47, s4, s47
    s_add_u32 s47, s47, s44
    s_add_u32 s46, s46, s45
    v_lshrrev_b32 v5, 3, v1
    v_mul_u32_u24 v6, 3456, v5
    v_and_b32 v5, 2, v5
    v_and_b32 v7, 7, v1
    v_xor_b32 v7, v7, v5
    v_lshl_add_u32 v8, v7, 4, v6
    v_xor_b32 v7, 4, v7
    v_lshl_add_u32 v9, v7, 4, v6
    s_mul_i32 s44, s46, 276480
    s_lshl_b32 s45, s47, 7
    s_add_u32 s44, s44, s45
    s_mul_i32 s43, s3, 20480
    s_mov_b32 s40, s43
    s_waitcnt lgkmcnt(0)
    s_mov_b32 m0, s40
    s_nop 0
    buffer_load_dwordx4 v8, s[24:27], s44 offen nt lds
    s_add_u32 m0, s40, 10240
    s_nop 0
    buffer_load_dwordx4 v9, s[28:31], s44 offen nt lds
    s_add_u32 s40, s40, 1024
    s_add_u32 s44, s44, 27648
    s_mov_b32 m0, s40
    s_nop 0
    buffer_load_dwordx4 v8, s[24:27], s44 offen nt lds
    s_add_u32 m0, s40, 10240
    s_nop 0
    buffer_load_dwordx4 v9, s[28:31], s44 offen nt lds
    s_add_u32 s40, s40, 1024
    s_add_u32 s44, s44, 27648
    s_mov_b32 m0, s40
    s_nop 0
    buffer_load_dwordx4 v8, s[24:27], s44 offen nt lds
    s_add_u32 m0, s40, 10240
    s_nop 0
    buffer_load_dwordx4 v9, s[28:31], s44 offen nt lds
    s_add_u32 s40, s40, 1024
    s_add_u32 s44, s44, 27648
    s_mov_b32 m0, s40
    s_nop 0
    buffer_load_dwordx4 v8, s[24:27], s44 offen nt lds
    s_add_u32 m0, s40, 10240
    s_nop 0
    buffer_load_dwordx4 v9, s[28:31], s44 offen nt lds
    s_add_u32 s40, s40, 1024
    s_add_u32 s44, s44, 27648
    s_mov_b32 m0, s40
    s_nop 0
    buffer_load_dwordx4 v8, s[24:27], s44 offen nt lds
    s_add_u32 m0, s40, 10240
    s_nop 0
    buffer_load_dwordx4 v9, s[28:31], s44 offen nt lds
    s_add_u32 s40, s40, 1024
    s_add_u32 s44, s44, 27648
    s_mov_b32 m0, s40
    s_nop 0
    buffer_load_dwordx4 v8, s[24:27], s44 offen nt lds
    s_add_u32 m0, s40, 10240
    s_nop 0
    buffer_load_dwordx4 v9, s[28:31], s44 offen nt lds
    s_add_u32 s40, s40, 1024
    s_add_u32 s44, s44, 27648
    s_mov_b32 m0, s40
    s_nop 0
    buffer_load_dwordx4 v8, s[24:27], s44 offen nt lds
    s_add_u32 m0, s40, 10240
    s_nop 0
    buffer_load_dwordx4 v9, s[28:31], s44 offen nt lds
    s_add_u32 s40, s40, 1024
    s_add_u32 s44, s44, 27648
    s_mov_b32 m0, s40
    s_nop 0
    buffer_load_dwordx4 v8, s[24:27], s44 offen nt lds
    s_add_u32 m0, s40, 10240
    s_nop 0
    buffer_load_dwordx4 v9, s[28:31], s44 offen nt lds
    s_add_u32 s40, s40, 1024
    s_add_u32 s44, s44, 27648
    s_mov_b32 m0, s40
    s_nop 0
    buffer_load_dwordx4 v8, s[24:27], s44 offen nt lds
    s_add_u32 m0, s40, 10240
    s_nop 0
    buffer_load_dwordx4 v9, s[28:31], s44 offen nt lds
    s_add_u32 s40, s40, 1024
    s_add_u32 s44, s44, 27648
    s_mov_b32 m0, s40
    s_nop 0
    buffer_load_dwordx4 v8, s[24:27], s44 offen nt lds
    s_add_u32 m0, s40, 10240
    s_nop 0
    buffer_load_dwordx4 v9, s[28:31], s44 offen nt lds
    s_add_u32 s40, s40, 1024
    s_add_u32 s44, s44, 27648
    s_cmp_ge_u32 s5, 14
    s_cbranch_scc1 L_bgh
    s_cmp_lg_u32 s3, 0
    s_cbranch_scc1 L_tc5984_0
    s_call_b64 s[60:61], L_pg3
    s_call_b64 s[60:61], L_pg7
L_tc5984_0:
    s_cmp_lg_u32 s3, 1
    s_cbranch_scc1 L_tc5984_1
    s_call_b64 s[60:61], L_pg4
L_tc5984_1:
    s_cmp_lg_u32 s3, 2
    s_cbranch_scc1 L_tc5984_2
    s_call_b64 s[60:61], L_pg5
L_tc5984_2:
    s_cmp_lg_u32 s3, 3
    s_cbranch_scc1 L_tc5984_3
    s_call_b64 s[60:61], L_pg6
L_tc5984_3:
    s_branch L_bgs
L_bgh:
    s_waitcnt vmcnt(40)
    v_lshlrev_b32 v112, 16, v100
    v_mul_f32 v132, 0xbfb8aa3b, v112
    v_exp_f32 v132, v132
    v_and_b32 v113, 0xffff0000, v100
    v_mul_f32 v133, 0xbfb8aa3b, v113
    v_exp_f32 v133, v133
    v_lshlrev_b32 v114, 16, v101
    v_mul_f32 v134, 0xbfb8aa3b, v114
    v_exp_f32 v134, v134
    v_and_b32 v115, 0xffff0000, v101
    v_mul_f32 v135, 0xbfb8aa3b, v115
    v_exp_f32 v135, v135
    v_lshlrev_b32 v116, 16, v102
    v_mul_f32 v136, 0xbfb8aa3b, v116
    v_exp_f32 v136, v136
    v_and_b32 v117, 0xffff0000, v102
    v_mul_f32 v137, 0xbfb8aa3b, v117
    v_exp_f32 v137, v137
    v_lshlrev_b32 v118, 16, v103
    v_mul_f32 v138, 0xbfb8aa3b, v118
    v_exp_f32 v138, v138
    v_and_b32 v119, 0xffff0000, v103
    v_mul_f32 v139, 0xbfb8aa3b, v119
    v_exp_f32 v139, v139
    v_lshlrev_b32 v120, 16, v104
    v_mul_f32 v140, 0xbfb8aa3b, v120
    v_exp_f32 v140, v140
    v_and_b32 v121, 0xffff0000, v104
    v_mul_f32 v141, 0xbfb8aa3b, v121
    v_exp_f32 v141, v141
    v_lshlrev_b32 v122, 16, v105
    v_mul_f32 v142, 0xbfb8aa3b, v122
    v_exp_f32 v142, v142
    v_and_b32 v123, 0xffff0000, v105
    v_mul_f32 v143, 0xbfb8aa3b, v123
    v_exp_f32 v143, v143
    v_lshlrev_b32 v124, 16, v106
    v_mul_f32 v144, 0xbfb8aa3b, v124
    v_exp_f32 v144, v144
    v_and_b32 v125, 0xffff0000, v106
    v_mul_f32 v145, 0xbfb8aa3b, v125
    v_exp_f32 v145, v145
    v_lshlrev_b32 v126, 16, v107
    v_mul_f32 v146, 0xbfb8aa3b, v126
    v_exp_f32 v146, v146
    v_and_b32 v127, 0xffff0000, v107
    v_mul_f32 v147, 0xbfb8aa3b, v127
    v_exp_f32 v147, v147
    v_lshlrev_b32 v128, 16, v108
    v_mul_f32 v148, 0xbfb8aa3b, v128
    v_exp_f32 v148, v148
    v_and_b32 v129, 0xffff0000, v108
    v_mul_f32 v149, 0xbfb8aa3b, v129
    v_exp_f32 v149, v149
    v_lshlrev_b32 v130, 16, v109
    v_mul_f32 v150, 0xbfb8aa3b, v130
    v_exp_f32 v150, v150
    v_and_b32 v131, 0xffff0000, v109
    v_mul_f32 v151, 0xbfb8aa3b, v131
    v_exp_f32 v151, v151
    v_add_f32 v132, 1.0, v132
    v_rcp_f32 v132, v132
    v_add_f32 v133, 1.0, v133
    v_rcp_f32 v133, v133
    v_add_f32 v134, 1.0, v134
    v_rcp_f32 v134, v134
    v_add_f32 v135, 1.0, v135
    v_rcp_f32 v135, v135
    v_add_f32 v136, 1.0, v136
    v_rcp_f32 v136, v136
    v_add_f32 v137, 1.0, v137
    v_rcp_f32 v137, v137
    v_add_f32 v138, 1.0, v138
    v_rcp_f32 v138, v138
    v_add_f32 v139, 1.0, v139
    v_rcp_f32 v139, v139
    v_add_f32 v140, 1.0, v140
    v_rcp_f32 v140, v140
    v_add_f32 v141, 1.0, v141
    v_rcp_f32 v141, v141
    v_add_f32 v142, 1.0, v142
    v_rcp_f32 v142, v142
    v_add_f32 v143, 1.0, v143
    v_rcp_f32 v143, v143
    v_add_f32 v144, 1.0, v144
    v_rcp_f32 v144, v144
    v_add_f32 v145, 1.0, v145
    v_rcp_f32 v145, v145
    v_add_f32 v146, 1.0, v146
    v_rcp_f32 v146, v146
    v_add_f32 v147, 1.0, v147
    v_rcp_f32 v147, v147
    v_add_f32 v148, 1.0, v148
    v_rcp_f32 v148, v148
    v_add_f32 v149, 1.0, v149
    v_rcp_f32 v149, v149
    v_add_f32 v150, 1.0, v150
    v_rcp_f32 v150, v150
    v_add_f32 v151, 1.0, v151
    v_rcp_f32 v151, v151
    v_mul_f32 v112, v112, v132
    v_cvt_pk_bf16_f32 v132, v112, 0
    v_lshlrev_b32 v112, 16, v132
    v_mul_f32 v113, v113, v133
    v_cvt_pk_bf16_f32 v133, v113, 0
    v_lshlrev_b32 v113, 16, v133
    v_mul_f32 v114, v114, v134
    v_cvt_pk_bf16_f32 v134, v114, 0
    v_lshlrev_b32 v114, 16, v134
    v_mul_f32 v115, v115, v135
    v_cvt_pk_bf16_f32 v135, v115, 0
    v_lshlrev_b32 v115, 16, v135
    v_mul_f32 v116, v116, v136
    v_cvt_pk_bf16_f32 v136, v116, 0
    v_lshlrev_b32 v116, 16, v136
    v_mul_f32 v117, v117, v137
    v_cvt_pk_bf16_f32 v137, v117, 0
    v_lshlrev_b32 v117, 16, v137
    v_mul_f32 v118, v118, v138
    v_cvt_pk_bf16_f32 v138, v118, 0
    v_lshlrev_b32 v118, 16, v138
    v_mul_f32 v119, v119, v139
    v_cvt_pk_bf16_f32 v139, v119, 0
    v_lshlrev_b32 v119, 16, v139
    v_mul_f32 v120, v120, v140
    v_cvt_pk_bf16_f32 v140, v120, 0
    v_lshlrev_b32 v120, 16, v140
    v_mul_f32 v121, v121, v141
    v_cvt_pk_bf16_f32 v141, v121, 0
    v_lshlrev_b32 v121, 16, v141
    v_mul_f32 v122, v122, v142
    v_cvt_pk_bf16_f32 v142, v122, 0
    v_lshlrev_b32 v122, 16, v142
    v_mul_f32 v123, v123, v143
    v_cvt_pk_bf16_f32 v143, v123, 0
    v_lshlrev_b32 v123, 16, v143
    v_mul_f32 v124, v124, v144
    v_cvt_pk_bf16_f32 v144, v124, 0
    v_lshlrev_b32 v124, 16, v144
    v_mul_f32 v125, v125, v145
    v_cvt_pk_bf16_f32 v145, v125, 0
    v_lshlrev_b32 v125, 16, v145
    v_mul_f32 v126, v126, v146
    v_cvt_pk_bf16_f32 v146, v126, 0
    v_lshlrev_b32 v126, 16, v146
    v_mul_f32 v127, v127, v147
    v_cvt_pk_bf16_f32 v147, v127, 0
    v_lshlrev_b32 v127, 16, v147
    v_mul_f32 v128, v128, v148
    v_cvt_pk_bf16_f32 v148, v128, 0
    v_lshlrev_b32 v128, 16, v148
    v_mul_f32 v129, v129, v149
    v_cvt_pk_bf16_f32 v149, v129, 0
    v_lshlrev_b32 v129, 16, v149
    v_mul_f32 v130, v130, v150
    v_cvt_pk_bf16_f32 v150, v130, 0
    v_lshlrev_b32 v130, 16, v150
    v_mul_f32 v131, v131, v151
    v_cvt_pk_bf16_f32 v151, v131, 0
    v_lshlrev_b32 v131, 16, v151
    v_mov_b32 v232, 0
    v_mov_b32 v233, 0
    v_mov_b32 v234, 0
    v_mov_b32 v235, 0
    v_mov_b32 v236, 0
    v_mov_b32 v237, 0
    v_mov_b32 v238, 0
    v_mov_b32 v239, 0
    v_lshrrev_b32 v240, 4, v0
    v_lshlrev_b32 v240, 8, v240
    v_lshl_add_u32 v240, v2, 5, v240
    v_add_u32 v240, 155648, v240
    s_lshr_b32 s65, s64, 6
    s_mul_i32 s65, s65, 26
    s_lshr_b32 s65, s65, 8
    s_cmp_eq_u32 s65, 1
    s_cselect_b32 s66, 1.0, 0
    s_cmp_eq_u32 s65, 4
    s_cselect_b32 s66, 1.0, s66
    v_lshlrev_b32 v241, 1, v1
    v_lshlrev_b32 v242, 2, v1
    v_add_u32 v243, 155648, v242
    v_and_b32 v245, 3, v1
    v_lshlrev_b32 v245, 6, v245
    v_bfe_u32 v246, v1, 2, 2
    v_lshl_add_u32 v245, v246, 4, v245
    v_lshl_add_u32 v245, v3, 2, v245
    s_lshl_b32 s51, s64, 2
    s_add_u32 s51, s51, 21921792
    s_lshl_b32 s67, s64, 2
    s_add_u32 s67, s67, 21889024
    s_lshl_b32 s68, s64, 1
    s_add_u32 s68, s68, 21905408
    s_waitcnt vmcnt(39)
    v_dot2_f32_bf16 v232, v152, v132, v232
    v_dot2_f32_bf16 v233, v152, v112, v233
    v_dot2_f32_bf16 v234, v153, v132, v234
    v_dot2_f32_bf16 v235, v153, v112, v235
    v_dot2_f32_bf16 v236, v154, v132, v236
    v_dot2_f32_bf16 v237, v154, v112, v237
    v_dot2_f32_bf16 v238, v155, v132, v238
    v_dot2_f32_bf16 v239, v155, v112, v239
    s_waitcnt vmcnt(38)
    v_dot2_f32_bf16 v232, v156, v133, v232
    v_dot2_f32_bf16 v233, v156, v113, v233
    v_dot2_f32_bf16 v234, v157, v133, v234
    v_dot2_f32_bf16 v235, v157, v113, v235
    v_dot2_f32_bf16 v236, v158, v133, v236
    v_dot2_f32_bf16 v237, v158, v113, v237
    v_dot2_f32_bf16 v238, v159, v133, v238
    v_dot2_f32_bf16 v239, v159, v113, v239
    s_waitcnt vmcnt(37)
    v_dot2_f32_bf16 v232, v160, v134, v232
    v_dot2_f32_bf16 v233, v160, v114, v233
    v_dot2_f32_bf16 v234, v161, v134, v234
    v_dot2_f32_bf16 v235, v161, v114, v235
    v_dot2_f32_bf16 v236, v162, v134, v236
    v_dot2_f32_bf16 v237, v162, v114, v237
    v_dot2_f32_bf16 v238, v163, v134, v238
    v_dot2_f32_bf16 v239, v163, v114, v239
    s_waitcnt vmcnt(36)
    v_dot2_f32_bf16 v232, v164, v135, v232
    v_dot2_f32_bf16 v233, v164, v115, v233
    v_dot2_f32_bf16 v234, v165, v135, v234
    v_dot2_f32_bf16 v235, v165, v115, v235
    v_dot2_f32_bf16 v236, v166, v135, v236
    v_dot2_f32_bf16 v237, v166, v115, v237
    v_dot2_f32_bf16 v238, v167, v135, v238
    v_dot2_f32_bf16 v239, v167, v115, v239
    s_waitcnt vmcnt(35)
    v_dot2_f32_bf16 v232, v168, v136, v232
    v_dot2_f32_bf16 v233, v168, v116, v233
    v_dot2_f32_bf16 v234, v169, v136, v234
    v_dot2_f32_bf16 v235, v169, v116, v235
    v_dot2_f32_bf16 v236, v170, v136, v236
    v_dot2_f32_bf16 v237, v170, v116, v237
    v_dot2_f32_bf16 v238, v171, v136, v238
    v_dot2_f32_bf16 v239, v171, v116, v239
    s_waitcnt vmcnt(34)
    v_dot2_f32_bf16 v232, v172, v137, v232
    v_dot2_f32_bf16 v233, v172, v117, v233
    v_dot2_f32_bf16 v234, v173, v137, v234
    v_dot2_f32_bf16 v235, v173, v117, v235
    v_dot2_f32_bf16 v236, v174, v137, v236
    v_dot2_f32_bf16 v237, v174, v117, v237
    v_dot2_f32_bf16 v238, v175, v137, v238
    v_dot2_f32_bf16 v239, v175, v117, v239
    s_waitcnt vmcnt(33)
    v_dot2_f32_bf16 v232, v176, v138, v232
    v_dot2_f32_bf16 v233, v176, v118, v233
    v_dot2_f32_bf16 v234, v177, v138, v234
    v_dot2_f32_bf16 v235, v177, v118, v235
    v_dot2_f32_bf16 v236, v178, v138, v236
    v_dot2_f32_bf16 v237, v178, v118, v237
    v_dot2_f32_bf16 v238, v179, v138, v238
    v_dot2_f32_bf16 v239, v179, v118, v239
    s_waitcnt vmcnt(32)
    v_dot2_f32_bf16 v232, v180, v139, v232
    v_dot2_f32_bf16 v233, v180, v119, v233
    v_dot2_f32_bf16 v234, v181, v139, v234
    v_dot2_f32_bf16 v235, v181, v119, v235
    v_dot2_f32_bf16 v236, v182, v139, v236
    v_dot2_f32_bf16 v237, v182, v119, v237
    v_dot2_f32_bf16 v238, v183, v139, v238
    v_dot2_f32_bf16 v239, v183, v119, v239
    s_waitcnt vmcnt(31)
    v_dot2_f32_bf16 v232, v184, v140, v232
    v_dot2_f32_bf16 v233, v184, v120, v233
    v_dot2_f32_bf16 v234, v185, v140, v234
    v_dot2_f32_bf16 v235, v185, v120, v235
    v_dot2_f32_bf16 v236, v186, v140, v236
    v_dot2_f32_bf16 v237, v186, v120, v237
    v_dot2_f32_bf16 v238, v187, v140, v238
    v_dot2_f32_bf16 v239, v187, v120, v239
    s_waitcnt vmcnt(30)
    v_dot2_f32_bf16 v232, v188, v141, v232
    v_dot2_f32_bf16 v233, v188, v121, v233
    v_dot2_f32_bf16 v234, v189, v141, v234
    v_dot2_f32_bf16 v235, v189, v121, v235
    v_dot2_f32_bf16 v236, v190, v141, v236
    v_dot2_f32_bf16 v237, v190, v121, v237
    v_dot2_f32_bf16 v238, v191, v141, v238
    v_dot2_f32_bf16 v239, v191, v121, v239
    s_waitcnt vmcnt(29)
    v_dot2_f32_bf16 v232, v192, v142, v232
    v_dot2_f32_bf16 v233, v192, v122, v233
    v_dot2_f32_bf16 v234, v193, v142, v234
    v_dot2_f32_bf16 v235, v193, v122, v235
    v_dot2_f32_bf16 v236, v194, v142, v236
    v_dot2_f32_bf16 v237, v194, v122, v237
    v_dot2_f32_bf16 v238, v195, v142, v238
    v_dot2_f32_bf16 v239, v195, v122, v239
    s_waitcnt vmcnt(28)
    v_dot2_f32_bf16 v232, v196, v143, v232
    v_dot2_f32_bf16 v233, v196, v123, v233
    v_dot2_f32_bf16 v234, v197, v143, v234
    v_dot2_f32_bf16 v235, v197, v123, v235
    v_dot2_f32_bf16 v236, v198, v143, v236
    v_dot2_f32_bf16 v237, v198, v123, v237
    v_dot2_f32_bf16 v238, v199, v143, v238
    v_dot2_f32_bf16 v239, v199, v123, v239
    s_waitcnt vmcnt(27)
    v_dot2_f32_bf16 v232, v200, v144, v232
    v_dot2_f32_bf16 v233, v200, v124, v233
    v_dot2_f32_bf16 v234, v201, v144, v234
    v_dot2_f32_bf16 v235, v201, v124, v235
    v_dot2_f32_bf16 v236, v202, v144, v236
    v_dot2_f32_bf16 v237, v202, v124, v237
    v_dot2_f32_bf16 v238, v203, v144, v238
    v_dot2_f32_bf16 v239, v203, v124, v239
    s_waitcnt vmcnt(26)
    v_dot2_f32_bf16 v232, v204, v145, v232
    v_dot2_f32_bf16 v233, v204, v125, v233
    v_dot2_f32_bf16 v234, v205, v145, v234
    v_dot2_f32_bf16 v235, v205, v125, v235
    v_dot2_f32_bf16 v236, v206, v145, v236
    v_dot2_f32_bf16 v237, v206, v125, v237
    v_dot2_f32_bf16 v238, v207, v145, v238
    v_dot2_f32_bf16 v239, v207, v125, v239
    s_waitcnt vmcnt(25)
    v_dot2_f32_bf16 v232, v208, v146, v232
    v_dot2_f32_bf16 v233, v208, v126, v233
    v_dot2_f32_bf16 v234, v209, v146, v234
    v_dot2_f32_bf16 v235, v209, v126, v235
    v_dot2_f32_bf16 v236, v210, v146, v236
    v_dot2_f32_bf16 v237, v210, v126, v237
    v_dot2_f32_bf16 v238, v211, v146, v238
    v_dot2_f32_bf16 v239, v211, v126, v239
    s_waitcnt vmcnt(24)
    v_dot2_f32_bf16 v232, v212, v147, v232
    v_dot2_f32_bf16 v233, v212, v127, v233
    v_dot2_f32_bf16 v234, v213, v147, v234
    v_dot2_f32_bf16 v235, v213, v127, v235
    v_dot2_f32_bf16 v236, v214, v147, v236
    v_dot2_f32_bf16 v237, v214, v127, v237
    v_dot2_f32_bf16 v238, v215, v147, v238
    v_dot2_f32_bf16 v239, v215, v127, v239
    s_waitcnt vmcnt(23)
    v_dot2_f32_bf16 v232, v216, v148, v232
    v_dot2_f32_bf16 v233, v216, v128, v233
    v_dot2_f32_bf16 v234, v217, v148, v234
    v_dot2_f32_bf16 v235, v217, v128, v235
    v_dot2_f32_bf16 v236, v218, v148, v236
    v_dot2_f32_bf16 v237, v218, v128, v237
    v_dot2_f32_bf16 v238, v219, v148, v238
    v_dot2_f32_bf16 v239, v219, v128, v239
    s_waitcnt vmcnt(22)
    v_dot2_f32_bf16 v232, v220, v149, v232
    v_dot2_f32_bf16 v233, v220, v129, v233
    v_dot2_f32_bf16 v234, v221, v149, v234
    v_dot2_f32_bf16 v235, v221, v129, v235
    v_dot2_f32_bf16 v236, v222, v149, v236
    v_dot2_f32_bf16 v237, v222, v129, v237
    v_dot2_f32_bf16 v238, v223, v149, v238
    v_dot2_f32_bf16 v239, v223, v129, v239
    s_waitcnt vmcnt(21)
    v_dot2_f32_bf16 v232, v224, v150, v232
    v_dot2_f32_bf16 v233, v224, v130, v233
    v_dot2_f32_bf16 v234, v225, v150, v234
    v_dot2_f32_bf16 v235, v225, v130, v235
    s_branch L_pg9c
.p2align 12
L_pg9:
    s_setpc_b64 s[60:61]
L_pg9c:
    v_dot2_f32_bf16 v236, v226, v150, v236
    v_dot2_f32_bf16 v237, v226, v130, v237
    v_dot2_f32_bf16 v238, v227, v150, v238
    v_dot2_f32_bf16 v239, v227, v130, v239
    s_waitcnt vmcnt(20)
    v_dot2_f32_bf16 v232, v228, v151, v232
    v_dot2_f32_bf16 v233, v228, v131, v233
    v_dot2_f32_bf16 v234, v229, v151, v234
    v_dot2_f32_bf16 v235, v229, v131, v235
    v_dot2_f32_bf16 v236, v230, v151, v236
    v_dot2_f32_bf16 v237, v230, v131, v237
    v_dot2_f32_bf16 v238, v231, v151, v238
    v_dot2_f32_bf16 v239, v231, v131, v239
    v_add_f32_dpp v232, v232, v232 row_ror:8 row_mask:0xf bank_mask:0xf
    v_add_f32_dpp v233, v233, v233 row_ror:8 row_mask:0xf bank_mask:0xf
    v_add_f32_dpp v234, v234, v234 row_ror:8 row_mask:0xf bank_mask:0xf
    v_add_f32_dpp v235, v235, v235 row_ror:8 row_mask:0xf bank_mask:0xf
    v_add_f32_dpp v236, v236, v236 row_ror:8 row_mask:0xf bank_mask:0xf
    v_add_f32_dpp v237, v237, v237 row_ror:8 row_mask:0xf bank_mask:0xf
    v_add_f32_dpp v238, v238, v238 row_ror:8 row_mask:0xf bank_mask:0xf
    v_add_f32_dpp v239, v239, v239 row_ror:8 row_mask:0xf bank_mask:0xf
    s_mov_b32 exec_lo, 0xff00ff
    s_mov_b32 exec_hi, 0xff00ff
    ds_write_b128 v240, v[232:235]
    ds_write_b128 v240, v[236:239] offset:16
    s_mov_b64 exec, -1
    s_waitcnt lgkmcnt(0)
    s_barrier
    s_cmp_lg_u32 s3, 0
    s_cbranch_scc1 L_gv25
    ds_read_b32 v152, v243 offset:0
    ds_read_b32 v153, v243 offset:256
    ds_read_b32 v154, v243 offset:512
    ds_read_b32 v155, v243 offset:768
    ds_read_b32 v156, v243 offset:1024
    ds_read_b32 v157, v243 offset:1280
    ds_read_b32 v158, v243 offset:1536
    ds_read_b32 v159, v243 offset:1792
    ds_read_b32 v160, v243 offset:2048
    ds_read_b32 v161, v243 offset:2304
    ds_read_b32 v162, v243 offset:2560
    ds_read_b32 v163, v243 offset:2816
    ds_read_b32 v164, v243 offset:3072
    ds_read_b32 v165, v243 offset:3328
    ds_read_b32 v166, v243 offset:3584
    ds_read_b32 v167, v243 offset:3840
    s_waitcnt lgkmcnt(0)
    v_add_f32 v152, v152, v153
    v_add_f32 v154, v154, v155
    v_add_f32 v156, v156, v157
    v_add_f32 v158, v158, v159
    v_add_f32 v160, v160, v161
    v_add_f32 v162, v162, v163
    v_add_f32 v164, v164, v165
    v_add_f32 v166, v166, v167
    v_add_f32 v152, v152, v154
    v_add_f32 v156, v156, v158
    v_add_f32 v160, v160, v162
    v_add_f32 v164, v164, v166
    v_add_f32 v152, v152, v156
    v_add_f32 v160, v160, v164
    v_add_f32 v152, v152, v160
    v_cvt_pk_bf16_f32 v247, v152, v152
    v_lshlrev_b32 v247, 16, v247
    v_add_f32 v247, s66, v247
    v_cvt_pk_bf16_f32 v247, v247, v247
    v_lshlrev_b32 v247, 16, v247
    buffer_store_dword v247, v242, s[8:11], s67 offen sc1
    buffer_store_short_d16_hi v247, v241, s[8:11], s68 offen sc1
    v_mov_b32 v255, 0
    buffer_load_dword v255, v255, s[20:23], 0 offen offset:128 sc1
    s_cmp_ge_u32 s2, 208
    s_cbranch_scc1 L_gv25
    s_waitcnt vmcnt(0)
    v_readfirstlane_b32 s53, v255
    s_nop 0
    s_cmp_lg_u32 s53, 0
    s_cbranch_scc1 L_rc26
    s_mov_b32 s52, 20000
L_rw27:
    s_sleep 4
    v_mov_b32 v255, 0
    buffer_load_dword v255, v255, s[20:23], 0 offen offset:128 sc1
    s_waitcnt vmcnt(0)
    v_readfirstlane_b32 s53, v255
    s_sub_u32 s52, s52, 1
    s_cselect_b32 s53, 1, s53
    s_cmp_eq_u32 s53, 0
    s_cbranch_scc1 L_rw27
L_rc26:
    v_lshlrev_b32 v6, 7, v1
    s_mov_b32 s52, 22458368
    s_mov_b32 exec_hi, 0
    v_mov_b32 v7, 1
    buffer_atomic_add v7, v6, s[8:11], s52 offen sc1
    s_mov_b64 exec, -1
L_gv25:
L_bgs:
    s_waitcnt vmcnt(0)
    v_bfe_u32 v5, v1, 4, 1
    v_mul_u32_u24 v12, 10240, v5
    v_bfe_u32 v6, v1, 2, 2
    v_lshl_add_u32 v12, v6, 7, v12
    v_and_b32 v6, 3, v1
    v_lshl_add_u32 v12, v6, 3, v12
    v_add_u32 v12, s43, v12
    v_bfe_u32 v13, v1, 3, 2
    v_lshrrev_b32 v6, 5, v1
    v_lshl_add_u32 v14, v6, 10, v12
    v_mul_u32_u24 v7, 5120, v6
    v_add_u32 v15, v7, v12
    v_xor_b32 v5, 0, v13
    v_lshl_add_u32 v36, v5, 5, v14
    v_lshl_add_u32 v40, v5, 5, v15
    v_xor_b32 v5, 1, v13
    v_lshl_add_u32 v37, v5, 5, v14
    v_lshl_add_u32 v41, v5, 5, v15
    v_xor_b32 v5, 2, v13
    v_lshl_add_u32 v38, v5, 5, v14
    v_lshl_add_u32 v42, v5, 5, v15
    v_xor_b32 v5, 3, v13
    v_lshl_add_u32 v39, v5, 5, v14
    v_lshl_add_u32 v43, v5, 5, v15
    v_and_b32 v5, 1, v1
    v_mul_u32_u24 v5, 1280, v5
    v_sub_u32 v5, 5120, v5
    v_lshl_add_u32 v10, v6, 4, v5
    v_mul_u32_u24 v6, 80, v6
    v_add_u32 v11, v5, v6
    s_lshl_b32 s44, s47, 2
    s_mul_i32 s44, s44, 40
    s_mul_i32 s45, s46, 5
    s_add_u32 s44, s44, s45
    s_lshl_b32 s44, s44, 10
    s_add_u32 s44, s44, 5505024
    ds_read_b64_tr_b16 a[0:1], v36 offset:0
    ds_read_b64_tr_b16 a[2:3], v36 offset:512
    ds_read_b64_tr_b16 a[4:5], v36 offset:2560
    ds_read_b64_tr_b16 a[6:7], v36 offset:3072
    ds_read_b64_tr_b16 a[8:9], v36 offset:5120
    ds_read_b64_tr_b16 a[10:11], v36 offset:5632
    ds_read_b64_tr_b16 a[12:13], v36 offset:7680
    ds_read_b64_tr_b16 a[14:15], v36 offset:8192
    ds_read_b64_tr_b16 a[16:17], v40 offset:2048
    ds_read_b64_tr_b16 a[18:19], v40 offset:4608
    ds_read_b64_tr_b16 a[20:21], v37 offset:0
    ds_read_b64_tr_b16 a[22:23], v37 offset:512
    ds_read_b64_tr_b16 a[24:25], v37 offset:2560
    ds_read_b64_tr_b16 a[26:27], v37 offset:3072
    ds_read_b64_tr_b16 a[28:29], v37 offset:5120
    ds_read_b64_tr_b16 a[30:31], v37 offset:5632
    ds_read_b64_tr_b16 a[32:33], v37 offset:7680
    ds_read_b64_tr_b16 a[34:35], v37 offset:8192
    ds_read_b64_tr_b16 a[36:37], v41 offset:2048
    ds_read_b64_tr_b16 a[38:39], v41 offset:4608
    s_waitcnt lgkmcnt(10)
    buffer_store_dwordx4 a[0:3], v4, s[8:11], s44 offen offset:0 sc1
    buffer_store_dwordx4 a[4:7], v4, s[8:11], s44 offen offset:1024 sc1
    buffer_store_dwordx4 a[8:11], v4, s[8:11], s44 offen offset:2048 sc1
    buffer_store_dwordx4 a[12:15], v4, s[8:11], s44 offen offset:3072 sc1
    s_add_u32 s45, s44, 4096
    buffer_store_dwordx4 a[16:19], v4, s[8:11], s45 offen offset:0 sc1
    s_add_u32 s44, s44, 40960
    ds_read_b64_tr_b16 a[40:41], v38 offset:0
    ds_read_b64_tr_b16 a[42:43], v38 offset:512
    ds_read_b64_tr_b16 a[44:45], v38 offset:2560
    ds_read_b64_tr_b16 a[46:47], v38 offset:3072
    ds_read_b64_tr_b16 a[48:49], v38 offset:5120
    ds_read_b64_tr_b16 a[50:51], v38 offset:5632
    ds_read_b64_tr_b16 a[52:53], v38 offset:7680
    ds_read_b64_tr_b16 a[54:55], v38 offset:8192
    ds_read_b64_tr_b16 a[56:57], v42 offset:2048
    ds_read_b64_tr_b16 a[58:59], v42 offset:4608
    s_waitcnt lgkmcnt(10)
    buffer_store_dwordx4 a[20:23], v4, s[8:11], s44 offen offset:0 sc1
    buffer_store_dwordx4 a[24:27], v4, s[8:11], s44 offen offset:1024 sc1
    buffer_store_dwordx4 a[28:31], v4, s[8:11], s44 offen offset:2048 sc1
    buffer_store_dwordx4 a[32:35], v4, s[8:11], s44 offen offset:3072 sc1
    s_add_u32 s45, s44, 4096
    buffer_store_dwordx4 a[36:39], v4, s[8:11], s45 offen offset:0 sc1
    s_add_u32 s44, s44, 40960
    ds_read_b64_tr_b16 a[60:61], v39 offset:0
    ds_read_b64_tr_b16 a[62:63], v39 offset:512
    ds_read_b64_tr_b16 a[64:65], v39 offset:2560
    ds_read_b64_tr_b16 a[66:67], v39 offset:3072
    ds_read_b64_tr_b16 a[68:69], v39 offset:5120
    ds_read_b64_tr_b16 a[70:71], v39 offset:5632
    ds_read_b64_tr_b16 a[72:73], v39 offset:7680
    ds_read_b64_tr_b16 a[74:75], v39 offset:8192
    ds_read_b64_tr_b16 a[76:77], v43 offset:2048
    ds_read_b64_tr_b16 a[78:79], v43 offset:4608
    s_waitcnt lgkmcnt(10)
    buffer_store_dwordx4 a[40:43], v4, s[8:11], s44 offen offset:0 sc1
    buffer_store_dwordx4 a[44:47], v4, s[8:11], s44 offen offset:1024 sc1
    buffer_store_dwordx4 a[48:51], v4, s[8:11], s44 offen offset:2048 sc1
    buffer_store_dwordx4 a[52:55], v4, s[8:11], s44 offen offset:3072 sc1
    s_add_u32 s45, s44, 4096
    buffer_store_dwordx4 a[56:59], v4, s[8:11], s45 offen offset:0 sc1
    s_add_u32 s44, s44, 40960
    s_waitcnt lgkmcnt(0)
    buffer_store_dwordx4 a[60:63], v4, s[8:11], s44 offen offset:0 sc1
    buffer_store_dwordx4 a[64:67], v4, s[8:11], s44 offen offset:1024 sc1
    buffer_store_dwordx4 a[68:71], v4, s[8:11], s44 offen offset:2048 sc1
    buffer_store_dwordx4 a[72:75], v4, s[8:11], s44 offen offset:3072 sc1
    s_add_u32 s45, s44, 4096
    buffer_store_dwordx4 a[76:79], v4, s[8:11], s45 offen offset:0 sc1
    s_add_u32 s44, s44, 40960
    v_mov_b32 v255, 0
    buffer_load_dword v255, v255, s[20:23], 0 offen offset:128 sc1
    s_waitcnt vmcnt(0) lgkmcnt(0)
    s_barrier
    s_cmp_lg_u32 s3, 0
    s_cbranch_scc1 L_sg28
    v_readfirstlane_b32 s53, v255
    s_nop 0
    s_cmp_lg_u32 s53, 0
    s_cbranch_scc1 L_rc29
    s_mov_b32 s52, 20000
L_rw30:
    s_sleep 4
    v_mov_b32 v255, 0
    buffer_load_dword v255, v255, s[20:23], 0 offen offset:128 sc1
    s_waitcnt vmcnt(0)
    v_readfirstlane_b32 s53, v255
    s_sub_u32 s52, s52, 1
    s_cselect_b32 s53, 1, s53
    s_cmp_eq_u32 s53, 0
    s_cbranch_scc1 L_rw30
L_rc29:
    v_lshlrev_b32 v6, 7, v1
    s_mov_b32 s52, 22450176
    s_mov_b32 exec_hi, 0
    v_mov_b32 v7, 1
    buffer_atomic_add v7, v6, s[8:11], s52 offen sc1
    s_mov_b64 exec, -1
L_sg28:
    s_lshl_b32 s6, s3, 6
    s_add_u32 s6, s6, s5
    s_cmp_ge_u32 s6, 12
    s_cbranch_scc1 L_bgt
    v_lshlrev_b32 v6, 7, v1
    s_mov_b32 s52, 22462464
    s_mov_b32 exec_hi, 0
    v_mov_b32 v7, 1
    buffer_atomic_add v7, v6, s[8:11], s52 offen sc1
    s_mov_b64 exec, -1
L_bgt:
    s_cmp_lg_u32 s3, 0
    s_cbranch_scc1 L_tc6595_0
    s_call_b64 s[60:61], L_pg3
    s_call_b64 s[60:61], L_pg7
L_tc6595_0:
    s_cmp_lg_u32 s3, 1
    s_cbranch_scc1 L_tc6595_1
    s_call_b64 s[60:61], L_pg4
L_tc6595_1:
    s_cmp_lg_u32 s3, 2
    s_cbranch_scc1 L_tc6595_2
    s_call_b64 s[60:61], L_pg5
L_tc6595_2:
    s_cmp_lg_u32 s3, 3
    s_cbranch_scc1 L_tc6595_3
    s_call_b64 s[60:61], L_pg6
L_tc6595_3:
    v_readfirstlane_b32 s53, v255
    s_nop 0
    s_cmp_lg_u32 s53, 0
    s_cbranch_scc1 L_rc31
    s_mov_b32 s52, 20000
L_rw32:
    s_sleep 4
    v_mov_b32 v255, 0
    buffer_load_dword v255, v255, s[20:23], 0 offen offset:128 sc1
    s_waitcnt vmcnt(0)
    v_readfirstlane_b32 s53, v255
    s_sub_u32 s52, s52, 1
    s_cselect_b32 s53, 1, s53
    s_cmp_eq_u32 s53, 0
    s_cbranch_scc1 L_rw32
L_rc31:
    s_and_b32 s53, s2, 31
    s_lshl_b32 s53, s53, 7
    s_add_u32 s53, s53, 22458368
    v_mov_b32 v7, 0
    s_mov_b64 exec, 1
    buffer_atomic_add v7, v7, s[8:11], s53 offen sc0 sc1
    s_mov_b64 exec, -1
    s_waitcnt vmcnt(0)
    s_mov_b32 s56, 20000
    s_branch L_cc33c
L_cc33:
    s_sleep 4
    s_and_b32 s53, s2, 31
    s_lshl_b32 s53, s53, 7
    s_add_u32 s53, s53, 22458368
    v_mov_b32 v7, 0
    s_mov_b64 exec, 1
    buffer_atomic_add v7, v7, s[8:11], s53 offen sc0 sc1
    s_mov_b64 exec, -1
    s_waitcnt vmcnt(0)
L_cc33c:
    v_readfirstlane_b32 s54, v7
    s_sub_u32 s56, s56, 1
    s_cselect_b32 s54, 20, s54
    s_cmp_lt_u32 s54, 20
    s_cbranch_scc1 L_cc33
    s_mul_i32 s45, s46, 160
    s_add_u32 s45, s45, 21905408
    buffer_load_dwordx4 v[16:19], v10, s[8:11], s45 offen offset:0 sc1
    buffer_load_dwordx4 v[20:23], v10, s[8:11], s45 offen offset:40 sc1
    buffer_load_dwordx4 v[24:27], v10, s[8:11], s45 offen offset:80 sc1
    buffer_load_dwordx4 v[28:31], v10, s[8:11], s45 offen offset:120 sc1
    buffer_load_dwordx2 v[32:33], v11, s[8:11], s45 offen offset:32 sc1
    buffer_load_dwordx2 v[34:35], v11, s[8:11], s45 offen offset:72 sc1
    v_lshlrev_b32 v5, 3, v1
    s_mul_i32 s44, s46, 108
    s_lshl_b32 s45, s47, 2
    s_add_u32 s44, s44, s45
    s_lshl_b32 s44, s44, 8
    s_add_u32 s44, s44, 21954560
    s_waitcnt vmcnt(0)
    v_mfma_f32_32x32x16_bf16 v[48:63], v[16:19], a[0:3], 0
    v_mfma_f32_32x32x16_bf16 v[64:79], v[16:19], a[20:23], 0
    v_mfma_f32_32x32x16_bf16 v[80:95], v[16:19], a[40:43], 0
    v_mfma_f32_32x32x16_bf16 v[96:111], v[16:19], a[60:63], 0
    v_mfma_f32_32x32x16_bf16 v[48:63], v[20:23], a[4:7], v[48:63]
    v_mfma_f32_32x32x16_bf16 v[64:79], v[20:23], a[24:27], v[64:79]
    v_mfma_f32_32x32x16_bf16 v[80:95], v[20:23], a[44:47], v[80:95]
    v_mfma_f32_32x32x16_bf16 v[96:111], v[20:23], a[64:67], v[96:111]
    v_mfma_f32_32x32x16_bf16 v[48:63], v[24:27], a[8:11], v[48:63]
    v_mfma_f32_32x32x16_bf16 v[64:79], v[24:27], a[28:31], v[64:79]
    v_mfma_f32_32x32x16_bf16 v[80:95], v[24:27], a[48:51], v[80:95]
    v_mfma_f32_32x32x16_bf16 v[96:111], v[24:27], a[68:71], v[96:111]
    v_mfma_f32_32x32x16_bf16 v[48:63], v[28:31], a[12:15], v[48:63]
    v_mfma_f32_32x32x16_bf16 v[64:79], v[28:31], a[32:35], v[64:79]
    v_mfma_f32_32x32x16_bf16 v[80:95], v[28:31], a[52:55], v[80:95]
    v_mfma_f32_32x32x16_bf16 v[96:111], v[28:31], a[72:75], v[96:111]
    v_mfma_f32_32x32x16_bf16 v[48:63], v[32:35], a[16:19], v[48:63]
    v_mfma_f32_32x32x16_bf16 v[64:79], v[32:35], a[36:39], v[64:79]
    v_mfma_f32_32x32x16_bf16 v[80:95], v[32:35], a[56:59], v[80:95]
    v_mfma_f32_32x32x16_bf16 v[96:111], v[32:35], a[76:79], v[96:111]
    s_mov_b32 exec_hi, 0
    s_nop 7
    buffer_store_dwordx2 v[48:49], v5, s[8:11], s44 offen offset:0 sc1
    buffer_store_dwordx2 v[64:65], v5, s[8:11], s44 offen offset:256 sc1
    buffer_store_dwordx2 v[80:81], v5, s[8:11], s44 offen offset:512 sc1
    buffer_store_dwordx2 v[96:97], v5, s[8:11], s44 offen offset:768 sc1
    s_mov_b64 exec, -1
    s_waitcnt vmcnt(0) lgkmcnt(0)
    s_barrier
    s_cmp_lg_u32 s3, 0
    s_cbranch_scc1 L_sg34
    v_lshlrev_b32 v6, 7, v1
    s_mov_b32 s52, 22454272
    s_mov_b32 exec_hi, 0
    v_mov_b32 v7, 1
    buffer_atomic_add v7, v6, s[8:11], s52 offen sc1
    s_mov_b64 exec, -1
L_sg34:
L_bge:
    s_mov_b32 s67, 0
    s_branch L_p3
L_wdi_s:
    s_setpc_b64 s[60:61]
L_wdi:
    s_lshl_b32 s49, s5, 2
    s_add_u32 s49, s49, s3
    s_mul_i32 s49, s49, 10240
    v_mul_u32_u24 v8, 6394, v1
    v_mov_b32 v5, v4
    s_mul_i32 s50, s3, 10496
    s_add_u32 m0, s50, s42
    s_mov_b32 s50, -32
    v_add_u32 v6, 0, v8
    v_lshrrev_b32 v6, 19, v6
    v_mad_i32_i24 v6, v6, s50, v5
    buffer_load_dwordx4 v6, s[32:35], s49 offen nt lds
    s_add_u32 m0, m0, 1024
    v_add_u32 v5, 1024, v5
    v_add_u32 v7, 409216, v8
    v_lshrrev_b32 v7, 19, v7
    v_mad_i32_i24 v7, v7, s50, v5
    buffer_load_dwordx4 v7, s[32:35], s49 offen nt lds
    s_add_u32 m0, m0, 1024
    v_add_u32 v5, 1024, v5
    v_add_u32 v6, 818432, v8
    v_lshrrev_b32 v6, 19, v6
    v_mad_i32_i24 v6, v6, s50, v5
    buffer_load_dwordx4 v6, s[32:35], s49 offen nt lds
    s_add_u32 m0, m0, 1024
    v_add_u32 v5, 1024, v5
    v_add_u32 v7, 1227648, v8
    v_lshrrev_b32 v7, 19, v7
    v_mad_i32_i24 v7, v7, s50, v5
    buffer_load_dwordx4 v7, s[32:35], s49 offen nt lds
    s_add_u32 m0, m0, 1024
    v_add_u32 v5, 1024, v5
    v_add_u32 v6, 1636864, v8
    v_lshrrev_b32 v6, 19, v6
    v_mad_i32_i24 v6, v6, s50, v5
    buffer_load_dwordx4 v6, s[32:35], s49 offen nt lds
    s_add_u32 m0, m0, 1024
    v_add_u32 v5, 1024, v5
    v_add_u32 v7, 2046080, v8
    v_lshrrev_b32 v7, 19, v7
    v_mad_i32_i24 v7, v7, s50, v5
    buffer_load_dwordx4 v7, s[32:35], s49 offen nt lds
    s_add_u32 m0, m0, 1024
    v_add_u32 v5, 1024, v5
    v_add_u32 v6, 2455296, v8
    v_lshrrev_b32 v6, 19, v6
    v_mad_i32_i24 v6, v6, s50, v5
    buffer_load_dwordx4 v6, s[32:35], s49 offen nt lds
    s_add_u32 m0, m0, 1024
    v_add_u32 v5, 1024, v5
    v_add_u32 v7, 2864512, v8
    v_lshrrev_b32 v7, 19, v7
    v_mad_i32_i24 v7, v7, s50, v5
    buffer_load_dwordx4 v7, s[32:35], s49 offen nt lds
    s_add_u32 m0, m0, 1024
    v_add_u32 v5, 1024, v5
    v_add_u32 v6, 3273728, v8
    v_lshrrev_b32 v6, 19, v6
    v_mad_i32_i24 v6, v6, s50, v5
    buffer_load_dwordx4 v6, s[32:35], s49 offen nt lds
    s_add_u32 m0, m0, 1024
    v_add_u32 v5, 1024, v5
    v_add_u32 v7, 3682944, v8
    v_lshrrev_b32 v7, 19, v7
    v_mad_i32_i24 v7, v7, s50, v5
    buffer_load_dwordx4 v7, s[32:35], s49 offen nt lds
    s_add_u32 m0, m0, 1024
    v_add_u32 v5, 1024, v5
    v_add_u32 v6, 4092160, v8
    v_lshrrev_b32 v6, 19, v6
    v_mad_i32_i24 v6, v6, s50, v5
    s_mov_b64 exec, 0xffff
    buffer_load_dwordx4 v6, s[32:35], s49 offen nt lds
    s_mov_b64 exec, -1
    s_nop 1
    s_setpc_b64 s[62:63]
L_wdf_s:
    s_setpc_b64 s[60:61]
L_wdf:
    v_lshrrev_b32 v8, 5, v1
    v_lshlrev_b32 v8, 4, v8
    v_bfe_u32 v5, v1, 2, 3
    v_add_u32 v8, v8, v5
    v_mul_u32_u24 v8, 1312, v8
    v_and_b32 v5, 3, v1
    v_mul_u32_u24 v5, 40, v5
    v_add_u32 v8, v8, v5
    s_mul_i32 s48, s3, 320
    s_add_u32 s48, s48, s42
    v_add_u32 v8, s48, v8
    s_mul_i32 s48, s3, 108
    s_add_u32 s48, s48, s5
    s_mul_i32 s48, s48, 5120
    s_add_u32 s48, s48, 9961472
    ds_read_b64_tr_b16 v[16:17], v8 offset:0
    ds_read_b64_tr_b16 v[18:19], v8 offset:10496
    ds_read_b64_tr_b16 v[20:21], v8 offset:8
    ds_read_b64_tr_b16 v[22:23], v8 offset:10504
    ds_read_b64_tr_b16 v[24:25], v8 offset:16
    ds_read_b64_tr_b16 v[26:27], v8 offset:10512
    ds_read_b64_tr_b16 v[28:29], v8 offset:24
    ds_read_b64_tr_b16 v[30:31], v8 offset:10520
    ds_read_b64_tr_b16 v[32:33], v8 offset:32
    ds_read_b64_tr_b16 v[34:35], v8 offset:10528
    ds_read_b64_tr_b16 v[36:37], v8 offset:160
    ds_read_b64_tr_b16 v[38:39], v8 offset:10656
    ds_read_b64_tr_b16 v[40:41], v8 offset:168
    ds_read_b64_tr_b16 v[42:43], v8 offset:10664
    ds_read_b64_tr_b16 v[44:45], v8 offset:176
    ds_read_b64_tr_b16 v[46:47], v8 offset:10672
    ds_read_b64_tr_b16 v[48:49], v8 offset:184
    ds_read_b64_tr_b16 v[50:51], v8 offset:10680
    ds_read_b64_tr_b16 v[52:53], v8 offset:192
    ds_read_b64_tr_b16 v[54:55], v8 offset:10688
    s_waitcnt lgkmcnt(10)
    buffer_store_dwordx4 v[16:19], v4, s[8:11], s48 offen offset:0 sc1
    buffer_store_dwordx4 v[20:23], v4, s[8:11], s48 offen offset:1024 sc1
    buffer_store_dwordx4 v[24:27], v4, s[8:11], s48 offen offset:2048 sc1
    buffer_store_dwordx4 v[28:31], v4, s[8:11], s48 offen offset:3072 sc1
    s_add_u32 s49, s48, 4096
    buffer_store_dwordx4 v[32:35], v4, s[8:11], s49 offen offset:0 sc1
    s_add_u32 s48, s48, 276480
    s_waitcnt lgkmcnt(0)
    buffer_store_dwordx4 v[36:39], v4, s[8:11], s48 offen offset:0 sc1
    buffer_store_dwordx4 v[40:43], v4, s[8:11], s48 offen offset:1024 sc1
    buffer_store_dwordx4 v[44:47], v4, s[8:11], s48 offen offset:2048 sc1
    buffer_store_dwordx4 v[48:51], v4, s[8:11], s48 offen offset:3072 sc1
    s_add_u32 s49, s48, 4096
    buffer_store_dwordx4 v[52:55], v4, s[8:11], s49 offen offset:0 sc1
    s_nop 1
    s_setpc_b64 s[62:63]
L_e:
.section .rodata,"a"
.p2align 6
.amdhsa_kernel adaLN_cond__spectral_gfnet__glu_gated_bilinear__prompt_kernel
  .amdhsa_next_free_vgpr 512
  .amdhsa_next_free_sgpr 70
  .amdhsa_accum_offset 256
  .amdhsa_group_segment_fixed_size 0
  .amdhsa_kernarg_size 96
  .amdhsa_user_sgpr_count 2
  .amdhsa_user_sgpr_kernarg_segment_ptr 1
  .amdhsa_system_sgpr_workgroup_id_x 1
.end_amdhsa_kernel
```
